```python
import torch

def _softmax(x, axis=-1):
    return torch.softmax(x, dim=axis)
def _gelu(x):
    return torch.nn.functional.gelu(x, approximate="tanh")
def _silu(x):
    return torch.nn.functional.silu(x)
def _sigmoid(x):
    return torch.sigmoid(x)
def _layernorm(x, axis=-1, eps=1e-5):
    m = x.mean(dim=axis, keepdim=True)
    v = x.var(dim=axis, keepdim=True, unbiased=False)
    return (x - m) / torch.sqrt(v + eps)
def _scatter_add(tgt, idx, src, axis=0):
    return tgt.clone().index_add_(axis, idx, src)
def _segment_sum(src, seg, n):
    out = torch.zeros((n,) + src.shape[1:], dtype=src.dtype)
    return out.index_add_(0, seg, src)
def _pad(x, pw):
    flat = tuple(v for pair in reversed(pw) for v in pair)
    return torch.nn.functional.pad(x, flat)

kernel_name = 'gated_mix__linear_attn_block__mha_block__prompt'

def setup_inputs():

    _w = (lambda a: (lambda t: t.to(torch.bfloat16) if t.is_floating_point() else t)(torch.as_tensor(a)))
    def _A_setup():
        B, S, D = 1, 2048, 576
        return {
            "x": _w((lambda *s: torch.randn(*s, dtype=torch.bfloat16) * 0.05)(B, S, D)),
            "wqkv": _w((lambda *s: torch.randn(*s, dtype=torch.bfloat16) * 0.8)(D, 3 * D)),
            "wo": _w((lambda *s: torch.randn(*s, dtype=torch.bfloat16) * 0.2)(D, D)),
        }
    _A_in = _A_setup()

    def _B_setup():
        B, S, D, H = 1, 2048, 576, 32
        return {
            "x": _w((lambda *s: torch.randn(*s, dtype=torch.bfloat16) * 0.05)(B, S, D)),
            "wqkv": _w((lambda *s: torch.randn(*s, dtype=torch.bfloat16) * 0.8)(D, 3 * D)),
            "wo": _w((lambda *s: torch.randn(*s, dtype=torch.bfloat16) * 0.05)(D, D)),
        }
    _B_in = _B_setup()

    return {
        "A_x": _A_in["x"],
        "A_wqkv": _A_in["wqkv"],
        "A_wo": _A_in["wo"],
        "B_x": _B_in["x"],
        "B_wqkv": _B_in["wqkv"],
        "B_wo": _B_in["wo"],
        "gate_w": _w((lambda *s: torch.randn(*s, dtype=torch.bfloat16) * 0.05)(576) * 16.0),
    }

def reference(A_x, A_wqkv, A_wo, B_x, B_wqkv, B_wo, gate_w):
    def _A_ref(x, wqkv, wo):
        B, S, D = x.shape
        H = 32; Dh = D // H
        qkv = (lambda x, *d: x.permute(*d))((x @ wqkv).reshape(B, S, 3, H, Dh), 2, 0, 3, 1, 4)
        q, k, v = qkv[0], qkv[1], qkv[2]
        phi = lambda t: torch.where(t > 0, t + 1, torch.exp(t)) + 1e-6
        pq, pk = phi(q), phi(k)
        kv = torch.einsum("bhsd,bhse->bhde", pk, v)
        z = torch.einsum("bhsd->bhd", pk)
        num = torch.einsum("bhqd,bhde->bhqe", pq, kv)
        den = torch.einsum("bhqd,bhd->bhq", pq, z)[..., None] + 1e-6
        o = num / den
        return (lambda x, *d: x.permute(*d))(o, 0, 2, 1, 3).reshape(B, S, D) @ wo

    def _B_ref(x, wqkv, wo):
        B, S, D = x.shape
        H = 32
        Dh = D // H
        qkv = (lambda x, *d: x.permute(*d))((x @ wqkv).reshape(B, S, 3, H, Dh), 2, 0, 3, 1, 4)
        q, k, v = qkv[0], qkv[1], qkv[2]
        scores = torch.einsum("bhqd,bhkd->bhqk", q, k) * (Dh ** -0.5)
        p = _softmax(scores, axis=-1)
        o = torch.einsum("bhqk,bhkd->bhqd", p, v)
        return (lambda x, *d: x.permute(*d))(o, 0, 2, 1, 3).reshape(B, S, D) @ wo

    x = A_x
    g = _sigmoid((x * gate_w).sum(-1, keepdims=True))
    a = _A_ref(x, A_wqkv, A_wo)
    b = _B_ref(x, B_wqkv, B_wo)
    return g * a + (1 - g) * b
```

```asm
; @launch grid=(256,1,1) block=(512,1,1) lds=163840
.amdgcn_target "amdgcn-amd-amdhsa--gfx950"
.text
.globl gated_mix__linear_attn_block__mha_block__prompt_kernel
.p2align 8
.type gated_mix__linear_attn_block__mha_block__prompt_kernel,@function
gated_mix__linear_attn_block__mha_block__prompt_kernel:
    s_cmp_ge_u32 s2, 256
    s_cbranch_scc1 L_done
    s_load_dwordx16 s[56:71], s[0:1], 0
    s_load_dwordx4 s[72:75], s[0:1], 64
    v_lshrrev_b32 v1, 6, v0
    s_and_b32 s29, s2, 7
    s_lshr_b32 s30, s2, 3
    v_readfirstlane_b32 s3, v1
    v_and_b32 v1, 63, v0
    s_waitcnt lgkmcnt(0)
    s_mov_b32 s8, s74
    s_and_b32 s9, s75, 0xffff
    s_mov_b32 s10, 268435456
    s_mov_b32 s11, 0x00020000
    s_mov_b32 s12, s56
    s_and_b32 s13, s57, 0xffff
    s_mov_b32 s14, 2359296
    s_mov_b32 s15, 0x00020000
    s_mov_b32 s20, s72
    s_and_b32 s21, s73, 0xffff
    s_mov_b32 s22, 256
    s_mov_b32 s23, 0x00020000
    s_cmp_eq_u32 s2, 0
    s_cbranch_scc0 L_notagc
    s_cmp_eq_u32 s3, 4
    s_cbranch_scc0 L_notagc
    s_memrealtime s[50:51]
    s_waitcnt lgkmcnt(0)
    s_or_b32 s50, s50, 1
    v_mov_b32 v2, 0
    v_mov_b32 v3, s50
    s_mov_b64 exec, 1
    buffer_store_dword v3, v2, s[20:23], 0 offen sc1
    s_mov_b64 exec, -1
L_notagc:
    s_and_b32 s31, s30, 1
    s_xor_b32 s31, s31, 1
    s_lshr_b32 s32, s30, 1
    s_mov_b32 s33, s29
    s_cmp_eq_u32 s31, 0
    s_cselect_b32 s4, s58, s64
    s_cselect_b32 s5, s59, s65
    s_mov_b32 s16, s4
    s_and_b32 s17, s5, 0xffff
    s_mov_b32 s18, 1990656
    s_mov_b32 s19, 0x00020000
    s_cmp_ge_u32 s3, 4
    s_cbranch_scc1 P1_loader
    s_lshl_b32 s40, s30, 6
    v_add_u32 v2, s40, v1
    v_mul_u32_u24 v244, 1152, v2
    s_and_b32 s40, s30, 15
    s_mul_i32 s40, s40, 24
    v_add_u32 v2, s40, v1
    v_mul_u32_u24 v3, 10923, v2
    v_lshrrev_b32 v3, 16, v3
    v_mul_u32_u24 v4, 6, v3
    v_sub_u32 v4, v2, v4
    v_lshrrev_b32 v5, 1, v4
    v_and_b32 v6, 1, v4
    v_mul_u32_u24 v3, 3456, v3
    v_mul_u32_u24 v5, 1152, v5
    v_lshlrev_b32 v6, 7, v6
    v_add3_u32 v3, v3, v5, v6
    s_mul_i32 s40, s33, 144
    s_and_b32 s40, s40, 0xffffff80
    v_add_u32 v3, s40, v3
    v_mov_b32 v4, 1073741824
    v_cmp_gt_u32 vcc, 24, v1
    s_cmp_ge_u32 s30, 16
    s_cselect_b32 s24, s64, s58
    s_cselect_b32 s25, s65, s59
    s_and_b32 s25, s25, 0xffff
    s_mov_b32 s26, 1990656
    s_mov_b32 s27, 0x00020000
    v_cndmask_b32 v246, v4, v3, vcc
    s_lshl_b32 s53, s3, 7
    s_mul_i32 s54, s3, 221184
    s_mul_i32 s34, s3, 128
    s_add_u32 s34, s34, 0
    buffer_load_dword v245, v244, s[12:15], s34 offen
    s_mul_i32 s34, s3, 221184
    s_add_u32 s34, s34, 0
    buffer_load_dword v245, v246, s[24:27], s34 offen
    s_mul_i32 s34, s3, 221184
    s_add_u32 s34, s34, 884736
    buffer_load_dword v245, v246, s[24:27], s34 offen
    s_mul_i32 s34, s3, 221184
    s_add_u32 s34, s34, 1769472
    s_cmp_lt_u32 s3, 1
    s_cselect_b32 s34, s34, 1073741824
    buffer_load_dword v245, v246, s[24:27], s34 offen
    s_cmp_eq_u32 s3, 0
    s_cbranch_scc0 P1_noxid
    s_getreg_b32 s40, hwreg(HW_REG_XCC_ID, 0, 4)
    s_add_u32 s40, s40, 1
    s_and_b32 s41, s30, 7
    s_lshl_b32 s41, s41, 2
    s_lshl_b32 s40, s40, s41
    s_lshl_b32 s41, s29, 4
    s_lshr_b32 s42, s30, 3
    s_lshl_b32 s42, s42, 2
    s_add_u32 s41, s41, s42
    s_add_u32 s41, s41, 128
    v_mov_b32 v2, s41
    v_mov_b32 v3, s40
    s_mov_b64 exec, 1
    buffer_atomic_or v3, v2, s[20:23], 0 offen sc1
    s_mov_b64 exec, -1
P1_noxid:
    s_lshr_b32 s38, s3, 1
    s_and_b32 s39, s3, 1
    v_and_b32 v2, 15, v1
    v_lshrrev_b32 v3, 4, v1
    s_lshl_b32 s40, s38, 13
    v_lshlrev_b32 v4, 7, v2
    v_add_u32 v4, s40, v4
    v_lshrrev_b32 v5, 1, v2
    v_xor_b32 v5, v5, v3
    v_lshlrev_b32 v6, 4, v5
    v_add_u32 v216, v4, v6
    v_xor_b32 v5, 4, v5
    v_lshlrev_b32 v6, 4, v5
    v_add_u32 v217, v4, v6
    v_lshrrev_b32 v4, 2, v2
    v_and_b32 v5, 3, v1
    v_lshlrev_b32 v6, 3, v3
    v_add_u32 v6, v6, v4
    v_mul_u32_u24 v6, 448, v6
    v_lshlrev_b32 v7, 3, v5
    v_add_u32 v6, v6, v7
    s_mul_i32 s40, s39, 224
    s_add_u32 s40, s40, 16384
    v_add_u32 v6, s40, v6
    v_and_b32 v7, 1, v3
    v_lshlrev_b32 v7, 5, v7
    v_add_u32 v8, v6, v7
    v_sub_u32 v9, v6, v7
    s_cmp_eq_u32 s39, 0
    s_cselect_b64 vcc, -1, 0
    v_cndmask_b32 v218, v9, v8, vcc
    v_cndmask_b32 v219, v8, v9, vcc
    s_lshl_b32 s41, s32, 1
    s_add_u32 s41, s41, s38
    s_mul_i32 s42, s39, 112
    s_lshl_b32 s43, s33, 2
    s_mul_i32 s44, s41, 2304
    s_mul_i32 s45, s41, 4736
    s_cmp_eq_u32 s31, 0
    s_mov_b32 s46, 4849664
    s_cselect_b32 s46, 7208960, s46
    s_add_u32 s44, s44, s46
    s_add_u32 s46, s45, 2304
    s_mul_i32 s47, s38, 4736
    s_add_u32 s48, s47, 1152
    s_cmp_eq_u32 s31, 0
    s_cselect_b32 s45, s47, s45
    s_cselect_b32 s46, s48, s46
    s_mov_b32 s47, 151552
    s_cselect_b32 s47, 9472, s47
    s_cselect_b32 s48, 0, s43
    s_mov_b32 s49, 73728
    v_mul_u32_u24 v14, 288, v3
    v_mul_u32_u24 v15, 304, v3
    v_add_u32 v4, s42, v2
    v_add_u32 v4, 0, v4
    v_mul_u32_u24 v5, 911, v4
    v_lshrrev_b32 v5, 16, v5
    v_mul_u32_u24 v6, 72, v5
    v_sub_u32 v6, v4, v6
    v_mul_u32_u24 v7, 3641, v6
    v_lshrrev_b32 v7, 16, v7
    v_mul_u32_u24 v8, 18, v7
    v_sub_u32 v8, v6, v8
    v_cmp_eq_u32 vcc, 3, v5
    v_mov_b32 v9, 18
    v_add_u32 v10, s43, v7
    v_cndmask_b32 v7, v7, v6, vcc
    v_cndmask_b32 v8, v8, v9, vcc
    v_add_u32 v9, s43, v7
    v_mul_lo_u32 v9, s49, v9
    v_add3_u32 v9, s44, v9, v14
    v_add_u32 v11, s48, v7
    v_mul_lo_u32 v11, s47, v11
    v_add3_u32 v12, s45, v11, v14
    v_cmp_eq_u32 vcc, 1, v5
    v_add3_u32 v13, s46, v11, v15
    v_lshlrev_b32 v8, 4, v8
    v_cndmask_b32 v9, v9, v12, vcc
    v_cmp_le_u32 vcc, 2, v5
    v_mov_b32 v10, 1073741824
    s_nop 0
    v_cndmask_b32 v9, v9, v13, vcc
    v_cmp_lt_u32 vcc, 219, v4
    v_add_u32 v9, v9, v8
    s_nop 0
    v_cndmask_b32 v220, v9, v10, vcc
    v_add_u32 v4, s42, v2
    v_add_u32 v4, 16, v4
    v_mul_u32_u24 v5, 911, v4
    v_lshrrev_b32 v5, 16, v5
    v_mul_u32_u24 v6, 72, v5
    v_sub_u32 v6, v4, v6
    v_mul_u32_u24 v7, 3641, v6
    v_lshrrev_b32 v7, 16, v7
    v_mul_u32_u24 v8, 18, v7
    v_sub_u32 v8, v6, v8
    v_cmp_eq_u32 vcc, 3, v5
    v_mov_b32 v9, 18
    v_add_u32 v10, s43, v7
    v_cndmask_b32 v7, v7, v6, vcc
    v_cndmask_b32 v8, v8, v9, vcc
    v_add_u32 v9, s43, v7
    v_mul_lo_u32 v9, s49, v9
    v_add3_u32 v9, s44, v9, v14
    v_add_u32 v11, s48, v7
    v_mul_lo_u32 v11, s47, v11
    v_add3_u32 v12, s45, v11, v14
    v_cmp_eq_u32 vcc, 1, v5
    v_add3_u32 v13, s46, v11, v15
    v_lshlrev_b32 v8, 4, v8
    v_cndmask_b32 v9, v9, v12, vcc
    v_cmp_le_u32 vcc, 2, v5
    v_mov_b32 v10, 1073741824
    s_nop 0
    v_cndmask_b32 v9, v9, v13, vcc
    v_cmp_lt_u32 vcc, 219, v4
    v_add_u32 v9, v9, v8
    s_nop 0
    v_cndmask_b32 v221, v9, v10, vcc
    v_add_u32 v4, s42, v2
    v_add_u32 v4, 32, v4
    v_mul_u32_u24 v5, 911, v4
    v_lshrrev_b32 v5, 16, v5
    v_mul_u32_u24 v6, 72, v5
    v_sub_u32 v6, v4, v6
    v_mul_u32_u24 v7, 3641, v6
    v_lshrrev_b32 v7, 16, v7
    v_mul_u32_u24 v8, 18, v7
    v_sub_u32 v8, v6, v8
    v_cmp_eq_u32 vcc, 3, v5
    v_mov_b32 v9, 18
    v_add_u32 v10, s43, v7
    v_cndmask_b32 v7, v7, v6, vcc
    v_cndmask_b32 v8, v8, v9, vcc
    v_add_u32 v9, s43, v7
    v_mul_lo_u32 v9, s49, v9
    v_add3_u32 v9, s44, v9, v14
    v_add_u32 v11, s48, v7
    v_mul_lo_u32 v11, s47, v11
    v_add3_u32 v12, s45, v11, v14
    v_cmp_eq_u32 vcc, 1, v5
    v_add3_u32 v13, s46, v11, v15
    v_lshlrev_b32 v8, 4, v8
    v_cndmask_b32 v9, v9, v12, vcc
    v_cmp_le_u32 vcc, 2, v5
    v_mov_b32 v10, 1073741824
    s_nop 0
    v_cndmask_b32 v9, v9, v13, vcc
    v_cmp_lt_u32 vcc, 219, v4
    v_add_u32 v9, v9, v8
    s_nop 0
    v_cndmask_b32 v222, v9, v10, vcc
    v_add_u32 v4, s42, v2
    v_add_u32 v4, 48, v4
    v_mul_u32_u24 v5, 911, v4
    v_lshrrev_b32 v5, 16, v5
    v_mul_u32_u24 v6, 72, v5
    v_sub_u32 v6, v4, v6
    v_mul_u32_u24 v7, 3641, v6
    v_lshrrev_b32 v7, 16, v7
    v_mul_u32_u24 v8, 18, v7
    v_sub_u32 v8, v6, v8
    v_cmp_eq_u32 vcc, 3, v5
    v_mov_b32 v9, 18
    v_add_u32 v10, s43, v7
    v_cndmask_b32 v7, v7, v6, vcc
    v_cndmask_b32 v8, v8, v9, vcc
    v_add_u32 v9, s43, v7
    v_mul_lo_u32 v9, s49, v9
    v_add3_u32 v9, s44, v9, v14
    v_add_u32 v11, s48, v7
    v_mul_lo_u32 v11, s47, v11
    v_add3_u32 v12, s45, v11, v14
    v_cmp_eq_u32 vcc, 1, v5
    v_add3_u32 v13, s46, v11, v15
    v_lshlrev_b32 v8, 4, v8
    v_cndmask_b32 v9, v9, v12, vcc
    v_cmp_le_u32 vcc, 2, v5
    v_mov_b32 v10, 1073741824
    s_nop 0
    v_cndmask_b32 v9, v9, v13, vcc
    v_cmp_lt_u32 vcc, 219, v4
    v_add_u32 v9, v9, v8
    s_nop 0
    v_cndmask_b32 v223, v9, v10, vcc
    v_add_u32 v4, s42, v2
    v_add_u32 v4, 64, v4
    v_mul_u32_u24 v5, 911, v4
    v_lshrrev_b32 v5, 16, v5
    v_mul_u32_u24 v6, 72, v5
    v_sub_u32 v6, v4, v6
    v_mul_u32_u24 v7, 3641, v6
    v_lshrrev_b32 v7, 16, v7
    v_mul_u32_u24 v8, 18, v7
    v_sub_u32 v8, v6, v8
    v_cmp_eq_u32 vcc, 3, v5
    v_mov_b32 v9, 18
    v_add_u32 v10, s43, v7
    v_cndmask_b32 v7, v7, v6, vcc
    v_cndmask_b32 v8, v8, v9, vcc
    v_add_u32 v9, s43, v7
    v_mul_lo_u32 v9, s49, v9
    v_add3_u32 v9, s44, v9, v14
    v_add_u32 v11, s48, v7
    v_mul_lo_u32 v11, s47, v11
    v_add3_u32 v12, s45, v11, v14
    v_cmp_eq_u32 vcc, 1, v5
    v_add3_u32 v13, s46, v11, v15
    v_lshlrev_b32 v8, 4, v8
    v_cndmask_b32 v9, v9, v12, vcc
    v_cmp_le_u32 vcc, 2, v5
    v_mov_b32 v10, 1073741824
    s_nop 0
    v_cndmask_b32 v9, v9, v13, vcc
    v_cmp_lt_u32 vcc, 219, v4
    v_add_u32 v9, v9, v8
    s_nop 0
    v_cndmask_b32 v224, v9, v10, vcc
    v_add_u32 v4, s42, v2
    v_add_u32 v4, 80, v4
    v_mul_u32_u24 v5, 911, v4
    v_lshrrev_b32 v5, 16, v5
    v_mul_u32_u24 v6, 72, v5
    v_sub_u32 v6, v4, v6
    v_mul_u32_u24 v7, 3641, v6
    v_lshrrev_b32 v7, 16, v7
    v_mul_u32_u24 v8, 18, v7
    v_sub_u32 v8, v6, v8
    v_cmp_eq_u32 vcc, 3, v5
    v_mov_b32 v9, 18
    v_add_u32 v10, s43, v7
    v_cndmask_b32 v7, v7, v6, vcc
    v_cndmask_b32 v8, v8, v9, vcc
    v_add_u32 v9, s43, v7
    v_mul_lo_u32 v9, s49, v9
    v_add3_u32 v9, s44, v9, v14
    v_add_u32 v11, s48, v7
    v_mul_lo_u32 v11, s47, v11
    v_add3_u32 v12, s45, v11, v14
    v_cmp_eq_u32 vcc, 1, v5
    v_add3_u32 v13, s46, v11, v15
    v_lshlrev_b32 v8, 4, v8
    v_cndmask_b32 v9, v9, v12, vcc
    v_cmp_le_u32 vcc, 2, v5
    v_mov_b32 v10, 1073741824
    s_nop 0
    v_cndmask_b32 v9, v9, v13, vcc
    v_cmp_lt_u32 vcc, 219, v4
    v_add_u32 v9, v9, v8
    s_nop 0
    v_cndmask_b32 v225, v9, v10, vcc
    v_add_u32 v4, s42, v2
    v_add_u32 v4, 96, v4
    v_mul_u32_u24 v5, 911, v4
    v_lshrrev_b32 v5, 16, v5
    v_mul_u32_u24 v6, 72, v5
    v_sub_u32 v6, v4, v6
    v_mul_u32_u24 v7, 3641, v6
    v_lshrrev_b32 v7, 16, v7
    v_mul_u32_u24 v8, 18, v7
    v_sub_u32 v8, v6, v8
    v_cmp_eq_u32 vcc, 3, v5
    v_mov_b32 v9, 18
    v_add_u32 v10, s43, v7
    v_cndmask_b32 v7, v7, v6, vcc
    v_cndmask_b32 v8, v8, v9, vcc
    v_add_u32 v9, s43, v7
    v_mul_lo_u32 v9, s49, v9
    v_add3_u32 v9, s44, v9, v14
    v_add_u32 v11, s48, v7
    v_mul_lo_u32 v11, s47, v11
    v_add3_u32 v12, s45, v11, v14
    v_cmp_eq_u32 vcc, 1, v5
    v_add3_u32 v13, s46, v11, v15
    v_lshlrev_b32 v8, 4, v8
    v_cndmask_b32 v9, v9, v12, vcc
    v_cmp_le_u32 vcc, 2, v5
    v_mov_b32 v10, 1073741824
    s_nop 0
    v_cndmask_b32 v9, v9, v13, vcc
    v_cmp_lt_u32 vcc, 219, v4
    v_add_u32 v9, v9, v8
    s_nop 0
    v_cndmask_b32 v226, v9, v10, vcc
    v_mov_b32 v16, 0
    v_mov_b32 v17, 0
    v_mov_b32 v18, 0
    v_mov_b32 v19, 0
    v_mov_b32 v20, 0
    v_mov_b32 v21, 0
    v_mov_b32 v22, 0
    v_mov_b32 v23, 0
    v_mov_b32 v24, 0
    v_mov_b32 v25, 0
    v_mov_b32 v26, 0
    v_mov_b32 v27, 0
    v_mov_b32 v28, 0
    v_mov_b32 v29, 0
    v_mov_b32 v30, 0
    v_mov_b32 v31, 0
    v_mov_b32 v32, 0
    v_mov_b32 v33, 0
    v_mov_b32 v34, 0
    v_mov_b32 v35, 0
    v_mov_b32 v36, 0
    v_mov_b32 v37, 0
    v_mov_b32 v38, 0
    v_mov_b32 v39, 0
    v_mov_b32 v40, 0
    v_mov_b32 v41, 0
    v_mov_b32 v42, 0
    v_mov_b32 v43, 0
    v_mov_b32 v44, 0
    v_mov_b32 v45, 0
    v_mov_b32 v46, 0
    v_mov_b32 v47, 0
    v_mov_b32 v48, 0
    v_mov_b32 v49, 0
    v_mov_b32 v50, 0
    v_mov_b32 v51, 0
    v_mov_b32 v52, 0
    v_mov_b32 v53, 0
    v_mov_b32 v54, 0
    v_mov_b32 v55, 0
    v_mov_b32 v56, 0
    v_mov_b32 v57, 0
    v_mov_b32 v58, 0
    v_mov_b32 v59, 0
    v_mov_b32 v60, 0
    v_mov_b32 v61, 0
    v_mov_b32 v62, 0
    v_mov_b32 v63, 0
    v_mov_b32 v64, 0
    v_mov_b32 v65, 0
    v_mov_b32 v66, 0
    v_mov_b32 v67, 0
    v_mov_b32 v68, 0
    v_mov_b32 v69, 0
    v_mov_b32 v70, 0
    v_mov_b32 v71, 0
    v_mov_b32 v72, 0
    v_mov_b32 v73, 0
    v_mov_b32 v74, 0
    v_mov_b32 v75, 0
    v_mov_b32 v76, 0
    v_mov_b32 v77, 0
    v_mov_b32 v78, 0
    v_mov_b32 v79, 0
    v_mov_b32 v80, 0
    v_mov_b32 v81, 0
    v_mov_b32 v82, 0
    v_mov_b32 v83, 0
    v_mov_b32 v84, 0
    v_mov_b32 v85, 0
    v_mov_b32 v86, 0
    v_mov_b32 v87, 0
    v_mov_b32 v88, 0
    v_mov_b32 v89, 0
    v_mov_b32 v90, 0
    v_mov_b32 v91, 0
    v_mov_b32 v92, 0
    v_mov_b32 v93, 0
    v_mov_b32 v94, 0
    v_mov_b32 v95, 0
    v_mov_b32 v96, 0
    v_mov_b32 v97, 0
    v_mov_b32 v98, 0
    v_mov_b32 v99, 0
    v_mov_b32 v100, 0
    v_mov_b32 v101, 0
    v_mov_b32 v102, 0
    v_mov_b32 v103, 0
    v_mov_b32 v104, 0
    v_mov_b32 v105, 0
    v_mov_b32 v106, 0
    v_mov_b32 v107, 0
    v_mov_b32 v108, 0
    v_mov_b32 v109, 0
    v_mov_b32 v110, 0
    v_mov_b32 v111, 0
    v_mov_b32 v112, 0
    v_mov_b32 v113, 0
    v_mov_b32 v114, 0
    v_mov_b32 v115, 0
    v_mov_b32 v116, 0
    v_mov_b32 v117, 0
    v_mov_b32 v118, 0
    v_mov_b32 v119, 0
    v_mov_b32 v120, 0
    v_mov_b32 v121, 0
    v_mov_b32 v122, 0
    v_mov_b32 v123, 0
    v_mov_b32 v124, 0
    v_mov_b32 v125, 0
    v_mov_b32 v126, 0
    v_mov_b32 v127, 0
    s_barrier
    ds_read_b128 v[128:131], v216 offset:0
    ds_read_b128 v[132:135], v216 offset:2048
    ds_read_b128 v[136:139], v216 offset:4096
    ds_read_b128 v[140:143], v216 offset:6144
    ds_read_b64_tr_b16 v[144:145], v218 offset:0
    ds_read_b64_tr_b16 v[146:147], v218 offset:1792
    ds_read_b64_tr_b16 v[148:149], v219 offset:32
    ds_read_b64_tr_b16 v[150:151], v219 offset:1824
    ds_read_b64_tr_b16 v[152:153], v218 offset:64
    ds_read_b64_tr_b16 v[154:155], v218 offset:1856
    ds_read_b64_tr_b16 v[156:157], v219 offset:96
    ds_read_b64_tr_b16 v[158:159], v219 offset:1888
    ds_read_b64_tr_b16 v[160:161], v218 offset:128
    ds_read_b64_tr_b16 v[162:163], v218 offset:1920
    ds_read_b64_tr_b16 v[164:165], v219 offset:160
    ds_read_b64_tr_b16 v[166:167], v219 offset:1952
    ds_read_b64_tr_b16 v[168:169], v218 offset:192
    ds_read_b64_tr_b16 v[170:171], v218 offset:1984
    s_mov_b32 s35, 0
P1_loop:
    s_waitcnt lgkmcnt(0)
    v_mfma_f32_16x16x32_bf16 v[16:19], v[128:131], v[144:147], v[16:19]
    ds_read_b128 v[172:175], v217 offset:0
    v_mfma_f32_16x16x32_bf16 v[44:47], v[132:135], v[144:147], v[44:47]
    ds_read_b128 v[176:179], v217 offset:2048
    v_mfma_f32_16x16x32_bf16 v[72:75], v[136:139], v[144:147], v[72:75]
    ds_read_b128 v[180:183], v217 offset:4096
    v_mfma_f32_16x16x32_bf16 v[100:103], v[140:143], v[144:147], v[100:103]
    ds_read_b128 v[184:187], v217 offset:6144
    v_mfma_f32_16x16x32_bf16 v[20:23], v[128:131], v[148:151], v[20:23]
    ds_read_b64_tr_b16 v[188:189], v218 offset:14336
    v_mfma_f32_16x16x32_bf16 v[48:51], v[132:135], v[148:151], v[48:51]
    ds_read_b64_tr_b16 v[190:191], v218 offset:16128
    v_mfma_f32_16x16x32_bf16 v[76:79], v[136:139], v[148:151], v[76:79]
    ds_read_b64_tr_b16 v[192:193], v219 offset:14368
    v_mfma_f32_16x16x32_bf16 v[104:107], v[140:143], v[148:151], v[104:107]
    ds_read_b64_tr_b16 v[194:195], v219 offset:16160
    v_mfma_f32_16x16x32_bf16 v[24:27], v[128:131], v[152:155], v[24:27]
    ds_read_b64_tr_b16 v[196:197], v218 offset:14400
    v_mfma_f32_16x16x32_bf16 v[52:55], v[132:135], v[152:155], v[52:55]
    ds_read_b64_tr_b16 v[198:199], v218 offset:16192
    v_mfma_f32_16x16x32_bf16 v[80:83], v[136:139], v[152:155], v[80:83]
    ds_read_b64_tr_b16 v[200:201], v219 offset:14432
    v_mfma_f32_16x16x32_bf16 v[108:111], v[140:143], v[152:155], v[108:111]
    ds_read_b64_tr_b16 v[202:203], v219 offset:16224
    v_mfma_f32_16x16x32_bf16 v[28:31], v[128:131], v[156:159], v[28:31]
    ds_read_b64_tr_b16 v[204:205], v218 offset:14464
    v_mfma_f32_16x16x32_bf16 v[56:59], v[132:135], v[156:159], v[56:59]
    ds_read_b64_tr_b16 v[206:207], v218 offset:16256
    v_mfma_f32_16x16x32_bf16 v[84:87], v[136:139], v[156:159], v[84:87]
    ds_read_b64_tr_b16 v[208:209], v219 offset:14496
    v_mfma_f32_16x16x32_bf16 v[112:115], v[140:143], v[156:159], v[112:115]
    ds_read_b64_tr_b16 v[210:211], v219 offset:16288
    v_mfma_f32_16x16x32_bf16 v[32:35], v[128:131], v[160:163], v[32:35]
    ds_read_b64_tr_b16 v[212:213], v218 offset:14528
    v_mfma_f32_16x16x32_bf16 v[60:63], v[132:135], v[160:163], v[60:63]
    ds_read_b64_tr_b16 v[214:215], v218 offset:16320
    v_mfma_f32_16x16x32_bf16 v[88:91], v[136:139], v[160:163], v[88:91]
    s_and_b32 s34, s35, 3
    v_mfma_f32_16x16x32_bf16 v[116:119], v[140:143], v[160:163], v[116:119]
    s_cmp_eq_u32 s34, s3
    v_mfma_f32_16x16x32_bf16 v[36:39], v[128:131], v[164:167], v[36:39]
    s_cselect_b32 s40, 0, 9
    v_mfma_f32_16x16x32_bf16 v[64:67], v[132:135], v[164:167], v[64:67]
    s_add_u32 s40, s40, s35
    v_mfma_f32_16x16x32_bf16 v[92:95], v[136:139], v[164:167], v[92:95]
    s_add_u32 s34, s35, 4
    v_mfma_f32_16x16x32_bf16 v[120:123], v[140:143], v[164:167], v[120:123]
    s_lshl_b32 s34, s34, 7
    v_mfma_f32_16x16x32_bf16 v[40:43], v[128:131], v[168:171], v[40:43]
    s_cmp_le_u32 s40, 4
    v_mfma_f32_16x16x32_bf16 v[68:71], v[132:135], v[168:171], v[68:71]
    s_cselect_b32 s34, s34, 1073741824
    v_mfma_f32_16x16x32_bf16 v[96:99], v[136:139], v[168:171], v[96:99]
    buffer_load_dword v245, v244, s[12:15], s34 offen
    v_mfma_f32_16x16x32_bf16 v[124:127], v[140:143], v[168:171], v[124:127]
    s_add_u32 s35, s35, 1
    v_add_u32 v216, 45056, v216
    v_add_u32 v217, 45056, v217
    v_add_u32 v218, 45056, v218
    v_add_u32 v219, 45056, v219
    s_waitcnt lgkmcnt(0)
    s_barrier
    v_mfma_f32_16x16x32_bf16 v[16:19], v[172:175], v[188:191], v[16:19]
    ds_read_b128 v[128:131], v216 offset:0
    v_mfma_f32_16x16x32_bf16 v[44:47], v[176:179], v[188:191], v[44:47]
    ds_read_b128 v[132:135], v216 offset:2048
    v_mfma_f32_16x16x32_bf16 v[72:75], v[180:183], v[188:191], v[72:75]
    ds_read_b128 v[136:139], v216 offset:4096
    v_mfma_f32_16x16x32_bf16 v[100:103], v[184:187], v[188:191], v[100:103]
    ds_read_b128 v[140:143], v216 offset:6144
    v_mfma_f32_16x16x32_bf16 v[20:23], v[172:175], v[192:195], v[20:23]
    ds_read_b64_tr_b16 v[144:145], v218 offset:0
    v_mfma_f32_16x16x32_bf16 v[48:51], v[176:179], v[192:195], v[48:51]
    ds_read_b64_tr_b16 v[146:147], v218 offset:1792
    v_mfma_f32_16x16x32_bf16 v[76:79], v[180:183], v[192:195], v[76:79]
    ds_read_b64_tr_b16 v[148:149], v219 offset:32
    v_mfma_f32_16x16x32_bf16 v[104:107], v[184:187], v[192:195], v[104:107]
    ds_read_b64_tr_b16 v[150:151], v219 offset:1824
    v_mfma_f32_16x16x32_bf16 v[24:27], v[172:175], v[196:199], v[24:27]
    ds_read_b64_tr_b16 v[152:153], v218 offset:64
    v_mfma_f32_16x16x32_bf16 v[52:55], v[176:179], v[196:199], v[52:55]
    ds_read_b64_tr_b16 v[154:155], v218 offset:1856
    v_mfma_f32_16x16x32_bf16 v[80:83], v[180:183], v[196:199], v[80:83]
    ds_read_b64_tr_b16 v[156:157], v219 offset:96
    v_mfma_f32_16x16x32_bf16 v[108:111], v[184:187], v[196:199], v[108:111]
    ds_read_b64_tr_b16 v[158:159], v219 offset:1888
    v_mfma_f32_16x16x32_bf16 v[28:31], v[172:175], v[200:203], v[28:31]
    ds_read_b64_tr_b16 v[160:161], v218 offset:128
    v_mfma_f32_16x16x32_bf16 v[56:59], v[176:179], v[200:203], v[56:59]
    ds_read_b64_tr_b16 v[162:163], v218 offset:1920
    v_mfma_f32_16x16x32_bf16 v[84:87], v[180:183], v[200:203], v[84:87]
    ds_read_b64_tr_b16 v[164:165], v219 offset:160
    v_mfma_f32_16x16x32_bf16 v[112:115], v[184:187], v[200:203], v[112:115]
    ds_read_b64_tr_b16 v[166:167], v219 offset:1952
    v_mfma_f32_16x16x32_bf16 v[32:35], v[172:175], v[204:207], v[32:35]
    ds_read_b64_tr_b16 v[168:169], v218 offset:192
    v_mfma_f32_16x16x32_bf16 v[60:63], v[176:179], v[204:207], v[60:63]
    ds_read_b64_tr_b16 v[170:171], v218 offset:1984
    v_mfma_f32_16x16x32_bf16 v[88:91], v[180:183], v[204:207], v[88:91]
    v_mfma_f32_16x16x32_bf16 v[116:119], v[184:187], v[204:207], v[116:119]
    v_mfma_f32_16x16x32_bf16 v[36:39], v[172:175], v[208:211], v[36:39]
    v_mfma_f32_16x16x32_bf16 v[64:67], v[176:179], v[208:211], v[64:67]
    v_mfma_f32_16x16x32_bf16 v[92:95], v[180:183], v[208:211], v[92:95]
    v_mfma_f32_16x16x32_bf16 v[120:123], v[184:187], v[208:211], v[120:123]
    v_mfma_f32_16x16x32_bf16 v[40:43], v[172:175], v[212:215], v[40:43]
    v_mfma_f32_16x16x32_bf16 v[68:71], v[176:179], v[212:215], v[68:71]
    v_mfma_f32_16x16x32_bf16 v[96:99], v[180:183], v[212:215], v[96:99]
    v_mfma_f32_16x16x32_bf16 v[124:127], v[184:187], v[212:215], v[124:127]
    s_waitcnt lgkmcnt(0)
    v_mfma_f32_16x16x32_bf16 v[16:19], v[128:131], v[144:147], v[16:19]
    ds_read_b128 v[172:175], v217 offset:0
    v_mfma_f32_16x16x32_bf16 v[44:47], v[132:135], v[144:147], v[44:47]
    ds_read_b128 v[176:179], v217 offset:2048
    v_mfma_f32_16x16x32_bf16 v[72:75], v[136:139], v[144:147], v[72:75]
    ds_read_b128 v[180:183], v217 offset:4096
    v_mfma_f32_16x16x32_bf16 v[100:103], v[140:143], v[144:147], v[100:103]
    ds_read_b128 v[184:187], v217 offset:6144
    v_mfma_f32_16x16x32_bf16 v[20:23], v[128:131], v[148:151], v[20:23]
    ds_read_b64_tr_b16 v[188:189], v218 offset:14336
    v_mfma_f32_16x16x32_bf16 v[48:51], v[132:135], v[148:151], v[48:51]
    ds_read_b64_tr_b16 v[190:191], v218 offset:16128
    v_mfma_f32_16x16x32_bf16 v[76:79], v[136:139], v[148:151], v[76:79]
    ds_read_b64_tr_b16 v[192:193], v219 offset:14368
    v_mfma_f32_16x16x32_bf16 v[104:107], v[140:143], v[148:151], v[104:107]
    ds_read_b64_tr_b16 v[194:195], v219 offset:16160
    v_mfma_f32_16x16x32_bf16 v[24:27], v[128:131], v[152:155], v[24:27]
    ds_read_b64_tr_b16 v[196:197], v218 offset:14400
    v_mfma_f32_16x16x32_bf16 v[52:55], v[132:135], v[152:155], v[52:55]
    ds_read_b64_tr_b16 v[198:199], v218 offset:16192
    v_mfma_f32_16x16x32_bf16 v[80:83], v[136:139], v[152:155], v[80:83]
    ds_read_b64_tr_b16 v[200:201], v219 offset:14432
    v_mfma_f32_16x16x32_bf16 v[108:111], v[140:143], v[152:155], v[108:111]
    ds_read_b64_tr_b16 v[202:203], v219 offset:16224
    v_mfma_f32_16x16x32_bf16 v[28:31], v[128:131], v[156:159], v[28:31]
    ds_read_b64_tr_b16 v[204:205], v218 offset:14464
    v_mfma_f32_16x16x32_bf16 v[56:59], v[132:135], v[156:159], v[56:59]
    ds_read_b64_tr_b16 v[206:207], v218 offset:16256
    v_mfma_f32_16x16x32_bf16 v[84:87], v[136:139], v[156:159], v[84:87]
    ds_read_b64_tr_b16 v[208:209], v219 offset:14496
    v_mfma_f32_16x16x32_bf16 v[112:115], v[140:143], v[156:159], v[112:115]
    ds_read_b64_tr_b16 v[210:211], v219 offset:16288
    v_mfma_f32_16x16x32_bf16 v[32:35], v[128:131], v[160:163], v[32:35]
    ds_read_b64_tr_b16 v[212:213], v218 offset:14528
    v_mfma_f32_16x16x32_bf16 v[60:63], v[132:135], v[160:163], v[60:63]
    ds_read_b64_tr_b16 v[214:215], v218 offset:16320
    v_mfma_f32_16x16x32_bf16 v[88:91], v[136:139], v[160:163], v[88:91]
    s_and_b32 s34, s35, 3
    v_mfma_f32_16x16x32_bf16 v[116:119], v[140:143], v[160:163], v[116:119]
    s_cmp_eq_u32 s34, s3
    v_mfma_f32_16x16x32_bf16 v[36:39], v[128:131], v[164:167], v[36:39]
    s_cselect_b32 s40, 0, 9
    v_mfma_f32_16x16x32_bf16 v[64:67], v[132:135], v[164:167], v[64:67]
    s_add_u32 s40, s40, s35
    v_mfma_f32_16x16x32_bf16 v[92:95], v[136:139], v[164:167], v[92:95]
    s_add_u32 s34, s35, 4
    v_mfma_f32_16x16x32_bf16 v[120:123], v[140:143], v[164:167], v[120:123]
    s_lshl_b32 s34, s34, 7
    v_mfma_f32_16x16x32_bf16 v[40:43], v[128:131], v[168:171], v[40:43]
    s_cmp_le_u32 s40, 4
    v_mfma_f32_16x16x32_bf16 v[68:71], v[132:135], v[168:171], v[68:71]
    s_cselect_b32 s34, s34, 1073741824
    v_mfma_f32_16x16x32_bf16 v[96:99], v[136:139], v[168:171], v[96:99]
    buffer_load_dword v245, v244, s[12:15], s34 offen
    v_mfma_f32_16x16x32_bf16 v[124:127], v[140:143], v[168:171], v[124:127]
    s_add_u32 s35, s35, 1
    v_add_u32 v216, 45056, v216
    v_add_u32 v217, 45056, v217
    v_add_u32 v218, 45056, v218
    v_add_u32 v219, 45056, v219
    s_waitcnt lgkmcnt(0)
    s_barrier
    v_mfma_f32_16x16x32_bf16 v[16:19], v[172:175], v[188:191], v[16:19]
    ds_read_b128 v[128:131], v216 offset:0
    v_mfma_f32_16x16x32_bf16 v[44:47], v[176:179], v[188:191], v[44:47]
    ds_read_b128 v[132:135], v216 offset:2048
    v_mfma_f32_16x16x32_bf16 v[72:75], v[180:183], v[188:191], v[72:75]
    ds_read_b128 v[136:139], v216 offset:4096
    v_mfma_f32_16x16x32_bf16 v[100:103], v[184:187], v[188:191], v[100:103]
    ds_read_b128 v[140:143], v216 offset:6144
    v_mfma_f32_16x16x32_bf16 v[20:23], v[172:175], v[192:195], v[20:23]
    ds_read_b64_tr_b16 v[144:145], v218 offset:0
    v_mfma_f32_16x16x32_bf16 v[48:51], v[176:179], v[192:195], v[48:51]
    ds_read_b64_tr_b16 v[146:147], v218 offset:1792
    v_mfma_f32_16x16x32_bf16 v[76:79], v[180:183], v[192:195], v[76:79]
    ds_read_b64_tr_b16 v[148:149], v219 offset:32
    v_mfma_f32_16x16x32_bf16 v[104:107], v[184:187], v[192:195], v[104:107]
    ds_read_b64_tr_b16 v[150:151], v219 offset:1824
    v_mfma_f32_16x16x32_bf16 v[24:27], v[172:175], v[196:199], v[24:27]
    ds_read_b64_tr_b16 v[152:153], v218 offset:64
    v_mfma_f32_16x16x32_bf16 v[52:55], v[176:179], v[196:199], v[52:55]
    ds_read_b64_tr_b16 v[154:155], v218 offset:1856
    v_mfma_f32_16x16x32_bf16 v[80:83], v[180:183], v[196:199], v[80:83]
    ds_read_b64_tr_b16 v[156:157], v219 offset:96
    v_mfma_f32_16x16x32_bf16 v[108:111], v[184:187], v[196:199], v[108:111]
    ds_read_b64_tr_b16 v[158:159], v219 offset:1888
    v_mfma_f32_16x16x32_bf16 v[28:31], v[172:175], v[200:203], v[28:31]
    ds_read_b64_tr_b16 v[160:161], v218 offset:128
    v_mfma_f32_16x16x32_bf16 v[56:59], v[176:179], v[200:203], v[56:59]
    ds_read_b64_tr_b16 v[162:163], v218 offset:1920
    v_mfma_f32_16x16x32_bf16 v[84:87], v[180:183], v[200:203], v[84:87]
    ds_read_b64_tr_b16 v[164:165], v219 offset:160
    v_mfma_f32_16x16x32_bf16 v[112:115], v[184:187], v[200:203], v[112:115]
    ds_read_b64_tr_b16 v[166:167], v219 offset:1952
    v_mfma_f32_16x16x32_bf16 v[32:35], v[172:175], v[204:207], v[32:35]
    ds_read_b64_tr_b16 v[168:169], v218 offset:192
    v_mfma_f32_16x16x32_bf16 v[60:63], v[176:179], v[204:207], v[60:63]
    ds_read_b64_tr_b16 v[170:171], v218 offset:1984
    v_mfma_f32_16x16x32_bf16 v[88:91], v[180:183], v[204:207], v[88:91]
    v_mfma_f32_16x16x32_bf16 v[116:119], v[184:187], v[204:207], v[116:119]
    v_mfma_f32_16x16x32_bf16 v[36:39], v[172:175], v[208:211], v[36:39]
    v_mfma_f32_16x16x32_bf16 v[64:67], v[176:179], v[208:211], v[64:67]
    v_mfma_f32_16x16x32_bf16 v[92:95], v[180:183], v[208:211], v[92:95]
    v_mfma_f32_16x16x32_bf16 v[120:123], v[184:187], v[208:211], v[120:123]
    v_mfma_f32_16x16x32_bf16 v[40:43], v[172:175], v[212:215], v[40:43]
    v_mfma_f32_16x16x32_bf16 v[68:71], v[176:179], v[212:215], v[68:71]
    v_mfma_f32_16x16x32_bf16 v[96:99], v[180:183], v[212:215], v[96:99]
    v_mfma_f32_16x16x32_bf16 v[124:127], v[184:187], v[212:215], v[124:127]
    s_waitcnt lgkmcnt(0)
    v_mfma_f32_16x16x32_bf16 v[16:19], v[128:131], v[144:147], v[16:19]
    ds_read_b128 v[172:175], v217 offset:0
    v_mfma_f32_16x16x32_bf16 v[44:47], v[132:135], v[144:147], v[44:47]
    ds_read_b128 v[176:179], v217 offset:2048
    v_mfma_f32_16x16x32_bf16 v[72:75], v[136:139], v[144:147], v[72:75]
    ds_read_b128 v[180:183], v217 offset:4096
    v_mfma_f32_16x16x32_bf16 v[100:103], v[140:143], v[144:147], v[100:103]
    ds_read_b128 v[184:187], v217 offset:6144
    v_mfma_f32_16x16x32_bf16 v[20:23], v[128:131], v[148:151], v[20:23]
    ds_read_b64_tr_b16 v[188:189], v218 offset:14336
    v_mfma_f32_16x16x32_bf16 v[48:51], v[132:135], v[148:151], v[48:51]
    ds_read_b64_tr_b16 v[190:191], v218 offset:16128
    v_mfma_f32_16x16x32_bf16 v[76:79], v[136:139], v[148:151], v[76:79]
    ds_read_b64_tr_b16 v[192:193], v219 offset:14368
    v_mfma_f32_16x16x32_bf16 v[104:107], v[140:143], v[148:151], v[104:107]
    ds_read_b64_tr_b16 v[194:195], v219 offset:16160
    v_mfma_f32_16x16x32_bf16 v[24:27], v[128:131], v[152:155], v[24:27]
    ds_read_b64_tr_b16 v[196:197], v218 offset:14400
    v_mfma_f32_16x16x32_bf16 v[52:55], v[132:135], v[152:155], v[52:55]
    ds_read_b64_tr_b16 v[198:199], v218 offset:16192
    v_mfma_f32_16x16x32_bf16 v[80:83], v[136:139], v[152:155], v[80:83]
    ds_read_b64_tr_b16 v[200:201], v219 offset:14432
    v_mfma_f32_16x16x32_bf16 v[108:111], v[140:143], v[152:155], v[108:111]
    ds_read_b64_tr_b16 v[202:203], v219 offset:16224
    v_mfma_f32_16x16x32_bf16 v[28:31], v[128:131], v[156:159], v[28:31]
    ds_read_b64_tr_b16 v[204:205], v218 offset:14464
    v_mfma_f32_16x16x32_bf16 v[56:59], v[132:135], v[156:159], v[56:59]
    ds_read_b64_tr_b16 v[206:207], v218 offset:16256
    v_mfma_f32_16x16x32_bf16 v[84:87], v[136:139], v[156:159], v[84:87]
    ds_read_b64_tr_b16 v[208:209], v219 offset:14496
    v_mfma_f32_16x16x32_bf16 v[112:115], v[140:143], v[156:159], v[112:115]
    ds_read_b64_tr_b16 v[210:211], v219 offset:16288
    v_mfma_f32_16x16x32_bf16 v[32:35], v[128:131], v[160:163], v[32:35]
    ds_read_b64_tr_b16 v[212:213], v218 offset:14528
    v_mfma_f32_16x16x32_bf16 v[60:63], v[132:135], v[160:163], v[60:63]
    ds_read_b64_tr_b16 v[214:215], v218 offset:16320
    v_mfma_f32_16x16x32_bf16 v[88:91], v[136:139], v[160:163], v[88:91]
    s_and_b32 s34, s35, 3
    v_mfma_f32_16x16x32_bf16 v[116:119], v[140:143], v[160:163], v[116:119]
    s_cmp_eq_u32 s34, s3
    v_mfma_f32_16x16x32_bf16 v[36:39], v[128:131], v[164:167], v[36:39]
    s_cselect_b32 s40, 0, 9
    v_mfma_f32_16x16x32_bf16 v[64:67], v[132:135], v[164:167], v[64:67]
    s_add_u32 s40, s40, s35
    v_mfma_f32_16x16x32_bf16 v[92:95], v[136:139], v[164:167], v[92:95]
    s_add_u32 s34, s35, 4
    v_mfma_f32_16x16x32_bf16 v[120:123], v[140:143], v[164:167], v[120:123]
    s_lshl_b32 s34, s34, 7
    v_mfma_f32_16x16x32_bf16 v[40:43], v[128:131], v[168:171], v[40:43]
    s_cmp_le_u32 s40, 4
    v_mfma_f32_16x16x32_bf16 v[68:71], v[132:135], v[168:171], v[68:71]
    s_cselect_b32 s34, s34, 1073741824
    v_mfma_f32_16x16x32_bf16 v[96:99], v[136:139], v[168:171], v[96:99]
    buffer_load_dword v245, v244, s[12:15], s34 offen
    v_mfma_f32_16x16x32_bf16 v[124:127], v[140:143], v[168:171], v[124:127]
    s_add_u32 s35, s35, 1
    v_add_u32 v216, 4294877184, v216
    v_add_u32 v217, 4294877184, v217
    v_add_u32 v218, 4294877184, v218
    v_add_u32 v219, 4294877184, v219
    s_waitcnt lgkmcnt(0)
    s_barrier
    v_mfma_f32_16x16x32_bf16 v[16:19], v[172:175], v[188:191], v[16:19]
    ds_read_b128 v[128:131], v216 offset:0
    v_mfma_f32_16x16x32_bf16 v[44:47], v[176:179], v[188:191], v[44:47]
    ds_read_b128 v[132:135], v216 offset:2048
    v_mfma_f32_16x16x32_bf16 v[72:75], v[180:183], v[188:191], v[72:75]
    ds_read_b128 v[136:139], v216 offset:4096
    v_mfma_f32_16x16x32_bf16 v[100:103], v[184:187], v[188:191], v[100:103]
    ds_read_b128 v[140:143], v216 offset:6144
    v_mfma_f32_16x16x32_bf16 v[20:23], v[172:175], v[192:195], v[20:23]
    ds_read_b64_tr_b16 v[144:145], v218 offset:0
    v_mfma_f32_16x16x32_bf16 v[48:51], v[176:179], v[192:195], v[48:51]
    ds_read_b64_tr_b16 v[146:147], v218 offset:1792
    v_mfma_f32_16x16x32_bf16 v[76:79], v[180:183], v[192:195], v[76:79]
    ds_read_b64_tr_b16 v[148:149], v219 offset:32
    v_mfma_f32_16x16x32_bf16 v[104:107], v[184:187], v[192:195], v[104:107]
    ds_read_b64_tr_b16 v[150:151], v219 offset:1824
    v_mfma_f32_16x16x32_bf16 v[24:27], v[172:175], v[196:199], v[24:27]
    ds_read_b64_tr_b16 v[152:153], v218 offset:64
    v_mfma_f32_16x16x32_bf16 v[52:55], v[176:179], v[196:199], v[52:55]
    ds_read_b64_tr_b16 v[154:155], v218 offset:1856
    v_mfma_f32_16x16x32_bf16 v[80:83], v[180:183], v[196:199], v[80:83]
    ds_read_b64_tr_b16 v[156:157], v219 offset:96
    v_mfma_f32_16x16x32_bf16 v[108:111], v[184:187], v[196:199], v[108:111]
    ds_read_b64_tr_b16 v[158:159], v219 offset:1888
    v_mfma_f32_16x16x32_bf16 v[28:31], v[172:175], v[200:203], v[28:31]
    ds_read_b64_tr_b16 v[160:161], v218 offset:128
    v_mfma_f32_16x16x32_bf16 v[56:59], v[176:179], v[200:203], v[56:59]
    ds_read_b64_tr_b16 v[162:163], v218 offset:1920
    v_mfma_f32_16x16x32_bf16 v[84:87], v[180:183], v[200:203], v[84:87]
    ds_read_b64_tr_b16 v[164:165], v219 offset:160
    v_mfma_f32_16x16x32_bf16 v[112:115], v[184:187], v[200:203], v[112:115]
    ds_read_b64_tr_b16 v[166:167], v219 offset:1952
    v_mfma_f32_16x16x32_bf16 v[32:35], v[172:175], v[204:207], v[32:35]
    ds_read_b64_tr_b16 v[168:169], v218 offset:192
    v_mfma_f32_16x16x32_bf16 v[60:63], v[176:179], v[204:207], v[60:63]
    ds_read_b64_tr_b16 v[170:171], v218 offset:1984
    v_mfma_f32_16x16x32_bf16 v[88:91], v[180:183], v[204:207], v[88:91]
    v_mfma_f32_16x16x32_bf16 v[116:119], v[184:187], v[204:207], v[116:119]
    v_mfma_f32_16x16x32_bf16 v[36:39], v[172:175], v[208:211], v[36:39]
    v_mfma_f32_16x16x32_bf16 v[64:67], v[176:179], v[208:211], v[64:67]
    v_mfma_f32_16x16x32_bf16 v[92:95], v[180:183], v[208:211], v[92:95]
    v_mfma_f32_16x16x32_bf16 v[120:123], v[184:187], v[208:211], v[120:123]
    v_mfma_f32_16x16x32_bf16 v[40:43], v[172:175], v[212:215], v[40:43]
    v_mfma_f32_16x16x32_bf16 v[68:71], v[176:179], v[212:215], v[68:71]
    v_mfma_f32_16x16x32_bf16 v[96:99], v[180:183], v[212:215], v[96:99]
    v_mfma_f32_16x16x32_bf16 v[124:127], v[184:187], v[212:215], v[124:127]
    s_cmp_lt_u32 s35, 9
    s_cbranch_scc1 P1_loop
    s_waitcnt lgkmcnt(0)
    s_nop 7
    v_mov_b32 v4, 163812
    ds_read_b32 v5, v4
    s_waitcnt lgkmcnt(0)
    v_readfirstlane_b32 s40, v5
    s_cmp_eq_u32 s40, 1
    s_cbranch_scc1 P1_epi_local
    s_cmp_eq_u32 s31, 0
    s_cbranch_scc1 P1_epiAg
    s_mov_b32 s54, 0x3eae1a93
    s_mov_b32 s55, 0x3eae1a93
    s_cmp_eq_u32 s39, 0
    s_cbranch_scc0 P1_epiB1g
    v_cmp_gt_u32 vcc, 8, v2
    v_mov_b32 v4, 1.0
    v_mov_b32 v5, s54
    v_cndmask_b32 v4, v4, v5, vcc
    v_mov_b32 v5, v4
    v_pk_mul_f32 v[16:17], v[16:17], s[54:55]
    v_pk_mul_f32 v[18:19], v[18:19], s[54:55]
    v_pk_mul_f32 v[44:45], v[44:45], s[54:55]
    v_pk_mul_f32 v[46:47], v[46:47], s[54:55]
    v_cvt_pk_bf16_f32 v228, v16, v17
    v_cvt_pk_bf16_f32 v229, v18, v19
    v_cvt_pk_bf16_f32 v230, v44, v45
    v_cvt_pk_bf16_f32 v231, v46, v47
    buffer_store_dwordx4 v[228:231], v220, s[8:11], 0 offen offset:0 sc1
    v_pk_mul_f32 v[72:73], v[72:73], s[54:55]
    v_pk_mul_f32 v[74:75], v[74:75], s[54:55]
    v_pk_mul_f32 v[100:101], v[100:101], s[54:55]
    v_pk_mul_f32 v[102:103], v[102:103], s[54:55]
    v_cvt_pk_bf16_f32 v232, v72, v73
    v_cvt_pk_bf16_f32 v233, v74, v75
    v_cvt_pk_bf16_f32 v234, v100, v101
    v_cvt_pk_bf16_f32 v235, v102, v103
    buffer_store_dwordx4 v[232:235], v220, s[8:11], 0 offen offset:1152 sc1
    v_pk_mul_f32 v[20:21], v[20:21], s[54:55]
    v_pk_mul_f32 v[22:23], v[22:23], s[54:55]
    v_pk_mul_f32 v[48:49], v[48:49], s[54:55]
    v_pk_mul_f32 v[50:51], v[50:51], s[54:55]
    v_cvt_pk_bf16_f32 v236, v20, v21
    v_cvt_pk_bf16_f32 v237, v22, v23
    v_cvt_pk_bf16_f32 v238, v48, v49
    v_cvt_pk_bf16_f32 v239, v50, v51
    buffer_store_dwordx4 v[236:239], v221, s[8:11], 0 offen offset:0 sc1
    v_pk_mul_f32 v[76:77], v[76:77], s[54:55]
    v_pk_mul_f32 v[78:79], v[78:79], s[54:55]
    v_pk_mul_f32 v[104:105], v[104:105], s[54:55]
    v_pk_mul_f32 v[106:107], v[106:107], s[54:55]
    v_cvt_pk_bf16_f32 v240, v76, v77
    v_cvt_pk_bf16_f32 v241, v78, v79
    v_cvt_pk_bf16_f32 v242, v104, v105
    v_cvt_pk_bf16_f32 v243, v106, v107
    buffer_store_dwordx4 v[240:243], v221, s[8:11], 0 offen offset:1152 sc1
    v_pk_mul_f32 v[24:25], v[24:25], s[54:55]
    v_pk_mul_f32 v[26:27], v[26:27], s[54:55]
    v_pk_mul_f32 v[52:53], v[52:53], s[54:55]
    v_pk_mul_f32 v[54:55], v[54:55], s[54:55]
    v_cvt_pk_bf16_f32 v228, v24, v25
    v_cvt_pk_bf16_f32 v229, v26, v27
    v_cvt_pk_bf16_f32 v230, v52, v53
    v_cvt_pk_bf16_f32 v231, v54, v55
    buffer_store_dwordx4 v[228:231], v222, s[8:11], 0 offen offset:0 sc1
    v_pk_mul_f32 v[80:81], v[80:81], s[54:55]
    v_pk_mul_f32 v[82:83], v[82:83], s[54:55]
    v_pk_mul_f32 v[108:109], v[108:109], s[54:55]
    v_pk_mul_f32 v[110:111], v[110:111], s[54:55]
    v_cvt_pk_bf16_f32 v232, v80, v81
    v_cvt_pk_bf16_f32 v233, v82, v83
    v_cvt_pk_bf16_f32 v234, v108, v109
    v_cvt_pk_bf16_f32 v235, v110, v111
    buffer_store_dwordx4 v[232:235], v222, s[8:11], 0 offen offset:1152 sc1
    v_pk_mul_f32 v[28:29], v[28:29], s[54:55]
    v_pk_mul_f32 v[30:31], v[30:31], s[54:55]
    v_pk_mul_f32 v[56:57], v[56:57], s[54:55]
    v_pk_mul_f32 v[58:59], v[58:59], s[54:55]
    v_cvt_pk_bf16_f32 v236, v28, v29
    v_cvt_pk_bf16_f32 v237, v30, v31
    v_cvt_pk_bf16_f32 v238, v56, v57
    v_cvt_pk_bf16_f32 v239, v58, v59
    buffer_store_dwordx4 v[236:239], v223, s[8:11], 0 offen offset:0 sc1
    v_pk_mul_f32 v[84:85], v[84:85], s[54:55]
    v_pk_mul_f32 v[86:87], v[86:87], s[54:55]
    v_pk_mul_f32 v[112:113], v[112:113], s[54:55]
    v_pk_mul_f32 v[114:115], v[114:115], s[54:55]
    v_cvt_pk_bf16_f32 v240, v84, v85
    v_cvt_pk_bf16_f32 v241, v86, v87
    v_cvt_pk_bf16_f32 v242, v112, v113
    v_cvt_pk_bf16_f32 v243, v114, v115
    buffer_store_dwordx4 v[240:243], v223, s[8:11], 0 offen offset:1152 sc1
    v_pk_mul_f32 v[32:33], v[32:33], v[4:5]
    v_pk_mul_f32 v[34:35], v[34:35], v[4:5]
    v_pk_mul_f32 v[60:61], v[60:61], v[4:5]
    v_pk_mul_f32 v[62:63], v[62:63], v[4:5]
    v_cvt_pk_bf16_f32 v228, v32, v33
    v_cvt_pk_bf16_f32 v229, v34, v35
    v_cvt_pk_bf16_f32 v230, v60, v61
    v_cvt_pk_bf16_f32 v231, v62, v63
    buffer_store_dwordx4 v[228:231], v224, s[8:11], 0 offen offset:0 sc1
    v_pk_mul_f32 v[88:89], v[88:89], v[4:5]
    v_pk_mul_f32 v[90:91], v[90:91], v[4:5]
    v_pk_mul_f32 v[116:117], v[116:117], v[4:5]
    v_pk_mul_f32 v[118:119], v[118:119], v[4:5]
    v_cvt_pk_bf16_f32 v232, v88, v89
    v_cvt_pk_bf16_f32 v233, v90, v91
    v_cvt_pk_bf16_f32 v234, v116, v117
    v_cvt_pk_bf16_f32 v235, v118, v119
    buffer_store_dwordx4 v[232:235], v224, s[8:11], 0 offen offset:1152 sc1
    v_cvt_pk_bf16_f32 v236, v36, v37
    v_cvt_pk_bf16_f32 v237, v38, v39
    v_cvt_pk_bf16_f32 v238, v64, v65
    v_cvt_pk_bf16_f32 v239, v66, v67
    buffer_store_dwordx4 v[236:239], v225, s[8:11], 0 offen offset:0 sc1
    v_cvt_pk_bf16_f32 v240, v92, v93
    v_cvt_pk_bf16_f32 v241, v94, v95
    v_cvt_pk_bf16_f32 v242, v120, v121
    v_cvt_pk_bf16_f32 v243, v122, v123
    buffer_store_dwordx4 v[240:243], v225, s[8:11], 0 offen offset:1152 sc1
    v_cvt_pk_bf16_f32 v228, v40, v41
    v_cvt_pk_bf16_f32 v229, v42, v43
    v_cvt_pk_bf16_f32 v230, v68, v69
    v_cvt_pk_bf16_f32 v231, v70, v71
    buffer_store_dwordx4 v[228:231], v226, s[8:11], 0 offen offset:0 sc1
    v_cvt_pk_bf16_f32 v232, v96, v97
    v_cvt_pk_bf16_f32 v233, v98, v99
    v_cvt_pk_bf16_f32 v234, v124, v125
    v_cvt_pk_bf16_f32 v235, v126, v127
    buffer_store_dwordx4 v[232:235], v226, s[8:11], 0 offen offset:1152 sc1
    s_barrier
    s_branch P1_fin
P1_epiB1g:
    v_cmp_le_u32 vcc, 8, v2
    v_mov_b32 v6, 0x3f803f80
    v_cvt_pk_bf16_f32 v236, v16, v17
    v_cvt_pk_bf16_f32 v237, v18, v19
    v_cvt_pk_bf16_f32 v238, v44, v45
    v_cvt_pk_bf16_f32 v239, v46, v47
    buffer_store_dwordx4 v[236:239], v220, s[8:11], 0 offen offset:0 sc1
    v_cvt_pk_bf16_f32 v240, v72, v73
    v_cvt_pk_bf16_f32 v241, v74, v75
    v_cvt_pk_bf16_f32 v242, v100, v101
    v_cvt_pk_bf16_f32 v243, v102, v103
    buffer_store_dwordx4 v[240:243], v220, s[8:11], 0 offen offset:1152 sc1
    v_cvt_pk_bf16_f32 v228, v20, v21
    v_cvt_pk_bf16_f32 v229, v22, v23
    v_cvt_pk_bf16_f32 v230, v48, v49
    v_cvt_pk_bf16_f32 v231, v50, v51
    buffer_store_dwordx4 v[228:231], v221, s[8:11], 0 offen offset:0 sc1
    v_cvt_pk_bf16_f32 v232, v76, v77
    v_cvt_pk_bf16_f32 v233, v78, v79
    v_cvt_pk_bf16_f32 v234, v104, v105
    v_cvt_pk_bf16_f32 v235, v106, v107
    buffer_store_dwordx4 v[232:235], v221, s[8:11], 0 offen offset:1152 sc1
    v_cvt_pk_bf16_f32 v236, v24, v25
    v_cvt_pk_bf16_f32 v237, v26, v27
    v_cvt_pk_bf16_f32 v238, v52, v53
    v_cvt_pk_bf16_f32 v239, v54, v55
    buffer_store_dwordx4 v[236:239], v222, s[8:11], 0 offen offset:0 sc1
    v_cvt_pk_bf16_f32 v240, v80, v81
    v_cvt_pk_bf16_f32 v241, v82, v83
    v_cvt_pk_bf16_f32 v242, v108, v109
    v_cvt_pk_bf16_f32 v243, v110, v111
    buffer_store_dwordx4 v[240:243], v222, s[8:11], 0 offen offset:1216 sc1
    v_cvt_pk_bf16_f32 v228, v28, v29
    v_cvt_pk_bf16_f32 v229, v30, v31
    v_cvt_pk_bf16_f32 v230, v56, v57
    v_cvt_pk_bf16_f32 v231, v58, v59
    buffer_store_dwordx4 v[228:231], v223, s[8:11], 0 offen offset:0 sc1
    v_cvt_pk_bf16_f32 v232, v84, v85
    v_cvt_pk_bf16_f32 v233, v86, v87
    v_cvt_pk_bf16_f32 v234, v112, v113
    v_cvt_pk_bf16_f32 v235, v114, v115
    buffer_store_dwordx4 v[232:235], v223, s[8:11], 0 offen offset:1216 sc1
    v_cvt_pk_bf16_f32 v236, v32, v33
    v_cvt_pk_bf16_f32 v237, v34, v35
    v_cvt_pk_bf16_f32 v238, v60, v61
    v_cvt_pk_bf16_f32 v239, v62, v63
    buffer_store_dwordx4 v[236:239], v224, s[8:11], 0 offen offset:0 sc1
    v_cvt_pk_bf16_f32 v240, v88, v89
    v_cvt_pk_bf16_f32 v241, v90, v91
    v_cvt_pk_bf16_f32 v242, v116, v117
    v_cvt_pk_bf16_f32 v243, v118, v119
    buffer_store_dwordx4 v[240:243], v224, s[8:11], 0 offen offset:1216 sc1
    v_cvt_pk_bf16_f32 v228, v36, v37
    v_cvt_pk_bf16_f32 v229, v38, v39
    v_cvt_pk_bf16_f32 v230, v64, v65
    v_cvt_pk_bf16_f32 v231, v66, v67
    buffer_store_dwordx4 v[228:231], v225, s[8:11], 0 offen offset:0 sc1
    v_cvt_pk_bf16_f32 v232, v92, v93
    v_cvt_pk_bf16_f32 v233, v94, v95
    v_cvt_pk_bf16_f32 v234, v120, v121
    v_cvt_pk_bf16_f32 v235, v122, v123
    buffer_store_dwordx4 v[232:235], v225, s[8:11], 0 offen offset:1216 sc1
    v_cvt_pk_bf16_f32 v236, v40, v41
    v_cvt_pk_bf16_f32 v237, v42, v43
    v_cvt_pk_bf16_f32 v238, v68, v69
    v_cvt_pk_bf16_f32 v239, v70, v71
    v_cndmask_b32 v236, v236, v6, vcc
    v_cndmask_b32 v237, v237, v6, vcc
    v_cndmask_b32 v238, v238, v6, vcc
    v_cndmask_b32 v239, v239, v6, vcc
    buffer_store_dwordx4 v[236:239], v226, s[8:11], 0 offen offset:0 sc1
    v_cvt_pk_bf16_f32 v240, v96, v97
    v_cvt_pk_bf16_f32 v241, v98, v99
    v_cvt_pk_bf16_f32 v242, v124, v125
    v_cvt_pk_bf16_f32 v243, v126, v127
    v_cndmask_b32 v240, v240, v6, vcc
    v_cndmask_b32 v241, v241, v6, vcc
    v_cndmask_b32 v242, v242, v6, vcc
    v_cndmask_b32 v243, v243, v6, vcc
    buffer_store_dwordx4 v[240:243], v226, s[8:11], 0 offen offset:1216 sc1
    s_barrier
    s_branch P1_fin
P1_epiAg:
    s_mov_b32 s54, 0x3fb8aa3b
    s_mov_b32 s55, 0x3fb8aa3b
    s_mov_b32 s50, 0x358637bd
    s_mov_b32 s51, 0x358637bd
    s_mov_b32 s52, 0.5
    s_mov_b32 s53, 0.5
    s_cmp_eq_u32 s39, 0
    s_cbranch_scc0 P1_epiA1g
    v_pk_mul_f32 v[6:7], v[36:37], s[54:55]
    v_pk_mul_f32 v[8:9], v[38:39], s[54:55]
    v_exp_f32_e64 v6, v6 clamp
    v_exp_f32_e64 v7, v7 clamp
    v_exp_f32_e64 v8, v8 clamp
    v_exp_f32_e64 v9, v9 clamp
    v_add_f32_e64 v36, v36, |v36|
    v_add_f32_e64 v37, v37, |v37|
    v_add_f32_e64 v38, v38, |v38|
    v_add_f32_e64 v39, v39, |v39|
    v_pk_fma_f32 v[36:37], v[36:37], s[52:53], v[6:7]
    v_pk_fma_f32 v[38:39], v[38:39], s[52:53], v[8:9]
    v_pk_add_f32 v[36:37], v[36:37], s[50:51]
    v_pk_add_f32 v[38:39], v[38:39], s[50:51]
    v_pk_mul_f32 v[6:7], v[64:65], s[54:55]
    v_pk_mul_f32 v[8:9], v[66:67], s[54:55]
    v_exp_f32_e64 v6, v6 clamp
    v_exp_f32_e64 v7, v7 clamp
    v_exp_f32_e64 v8, v8 clamp
    v_exp_f32_e64 v9, v9 clamp
    v_add_f32_e64 v64, v64, |v64|
    v_add_f32_e64 v65, v65, |v65|
    v_add_f32_e64 v66, v66, |v66|
    v_add_f32_e64 v67, v67, |v67|
    v_pk_fma_f32 v[64:65], v[64:65], s[52:53], v[6:7]
    v_pk_fma_f32 v[66:67], v[66:67], s[52:53], v[8:9]
    v_pk_add_f32 v[64:65], v[64:65], s[50:51]
    v_pk_add_f32 v[66:67], v[66:67], s[50:51]
    v_cvt_pk_bf16_f32 v228, v36, v37
    v_cvt_pk_bf16_f32 v229, v38, v39
    v_cvt_pk_bf16_f32 v230, v64, v65
    v_cvt_pk_bf16_f32 v231, v66, v67
    ds_write_b128 v225, v[228:231] offset:0
    v_pk_mul_f32 v[6:7], v[92:93], s[54:55]
    v_pk_mul_f32 v[8:9], v[94:95], s[54:55]
    v_exp_f32_e64 v6, v6 clamp
    v_exp_f32_e64 v7, v7 clamp
    v_exp_f32_e64 v8, v8 clamp
    v_exp_f32_e64 v9, v9 clamp
    v_add_f32_e64 v92, v92, |v92|
    v_add_f32_e64 v93, v93, |v93|
    v_add_f32_e64 v94, v94, |v94|
    v_add_f32_e64 v95, v95, |v95|
    v_pk_fma_f32 v[92:93], v[92:93], s[52:53], v[6:7]
    v_pk_fma_f32 v[94:95], v[94:95], s[52:53], v[8:9]
    v_pk_add_f32 v[92:93], v[92:93], s[50:51]
    v_pk_add_f32 v[94:95], v[94:95], s[50:51]
    v_pk_mul_f32 v[6:7], v[120:121], s[54:55]
    v_pk_mul_f32 v[8:9], v[122:123], s[54:55]
    v_exp_f32_e64 v6, v6 clamp
    v_exp_f32_e64 v7, v7 clamp
    v_exp_f32_e64 v8, v8 clamp
    v_exp_f32_e64 v9, v9 clamp
    v_add_f32_e64 v120, v120, |v120|
    v_add_f32_e64 v121, v121, |v121|
    v_add_f32_e64 v122, v122, |v122|
    v_add_f32_e64 v123, v123, |v123|
    v_pk_fma_f32 v[120:121], v[120:121], s[52:53], v[6:7]
    v_pk_fma_f32 v[122:123], v[122:123], s[52:53], v[8:9]
    v_pk_add_f32 v[120:121], v[120:121], s[50:51]
    v_pk_add_f32 v[122:123], v[122:123], s[50:51]
    v_cvt_pk_bf16_f32 v232, v92, v93
    v_cvt_pk_bf16_f32 v233, v94, v95
    v_cvt_pk_bf16_f32 v234, v120, v121
    v_cvt_pk_bf16_f32 v235, v122, v123
    ds_write_b128 v225, v[232:235] offset:2368
    v_pk_mul_f32 v[6:7], v[40:41], s[54:55]
    v_pk_mul_f32 v[8:9], v[42:43], s[54:55]
    v_exp_f32_e64 v6, v6 clamp
    v_exp_f32_e64 v7, v7 clamp
    v_exp_f32_e64 v8, v8 clamp
    v_exp_f32_e64 v9, v9 clamp
    v_add_f32_e64 v40, v40, |v40|
    v_add_f32_e64 v41, v41, |v41|
    v_add_f32_e64 v42, v42, |v42|
    v_add_f32_e64 v43, v43, |v43|
    v_pk_fma_f32 v[40:41], v[40:41], s[52:53], v[6:7]
    v_pk_fma_f32 v[42:43], v[42:43], s[52:53], v[8:9]
    v_pk_add_f32 v[40:41], v[40:41], s[50:51]
    v_pk_add_f32 v[42:43], v[42:43], s[50:51]
    v_pk_mul_f32 v[6:7], v[68:69], s[54:55]
    v_pk_mul_f32 v[8:9], v[70:71], s[54:55]
    v_exp_f32_e64 v6, v6 clamp
    v_exp_f32_e64 v7, v7 clamp
    v_exp_f32_e64 v8, v8 clamp
    v_exp_f32_e64 v9, v9 clamp
    v_add_f32_e64 v68, v68, |v68|
    v_add_f32_e64 v69, v69, |v69|
    v_add_f32_e64 v70, v70, |v70|
    v_add_f32_e64 v71, v71, |v71|
    v_pk_fma_f32 v[68:69], v[68:69], s[52:53], v[6:7]
    v_pk_fma_f32 v[70:71], v[70:71], s[52:53], v[8:9]
    v_pk_add_f32 v[68:69], v[68:69], s[50:51]
    v_pk_add_f32 v[70:71], v[70:71], s[50:51]
    v_cvt_pk_bf16_f32 v236, v40, v41
    v_cvt_pk_bf16_f32 v237, v42, v43
    v_cvt_pk_bf16_f32 v238, v68, v69
    v_cvt_pk_bf16_f32 v239, v70, v71
    ds_write_b128 v226, v[236:239] offset:0
    v_pk_mul_f32 v[6:7], v[96:97], s[54:55]
    v_pk_mul_f32 v[8:9], v[98:99], s[54:55]
    v_exp_f32_e64 v6, v6 clamp
    v_exp_f32_e64 v7, v7 clamp
    v_exp_f32_e64 v8, v8 clamp
    v_exp_f32_e64 v9, v9 clamp
    v_add_f32_e64 v96, v96, |v96|
    v_add_f32_e64 v97, v97, |v97|
    v_add_f32_e64 v98, v98, |v98|
    v_add_f32_e64 v99, v99, |v99|
    v_pk_fma_f32 v[96:97], v[96:97], s[52:53], v[6:7]
    v_pk_fma_f32 v[98:99], v[98:99], s[52:53], v[8:9]
    v_pk_add_f32 v[96:97], v[96:97], s[50:51]
    v_pk_add_f32 v[98:99], v[98:99], s[50:51]
    v_pk_mul_f32 v[6:7], v[124:125], s[54:55]
    v_pk_mul_f32 v[8:9], v[126:127], s[54:55]
    v_exp_f32_e64 v6, v6 clamp
    v_exp_f32_e64 v7, v7 clamp
    v_exp_f32_e64 v8, v8 clamp
    v_exp_f32_e64 v9, v9 clamp
    v_add_f32_e64 v124, v124, |v124|
    v_add_f32_e64 v125, v125, |v125|
    v_add_f32_e64 v126, v126, |v126|
    v_add_f32_e64 v127, v127, |v127|
    v_pk_fma_f32 v[124:125], v[124:125], s[52:53], v[6:7]
    v_pk_fma_f32 v[126:127], v[126:127], s[52:53], v[8:9]
    v_pk_add_f32 v[124:125], v[124:125], s[50:51]
    v_pk_add_f32 v[126:127], v[126:127], s[50:51]
    v_cvt_pk_bf16_f32 v240, v96, v97
    v_cvt_pk_bf16_f32 v241, v98, v99
    v_cvt_pk_bf16_f32 v242, v124, v125
    v_cvt_pk_bf16_f32 v243, v126, v127
    ds_write_b128 v226, v[240:243] offset:2368
    v_cvt_pk_bf16_f32 v228, v32, v33
    v_cvt_pk_bf16_f32 v229, v34, v35
    v_cvt_pk_bf16_f32 v230, v60, v61
    v_cvt_pk_bf16_f32 v231, v62, v63
    s_mov_b32 exec_lo, 0xff00ff
    s_mov_b32 exec_hi, 0xff00ff
    buffer_store_dwordx4 v[228:231], v224, s[8:11], 0 offen offset:0 sc1
    s_mov_b64 exec, -1
    v_pk_mul_f32 v[6:7], v[32:33], s[54:55]
    v_pk_mul_f32 v[8:9], v[34:35], s[54:55]
    v_exp_f32_e64 v6, v6 clamp
    v_exp_f32_e64 v7, v7 clamp
    v_exp_f32_e64 v8, v8 clamp
    v_exp_f32_e64 v9, v9 clamp
    v_add_f32_e64 v32, v32, |v32|
    v_add_f32_e64 v33, v33, |v33|
    v_add_f32_e64 v34, v34, |v34|
    v_add_f32_e64 v35, v35, |v35|
    v_pk_fma_f32 v[32:33], v[32:33], s[52:53], v[6:7]
    v_pk_fma_f32 v[34:35], v[34:35], s[52:53], v[8:9]
    v_pk_add_f32 v[32:33], v[32:33], s[50:51]
    v_pk_add_f32 v[34:35], v[34:35], s[50:51]
    v_pk_mul_f32 v[6:7], v[60:61], s[54:55]
    v_pk_mul_f32 v[8:9], v[62:63], s[54:55]
    v_exp_f32_e64 v6, v6 clamp
    v_exp_f32_e64 v7, v7 clamp
    v_exp_f32_e64 v8, v8 clamp
    v_exp_f32_e64 v9, v9 clamp
    v_add_f32_e64 v60, v60, |v60|
    v_add_f32_e64 v61, v61, |v61|
    v_add_f32_e64 v62, v62, |v62|
    v_add_f32_e64 v63, v63, |v63|
    v_pk_fma_f32 v[60:61], v[60:61], s[52:53], v[6:7]
    v_pk_fma_f32 v[62:63], v[62:63], s[52:53], v[8:9]
    v_pk_add_f32 v[60:61], v[60:61], s[50:51]
    v_pk_add_f32 v[62:63], v[62:63], s[50:51]
    v_cvt_pk_bf16_f32 v232, v32, v33
    v_cvt_pk_bf16_f32 v233, v34, v35
    v_cvt_pk_bf16_f32 v234, v60, v61
    v_cvt_pk_bf16_f32 v235, v62, v63
    s_mov_b32 exec_lo, 0xff00ff00
    s_mov_b32 exec_hi, 0xff00ff00
    ds_write_b128 v224, v[232:235] offset:0
    s_mov_b64 exec, -1
    v_cvt_pk_bf16_f32 v236, v88, v89
    v_cvt_pk_bf16_f32 v237, v90, v91
    v_cvt_pk_bf16_f32 v238, v116, v117
    v_cvt_pk_bf16_f32 v239, v118, v119
    s_mov_b32 exec_lo, 0xff00ff
    s_mov_b32 exec_hi, 0xff00ff
    buffer_store_dwordx4 v[236:239], v224, s[8:11], 0 offen offset:1152 sc1
    s_mov_b64 exec, -1
    v_pk_mul_f32 v[6:7], v[88:89], s[54:55]
    v_pk_mul_f32 v[8:9], v[90:91], s[54:55]
    v_exp_f32_e64 v6, v6 clamp
    v_exp_f32_e64 v7, v7 clamp
    v_exp_f32_e64 v8, v8 clamp
    v_exp_f32_e64 v9, v9 clamp
    v_add_f32_e64 v88, v88, |v88|
    v_add_f32_e64 v89, v89, |v89|
    v_add_f32_e64 v90, v90, |v90|
    v_add_f32_e64 v91, v91, |v91|
    v_pk_fma_f32 v[88:89], v[88:89], s[52:53], v[6:7]
    v_pk_fma_f32 v[90:91], v[90:91], s[52:53], v[8:9]
    v_pk_add_f32 v[88:89], v[88:89], s[50:51]
    v_pk_add_f32 v[90:91], v[90:91], s[50:51]
    v_pk_mul_f32 v[6:7], v[116:117], s[54:55]
    v_pk_mul_f32 v[8:9], v[118:119], s[54:55]
    v_exp_f32_e64 v6, v6 clamp
    v_exp_f32_e64 v7, v7 clamp
    v_exp_f32_e64 v8, v8 clamp
    v_exp_f32_e64 v9, v9 clamp
    v_add_f32_e64 v116, v116, |v116|
    v_add_f32_e64 v117, v117, |v117|
    v_add_f32_e64 v118, v118, |v118|
    v_add_f32_e64 v119, v119, |v119|
    v_pk_fma_f32 v[116:117], v[116:117], s[52:53], v[6:7]
    v_pk_fma_f32 v[118:119], v[118:119], s[52:53], v[8:9]
    v_pk_add_f32 v[116:117], v[116:117], s[50:51]
    v_pk_add_f32 v[118:119], v[118:119], s[50:51]
    v_cvt_pk_bf16_f32 v240, v88, v89
    v_cvt_pk_bf16_f32 v241, v90, v91
    v_cvt_pk_bf16_f32 v242, v116, v117
    v_cvt_pk_bf16_f32 v243, v118, v119
    s_mov_b32 exec_lo, 0xff00ff00
    s_mov_b32 exec_hi, 0xff00ff00
    ds_write_b128 v224, v[240:243] offset:2368
    s_mov_b64 exec, -1
    s_waitcnt lgkmcnt(0)
    s_barrier
    v_cvt_pk_bf16_f32 v228, v16, v17
    v_cvt_pk_bf16_f32 v229, v18, v19
    v_cvt_pk_bf16_f32 v230, v44, v45
    v_cvt_pk_bf16_f32 v231, v46, v47
    buffer_store_dwordx4 v[228:231], v220, s[8:11], 0 offen offset:0 sc1
    v_cvt_pk_bf16_f32 v232, v72, v73
    v_cvt_pk_bf16_f32 v233, v74, v75
    v_cvt_pk_bf16_f32 v234, v100, v101
    v_cvt_pk_bf16_f32 v235, v102, v103
    buffer_store_dwordx4 v[232:235], v220, s[8:11], 0 offen offset:1152 sc1
    v_cvt_pk_bf16_f32 v236, v20, v21
    v_cvt_pk_bf16_f32 v237, v22, v23
    v_cvt_pk_bf16_f32 v238, v48, v49
    v_cvt_pk_bf16_f32 v239, v50, v51
    buffer_store_dwordx4 v[236:239], v221, s[8:11], 0 offen offset:0 sc1
    v_cvt_pk_bf16_f32 v240, v76, v77
    v_cvt_pk_bf16_f32 v241, v78, v79
    v_cvt_pk_bf16_f32 v242, v104, v105
    v_cvt_pk_bf16_f32 v243, v106, v107
    buffer_store_dwordx4 v[240:243], v221, s[8:11], 0 offen offset:1152 sc1
    v_cvt_pk_bf16_f32 v228, v24, v25
    v_cvt_pk_bf16_f32 v229, v26, v27
    v_cvt_pk_bf16_f32 v230, v52, v53
    v_cvt_pk_bf16_f32 v231, v54, v55
    buffer_store_dwordx4 v[228:231], v222, s[8:11], 0 offen offset:0 sc1
    v_cvt_pk_bf16_f32 v232, v80, v81
    v_cvt_pk_bf16_f32 v233, v82, v83
    v_cvt_pk_bf16_f32 v234, v108, v109
    v_cvt_pk_bf16_f32 v235, v110, v111
    buffer_store_dwordx4 v[232:235], v222, s[8:11], 0 offen offset:1152 sc1
    v_cvt_pk_bf16_f32 v236, v28, v29
    v_cvt_pk_bf16_f32 v237, v30, v31
    v_cvt_pk_bf16_f32 v238, v56, v57
    v_cvt_pk_bf16_f32 v239, v58, v59
    buffer_store_dwordx4 v[236:239], v223, s[8:11], 0 offen offset:0 sc1
    v_cvt_pk_bf16_f32 v240, v84, v85
    v_cvt_pk_bf16_f32 v241, v86, v87
    v_cvt_pk_bf16_f32 v242, v112, v113
    v_cvt_pk_bf16_f32 v243, v114, v115
    buffer_store_dwordx4 v[240:243], v223, s[8:11], 0 offen offset:1152 sc1
    s_branch P1_epiA3g
P1_epiA1g:
    v_cmp_le_u32 vcc, 8, v2
    v_mov_b32 v12, 0x3f803f80
    v_pk_mul_f32 v[6:7], v[16:17], s[54:55]
    v_pk_mul_f32 v[8:9], v[18:19], s[54:55]
    v_exp_f32_e64 v6, v6 clamp
    v_exp_f32_e64 v7, v7 clamp
    v_exp_f32_e64 v8, v8 clamp
    v_exp_f32_e64 v9, v9 clamp
    v_add_f32_e64 v16, v16, |v16|
    v_add_f32_e64 v17, v17, |v17|
    v_add_f32_e64 v18, v18, |v18|
    v_add_f32_e64 v19, v19, |v19|
    v_pk_fma_f32 v[16:17], v[16:17], s[52:53], v[6:7]
    v_pk_fma_f32 v[18:19], v[18:19], s[52:53], v[8:9]
    v_pk_add_f32 v[16:17], v[16:17], s[50:51]
    v_pk_add_f32 v[18:19], v[18:19], s[50:51]
    v_pk_mul_f32 v[6:7], v[44:45], s[54:55]
    v_pk_mul_f32 v[8:9], v[46:47], s[54:55]
    v_exp_f32_e64 v6, v6 clamp
    v_exp_f32_e64 v7, v7 clamp
    v_exp_f32_e64 v8, v8 clamp
    v_exp_f32_e64 v9, v9 clamp
    v_add_f32_e64 v44, v44, |v44|
    v_add_f32_e64 v45, v45, |v45|
    v_add_f32_e64 v46, v46, |v46|
    v_add_f32_e64 v47, v47, |v47|
    v_pk_fma_f32 v[44:45], v[44:45], s[52:53], v[6:7]
    v_pk_fma_f32 v[46:47], v[46:47], s[52:53], v[8:9]
    v_pk_add_f32 v[44:45], v[44:45], s[50:51]
    v_pk_add_f32 v[46:47], v[46:47], s[50:51]
    v_cvt_pk_bf16_f32 v228, v16, v17
    v_cvt_pk_bf16_f32 v229, v18, v19
    v_cvt_pk_bf16_f32 v230, v44, v45
    v_cvt_pk_bf16_f32 v231, v46, v47
    ds_write_b128 v220, v[228:231] offset:0
    v_pk_mul_f32 v[6:7], v[72:73], s[54:55]
    v_pk_mul_f32 v[8:9], v[74:75], s[54:55]
    v_exp_f32_e64 v6, v6 clamp
    v_exp_f32_e64 v7, v7 clamp
    v_exp_f32_e64 v8, v8 clamp
    v_exp_f32_e64 v9, v9 clamp
    v_add_f32_e64 v72, v72, |v72|
    v_add_f32_e64 v73, v73, |v73|
    v_add_f32_e64 v74, v74, |v74|
    v_add_f32_e64 v75, v75, |v75|
    v_pk_fma_f32 v[72:73], v[72:73], s[52:53], v[6:7]
    v_pk_fma_f32 v[74:75], v[74:75], s[52:53], v[8:9]
    v_pk_add_f32 v[72:73], v[72:73], s[50:51]
    v_pk_add_f32 v[74:75], v[74:75], s[50:51]
    v_pk_mul_f32 v[6:7], v[100:101], s[54:55]
    v_pk_mul_f32 v[8:9], v[102:103], s[54:55]
    v_exp_f32_e64 v6, v6 clamp
    v_exp_f32_e64 v7, v7 clamp
    v_exp_f32_e64 v8, v8 clamp
    v_exp_f32_e64 v9, v9 clamp
    v_add_f32_e64 v100, v100, |v100|
    v_add_f32_e64 v101, v101, |v101|
    v_add_f32_e64 v102, v102, |v102|
    v_add_f32_e64 v103, v103, |v103|
    v_pk_fma_f32 v[100:101], v[100:101], s[52:53], v[6:7]
    v_pk_fma_f32 v[102:103], v[102:103], s[52:53], v[8:9]
    v_pk_add_f32 v[100:101], v[100:101], s[50:51]
    v_pk_add_f32 v[102:103], v[102:103], s[50:51]
    v_cvt_pk_bf16_f32 v232, v72, v73
    v_cvt_pk_bf16_f32 v233, v74, v75
    v_cvt_pk_bf16_f32 v234, v100, v101
    v_cvt_pk_bf16_f32 v235, v102, v103
    ds_write_b128 v220, v[232:235] offset:2368
    v_pk_mul_f32 v[6:7], v[20:21], s[54:55]
    v_pk_mul_f32 v[8:9], v[22:23], s[54:55]
    v_exp_f32_e64 v6, v6 clamp
    v_exp_f32_e64 v7, v7 clamp
    v_exp_f32_e64 v8, v8 clamp
    v_exp_f32_e64 v9, v9 clamp
    v_add_f32_e64 v20, v20, |v20|
    v_add_f32_e64 v21, v21, |v21|
    v_add_f32_e64 v22, v22, |v22|
    v_add_f32_e64 v23, v23, |v23|
    v_pk_fma_f32 v[20:21], v[20:21], s[52:53], v[6:7]
    v_pk_fma_f32 v[22:23], v[22:23], s[52:53], v[8:9]
    v_pk_add_f32 v[20:21], v[20:21], s[50:51]
    v_pk_add_f32 v[22:23], v[22:23], s[50:51]
    v_pk_mul_f32 v[6:7], v[48:49], s[54:55]
    v_pk_mul_f32 v[8:9], v[50:51], s[54:55]
    v_exp_f32_e64 v6, v6 clamp
    v_exp_f32_e64 v7, v7 clamp
    v_exp_f32_e64 v8, v8 clamp
    v_exp_f32_e64 v9, v9 clamp
    v_add_f32_e64 v48, v48, |v48|
    v_add_f32_e64 v49, v49, |v49|
    v_add_f32_e64 v50, v50, |v50|
    v_add_f32_e64 v51, v51, |v51|
    v_pk_fma_f32 v[48:49], v[48:49], s[52:53], v[6:7]
    v_pk_fma_f32 v[50:51], v[50:51], s[52:53], v[8:9]
    v_pk_add_f32 v[48:49], v[48:49], s[50:51]
    v_pk_add_f32 v[50:51], v[50:51], s[50:51]
    v_cvt_pk_bf16_f32 v236, v20, v21
    v_cvt_pk_bf16_f32 v237, v22, v23
    v_cvt_pk_bf16_f32 v238, v48, v49
    v_cvt_pk_bf16_f32 v239, v50, v51
    ds_write_b128 v221, v[236:239] offset:0
    v_pk_mul_f32 v[6:7], v[76:77], s[54:55]
    v_pk_mul_f32 v[8:9], v[78:79], s[54:55]
    v_exp_f32_e64 v6, v6 clamp
    v_exp_f32_e64 v7, v7 clamp
    v_exp_f32_e64 v8, v8 clamp
    v_exp_f32_e64 v9, v9 clamp
    v_add_f32_e64 v76, v76, |v76|
    v_add_f32_e64 v77, v77, |v77|
    v_add_f32_e64 v78, v78, |v78|
    v_add_f32_e64 v79, v79, |v79|
    v_pk_fma_f32 v[76:77], v[76:77], s[52:53], v[6:7]
    v_pk_fma_f32 v[78:79], v[78:79], s[52:53], v[8:9]
    v_pk_add_f32 v[76:77], v[76:77], s[50:51]
    v_pk_add_f32 v[78:79], v[78:79], s[50:51]
    v_pk_mul_f32 v[6:7], v[104:105], s[54:55]
    v_pk_mul_f32 v[8:9], v[106:107], s[54:55]
    v_exp_f32_e64 v6, v6 clamp
    v_exp_f32_e64 v7, v7 clamp
    v_exp_f32_e64 v8, v8 clamp
    v_exp_f32_e64 v9, v9 clamp
    v_add_f32_e64 v104, v104, |v104|
    v_add_f32_e64 v105, v105, |v105|
    v_add_f32_e64 v106, v106, |v106|
    v_add_f32_e64 v107, v107, |v107|
    v_pk_fma_f32 v[104:105], v[104:105], s[52:53], v[6:7]
    v_pk_fma_f32 v[106:107], v[106:107], s[52:53], v[8:9]
    v_pk_add_f32 v[104:105], v[104:105], s[50:51]
    v_pk_add_f32 v[106:107], v[106:107], s[50:51]
    v_cvt_pk_bf16_f32 v240, v76, v77
    v_cvt_pk_bf16_f32 v241, v78, v79
    v_cvt_pk_bf16_f32 v242, v104, v105
    v_cvt_pk_bf16_f32 v243, v106, v107
    ds_write_b128 v221, v[240:243] offset:2368
    v_cvt_pk_bf16_f32 v228, v24, v25
    v_cvt_pk_bf16_f32 v229, v26, v27
    v_cvt_pk_bf16_f32 v230, v52, v53
    v_cvt_pk_bf16_f32 v231, v54, v55
    ds_write_b128 v222, v[228:231] offset:0
    v_cvt_pk_bf16_f32 v232, v80, v81
    v_cvt_pk_bf16_f32 v233, v82, v83
    v_cvt_pk_bf16_f32 v234, v108, v109
    v_cvt_pk_bf16_f32 v235, v110, v111
    ds_write_b128 v222, v[232:235] offset:2368
    v_cvt_pk_bf16_f32 v236, v28, v29
    v_cvt_pk_bf16_f32 v237, v30, v31
    v_cvt_pk_bf16_f32 v238, v56, v57
    v_cvt_pk_bf16_f32 v239, v58, v59
    ds_write_b128 v223, v[236:239] offset:0
    v_cvt_pk_bf16_f32 v240, v84, v85
    v_cvt_pk_bf16_f32 v241, v86, v87
    v_cvt_pk_bf16_f32 v242, v112, v113
    v_cvt_pk_bf16_f32 v243, v114, v115
    ds_write_b128 v223, v[240:243] offset:2368
    v_cvt_pk_bf16_f32 v228, v32, v33
    v_cvt_pk_bf16_f32 v229, v34, v35
    v_cvt_pk_bf16_f32 v230, v60, v61
    v_cvt_pk_bf16_f32 v231, v62, v63
    ds_write_b128 v224, v[228:231] offset:0
    v_cvt_pk_bf16_f32 v232, v88, v89
    v_cvt_pk_bf16_f32 v233, v90, v91
    v_cvt_pk_bf16_f32 v234, v116, v117
    v_cvt_pk_bf16_f32 v235, v118, v119
    ds_write_b128 v224, v[232:235] offset:2368
    v_cvt_pk_bf16_f32 v236, v36, v37
    v_cvt_pk_bf16_f32 v237, v38, v39
    v_cvt_pk_bf16_f32 v238, v64, v65
    v_cvt_pk_bf16_f32 v239, v66, v67
    ds_write_b128 v225, v[236:239] offset:0
    v_cvt_pk_bf16_f32 v240, v92, v93
    v_cvt_pk_bf16_f32 v241, v94, v95
    v_cvt_pk_bf16_f32 v242, v120, v121
    v_cvt_pk_bf16_f32 v243, v122, v123
    ds_write_b128 v225, v[240:243] offset:2368
    v_cvt_pk_bf16_f32 v228, v40, v41
    v_cvt_pk_bf16_f32 v229, v42, v43
    v_cvt_pk_bf16_f32 v230, v68, v69
    v_cvt_pk_bf16_f32 v231, v70, v71
    v_cndmask_b32 v228, v228, v12, vcc
    v_cndmask_b32 v229, v229, v12, vcc
    v_cndmask_b32 v230, v230, v12, vcc
    v_cndmask_b32 v231, v231, v12, vcc
    s_mov_b32 exec_lo, 0xfff0fff
    s_mov_b32 exec_hi, 0xfff0fff
    ds_write_b128 v226, v[228:231] offset:0
    s_mov_b64 exec, -1
    v_cvt_pk_bf16_f32 v232, v96, v97
    v_cvt_pk_bf16_f32 v233, v98, v99
    v_cvt_pk_bf16_f32 v234, v124, v125
    v_cvt_pk_bf16_f32 v235, v126, v127
    v_cndmask_b32 v232, v232, v12, vcc
    v_cndmask_b32 v233, v233, v12, vcc
    v_cndmask_b32 v234, v234, v12, vcc
    v_cndmask_b32 v235, v235, v12, vcc
    s_mov_b32 exec_lo, 0xfff0fff
    s_mov_b32 exec_hi, 0xfff0fff
    ds_write_b128 v226, v[232:235] offset:2368
    s_mov_b64 exec, -1
P1_epiA2g:
    s_waitcnt lgkmcnt(0)
    s_barrier
P1_epiA3g:
    v_and_b32 v2, 31, v1
    v_lshrrev_b32 v3, 5, v1
    v_min_u32 v4, 17, v2
    v_min_u32 v5, 18, v2
    s_mul_i32 s40, s3, 9472
    v_mul_u32_u24 v6, 288, v3
    v_lshlrev_b32 v4, 4, v4
    v_add3_u32 v4, v4, v6, s40
    v_mul_u32_u24 v6, 304, v3
    v_lshlrev_b32 v5, 4, v5
    v_add3_u32 v5, v5, v6, s40
    ds_read_b128 v[16:19], v4 offset:0
    ds_read_b128 v[48:51], v5 offset:1152
    ds_read_b128 v[20:23], v4 offset:576
    ds_read_b128 v[52:55], v5 offset:1760
    ds_read_b128 v[24:27], v4 offset:2368
    ds_read_b128 v[56:59], v5 offset:3520
    ds_read_b128 v[28:31], v4 offset:2944
    ds_read_b128 v[60:63], v5 offset:4128
    ds_read_b128 v[32:35], v4 offset:4736
    ds_read_b128 v[64:67], v5 offset:5888
    ds_read_b128 v[36:39], v4 offset:5312
    ds_read_b128 v[68:71], v5 offset:6496
    ds_read_b128 v[40:43], v4 offset:7104
    ds_read_b128 v[72:75], v5 offset:8256
    ds_read_b128 v[44:47], v4 offset:7680
    ds_read_b128 v[76:79], v5 offset:8864
    s_lshl_b32 s40, s32, 5
    s_lshl_b32 s41, s33, 2
    s_add_u32 s40, s40, s41
    s_add_u32 s40, s40, s3
    s_mul_i32 s40, s40, 1520
    s_add_u32 s40, s40, 9568256
    v_mul_u32_u24 v10, 80, v2
    v_lshlrev_b32 v11, 4, v3
    v_add3_u32 v10, v10, v11, s40
    v_mov_b32 v12, 1073741824
    v_cmp_gt_u32 vcc, 19, v2
    s_nop 1
    v_cndmask_b32 v10, v12, v10, vcc
    v_cmp_eq_u32 vcc, 0, v3
    s_nop 1
    v_cndmask_b32 v11, v12, v10, vcc
    s_waitcnt lgkmcnt(0)
    v_mfma_f32_32x32x16_bf16 v[80:95], v[16:19], v[48:51], 0
    v_mfma_f32_32x32x16_bf16 v[80:95], v[20:23], v[52:55], v[80:95]
    v_mfma_f32_32x32x16_bf16 v[80:95], v[24:27], v[56:59], v[80:95]
    v_mfma_f32_32x32x16_bf16 v[80:95], v[28:31], v[60:63], v[80:95]
    v_mfma_f32_32x32x16_bf16 v[80:95], v[32:35], v[64:67], v[80:95]
    v_mfma_f32_32x32x16_bf16 v[80:95], v[36:39], v[68:71], v[80:95]
    v_mfma_f32_32x32x16_bf16 v[80:95], v[40:43], v[72:75], v[80:95]
    v_mfma_f32_32x32x16_bf16 v[80:95], v[44:47], v[76:79], v[80:95]
    s_nop 11
    buffer_store_dwordx4 v[80:83], v10, s[8:11], 0 offen sc1
    buffer_store_dwordx4 v[84:87], v10, s[8:11], 0 offen offset:32 sc1
    buffer_store_dwordx2 v[88:89], v11, s[8:11], 0 offen offset:64 sc1
    s_branch P1_fin
P1_epi_local:
    s_cmp_eq_u32 s31, 0
    s_cbranch_scc1 P1_epiAl
    s_mov_b32 s54, 0x3eae1a93
    s_mov_b32 s55, 0x3eae1a93
    s_cmp_eq_u32 s39, 0
    s_cbranch_scc0 P1_epiB1l
    v_cmp_gt_u32 vcc, 8, v2
    v_mov_b32 v4, 1.0
    v_mov_b32 v5, s54
    v_cndmask_b32 v4, v4, v5, vcc
    v_mov_b32 v5, v4
    v_pk_mul_f32 v[16:17], v[16:17], s[54:55]
    v_pk_mul_f32 v[18:19], v[18:19], s[54:55]
    v_pk_mul_f32 v[44:45], v[44:45], s[54:55]
    v_pk_mul_f32 v[46:47], v[46:47], s[54:55]
    v_cvt_pk_bf16_f32 v228, v16, v17
    v_cvt_pk_bf16_f32 v229, v18, v19
    v_cvt_pk_bf16_f32 v230, v44, v45
    v_cvt_pk_bf16_f32 v231, v46, v47
    buffer_store_dwordx4 v[228:231], v220, s[8:11], 0 offen offset:0
    v_pk_mul_f32 v[72:73], v[72:73], s[54:55]
    v_pk_mul_f32 v[74:75], v[74:75], s[54:55]
    v_pk_mul_f32 v[100:101], v[100:101], s[54:55]
    v_pk_mul_f32 v[102:103], v[102:103], s[54:55]
    v_cvt_pk_bf16_f32 v232, v72, v73
    v_cvt_pk_bf16_f32 v233, v74, v75
    v_cvt_pk_bf16_f32 v234, v100, v101
    v_cvt_pk_bf16_f32 v235, v102, v103
    buffer_store_dwordx4 v[232:235], v220, s[8:11], 0 offen offset:1152
    v_pk_mul_f32 v[20:21], v[20:21], s[54:55]
    v_pk_mul_f32 v[22:23], v[22:23], s[54:55]
    v_pk_mul_f32 v[48:49], v[48:49], s[54:55]
    v_pk_mul_f32 v[50:51], v[50:51], s[54:55]
    v_cvt_pk_bf16_f32 v236, v20, v21
    v_cvt_pk_bf16_f32 v237, v22, v23
    v_cvt_pk_bf16_f32 v238, v48, v49
    v_cvt_pk_bf16_f32 v239, v50, v51
    buffer_store_dwordx4 v[236:239], v221, s[8:11], 0 offen offset:0
    v_pk_mul_f32 v[76:77], v[76:77], s[54:55]
    v_pk_mul_f32 v[78:79], v[78:79], s[54:55]
    v_pk_mul_f32 v[104:105], v[104:105], s[54:55]
    v_pk_mul_f32 v[106:107], v[106:107], s[54:55]
    v_cvt_pk_bf16_f32 v240, v76, v77
    v_cvt_pk_bf16_f32 v241, v78, v79
    v_cvt_pk_bf16_f32 v242, v104, v105
    v_cvt_pk_bf16_f32 v243, v106, v107
    buffer_store_dwordx4 v[240:243], v221, s[8:11], 0 offen offset:1152
    v_pk_mul_f32 v[24:25], v[24:25], s[54:55]
    v_pk_mul_f32 v[26:27], v[26:27], s[54:55]
    v_pk_mul_f32 v[52:53], v[52:53], s[54:55]
    v_pk_mul_f32 v[54:55], v[54:55], s[54:55]
    v_cvt_pk_bf16_f32 v228, v24, v25
    v_cvt_pk_bf16_f32 v229, v26, v27
    v_cvt_pk_bf16_f32 v230, v52, v53
    v_cvt_pk_bf16_f32 v231, v54, v55
    buffer_store_dwordx4 v[228:231], v222, s[8:11], 0 offen offset:0
    v_pk_mul_f32 v[80:81], v[80:81], s[54:55]
    v_pk_mul_f32 v[82:83], v[82:83], s[54:55]
    v_pk_mul_f32 v[108:109], v[108:109], s[54:55]
    v_pk_mul_f32 v[110:111], v[110:111], s[54:55]
    v_cvt_pk_bf16_f32 v232, v80, v81
    v_cvt_pk_bf16_f32 v233, v82, v83
    v_cvt_pk_bf16_f32 v234, v108, v109
    v_cvt_pk_bf16_f32 v235, v110, v111
    buffer_store_dwordx4 v[232:235], v222, s[8:11], 0 offen offset:1152
    v_pk_mul_f32 v[28:29], v[28:29], s[54:55]
    v_pk_mul_f32 v[30:31], v[30:31], s[54:55]
    v_pk_mul_f32 v[56:57], v[56:57], s[54:55]
    v_pk_mul_f32 v[58:59], v[58:59], s[54:55]
    v_cvt_pk_bf16_f32 v236, v28, v29
    v_cvt_pk_bf16_f32 v237, v30, v31
    v_cvt_pk_bf16_f32 v238, v56, v57
    v_cvt_pk_bf16_f32 v239, v58, v59
    buffer_store_dwordx4 v[236:239], v223, s[8:11], 0 offen offset:0
    v_pk_mul_f32 v[84:85], v[84:85], s[54:55]
    v_pk_mul_f32 v[86:87], v[86:87], s[54:55]
    v_pk_mul_f32 v[112:113], v[112:113], s[54:55]
    v_pk_mul_f32 v[114:115], v[114:115], s[54:55]
    v_cvt_pk_bf16_f32 v240, v84, v85
    v_cvt_pk_bf16_f32 v241, v86, v87
    v_cvt_pk_bf16_f32 v242, v112, v113
    v_cvt_pk_bf16_f32 v243, v114, v115
    buffer_store_dwordx4 v[240:243], v223, s[8:11], 0 offen offset:1152
    v_pk_mul_f32 v[32:33], v[32:33], v[4:5]
    v_pk_mul_f32 v[34:35], v[34:35], v[4:5]
    v_pk_mul_f32 v[60:61], v[60:61], v[4:5]
    v_pk_mul_f32 v[62:63], v[62:63], v[4:5]
    v_cvt_pk_bf16_f32 v228, v32, v33
    v_cvt_pk_bf16_f32 v229, v34, v35
    v_cvt_pk_bf16_f32 v230, v60, v61
    v_cvt_pk_bf16_f32 v231, v62, v63
    buffer_store_dwordx4 v[228:231], v224, s[8:11], 0 offen offset:0
    v_pk_mul_f32 v[88:89], v[88:89], v[4:5]
    v_pk_mul_f32 v[90:91], v[90:91], v[4:5]
    v_pk_mul_f32 v[116:117], v[116:117], v[4:5]
    v_pk_mul_f32 v[118:119], v[118:119], v[4:5]
    v_cvt_pk_bf16_f32 v232, v88, v89
    v_cvt_pk_bf16_f32 v233, v90, v91
    v_cvt_pk_bf16_f32 v234, v116, v117
    v_cvt_pk_bf16_f32 v235, v118, v119
    buffer_store_dwordx4 v[232:235], v224, s[8:11], 0 offen offset:1152
    v_cvt_pk_bf16_f32 v236, v36, v37
    v_cvt_pk_bf16_f32 v237, v38, v39
    v_cvt_pk_bf16_f32 v238, v64, v65
    v_cvt_pk_bf16_f32 v239, v66, v67
    buffer_store_dwordx4 v[236:239], v225, s[8:11], 0 offen offset:0
    v_cvt_pk_bf16_f32 v240, v92, v93
    v_cvt_pk_bf16_f32 v241, v94, v95
    v_cvt_pk_bf16_f32 v242, v120, v121
    v_cvt_pk_bf16_f32 v243, v122, v123
    buffer_store_dwordx4 v[240:243], v225, s[8:11], 0 offen offset:1152
    v_cvt_pk_bf16_f32 v228, v40, v41
    v_cvt_pk_bf16_f32 v229, v42, v43
    v_cvt_pk_bf16_f32 v230, v68, v69
    v_cvt_pk_bf16_f32 v231, v70, v71
    buffer_store_dwordx4 v[228:231], v226, s[8:11], 0 offen offset:0
    v_cvt_pk_bf16_f32 v232, v96, v97
    v_cvt_pk_bf16_f32 v233, v98, v99
    v_cvt_pk_bf16_f32 v234, v124, v125
    v_cvt_pk_bf16_f32 v235, v126, v127
    buffer_store_dwordx4 v[232:235], v226, s[8:11], 0 offen offset:1152
    s_barrier
    s_branch P1_fin
P1_epiB1l:
    v_cmp_le_u32 vcc, 8, v2
    v_mov_b32 v6, 0x3f803f80
    v_cvt_pk_bf16_f32 v236, v16, v17
    v_cvt_pk_bf16_f32 v237, v18, v19
    v_cvt_pk_bf16_f32 v238, v44, v45
    v_cvt_pk_bf16_f32 v239, v46, v47
    buffer_store_dwordx4 v[236:239], v220, s[8:11], 0 offen offset:0
    v_cvt_pk_bf16_f32 v240, v72, v73
    v_cvt_pk_bf16_f32 v241, v74, v75
    v_cvt_pk_bf16_f32 v242, v100, v101
    v_cvt_pk_bf16_f32 v243, v102, v103
    buffer_store_dwordx4 v[240:243], v220, s[8:11], 0 offen offset:1152
    v_cvt_pk_bf16_f32 v228, v20, v21
    v_cvt_pk_bf16_f32 v229, v22, v23
    v_cvt_pk_bf16_f32 v230, v48, v49
    v_cvt_pk_bf16_f32 v231, v50, v51
    buffer_store_dwordx4 v[228:231], v221, s[8:11], 0 offen offset:0
    v_cvt_pk_bf16_f32 v232, v76, v77
    v_cvt_pk_bf16_f32 v233, v78, v79
    v_cvt_pk_bf16_f32 v234, v104, v105
    v_cvt_pk_bf16_f32 v235, v106, v107
    buffer_store_dwordx4 v[232:235], v221, s[8:11], 0 offen offset:1152
    v_cvt_pk_bf16_f32 v236, v24, v25
    v_cvt_pk_bf16_f32 v237, v26, v27
    v_cvt_pk_bf16_f32 v238, v52, v53
    v_cvt_pk_bf16_f32 v239, v54, v55
    buffer_store_dwordx4 v[236:239], v222, s[8:11], 0 offen offset:0
    v_cvt_pk_bf16_f32 v240, v80, v81
    v_cvt_pk_bf16_f32 v241, v82, v83
    v_cvt_pk_bf16_f32 v242, v108, v109
    v_cvt_pk_bf16_f32 v243, v110, v111
    buffer_store_dwordx4 v[240:243], v222, s[8:11], 0 offen offset:1216
    v_cvt_pk_bf16_f32 v228, v28, v29
    v_cvt_pk_bf16_f32 v229, v30, v31
    v_cvt_pk_bf16_f32 v230, v56, v57
    v_cvt_pk_bf16_f32 v231, v58, v59
    buffer_store_dwordx4 v[228:231], v223, s[8:11], 0 offen offset:0
    v_cvt_pk_bf16_f32 v232, v84, v85
    v_cvt_pk_bf16_f32 v233, v86, v87
    v_cvt_pk_bf16_f32 v234, v112, v113
    v_cvt_pk_bf16_f32 v235, v114, v115
    buffer_store_dwordx4 v[232:235], v223, s[8:11], 0 offen offset:1216
    v_cvt_pk_bf16_f32 v236, v32, v33
    v_cvt_pk_bf16_f32 v237, v34, v35
    v_cvt_pk_bf16_f32 v238, v60, v61
    v_cvt_pk_bf16_f32 v239, v62, v63
    buffer_store_dwordx4 v[236:239], v224, s[8:11], 0 offen offset:0
    v_cvt_pk_bf16_f32 v240, v88, v89
    v_cvt_pk_bf16_f32 v241, v90, v91
    v_cvt_pk_bf16_f32 v242, v116, v117
    v_cvt_pk_bf16_f32 v243, v118, v119
    buffer_store_dwordx4 v[240:243], v224, s[8:11], 0 offen offset:1216
    v_cvt_pk_bf16_f32 v228, v36, v37
    v_cvt_pk_bf16_f32 v229, v38, v39
    v_cvt_pk_bf16_f32 v230, v64, v65
    v_cvt_pk_bf16_f32 v231, v66, v67
    buffer_store_dwordx4 v[228:231], v225, s[8:11], 0 offen offset:0
    v_cvt_pk_bf16_f32 v232, v92, v93
    v_cvt_pk_bf16_f32 v233, v94, v95
    v_cvt_pk_bf16_f32 v234, v120, v121
    v_cvt_pk_bf16_f32 v235, v122, v123
    buffer_store_dwordx4 v[232:235], v225, s[8:11], 0 offen offset:1216
    v_cvt_pk_bf16_f32 v236, v40, v41
    v_cvt_pk_bf16_f32 v237, v42, v43
    v_cvt_pk_bf16_f32 v238, v68, v69
    v_cvt_pk_bf16_f32 v239, v70, v71
    v_cndmask_b32 v236, v236, v6, vcc
    v_cndmask_b32 v237, v237, v6, vcc
    v_cndmask_b32 v238, v238, v6, vcc
    v_cndmask_b32 v239, v239, v6, vcc
    buffer_store_dwordx4 v[236:239], v226, s[8:11], 0 offen offset:0
    v_cvt_pk_bf16_f32 v240, v96, v97
    v_cvt_pk_bf16_f32 v241, v98, v99
    v_cvt_pk_bf16_f32 v242, v124, v125
    v_cvt_pk_bf16_f32 v243, v126, v127
    v_cndmask_b32 v240, v240, v6, vcc
    v_cndmask_b32 v241, v241, v6, vcc
    v_cndmask_b32 v242, v242, v6, vcc
    v_cndmask_b32 v243, v243, v6, vcc
    buffer_store_dwordx4 v[240:243], v226, s[8:11], 0 offen offset:1216
    s_barrier
    s_branch P1_fin
P1_epiAl:
    s_mov_b32 s54, 0x3fb8aa3b
    s_mov_b32 s55, 0x3fb8aa3b
    s_mov_b32 s50, 0x358637bd
    s_mov_b32 s51, 0x358637bd
    s_mov_b32 s52, 0.5
    s_mov_b32 s53, 0.5
    s_cmp_eq_u32 s39, 0
    s_cbranch_scc0 P1_epiA1l
    v_pk_mul_f32 v[6:7], v[36:37], s[54:55]
    v_pk_mul_f32 v[8:9], v[38:39], s[54:55]
    v_exp_f32_e64 v6, v6 clamp
    v_exp_f32_e64 v7, v7 clamp
    v_exp_f32_e64 v8, v8 clamp
    v_exp_f32_e64 v9, v9 clamp
    v_add_f32_e64 v36, v36, |v36|
    v_add_f32_e64 v37, v37, |v37|
    v_add_f32_e64 v38, v38, |v38|
    v_add_f32_e64 v39, v39, |v39|
    v_pk_fma_f32 v[36:37], v[36:37], s[52:53], v[6:7]
    v_pk_fma_f32 v[38:39], v[38:39], s[52:53], v[8:9]
    v_pk_add_f32 v[36:37], v[36:37], s[50:51]
    v_pk_add_f32 v[38:39], v[38:39], s[50:51]
    v_pk_mul_f32 v[6:7], v[64:65], s[54:55]
    v_pk_mul_f32 v[8:9], v[66:67], s[54:55]
    v_exp_f32_e64 v6, v6 clamp
    v_exp_f32_e64 v7, v7 clamp
    v_exp_f32_e64 v8, v8 clamp
    v_exp_f32_e64 v9, v9 clamp
    v_add_f32_e64 v64, v64, |v64|
    v_add_f32_e64 v65, v65, |v65|
    v_add_f32_e64 v66, v66, |v66|
    v_add_f32_e64 v67, v67, |v67|
    v_pk_fma_f32 v[64:65], v[64:65], s[52:53], v[6:7]
    v_pk_fma_f32 v[66:67], v[66:67], s[52:53], v[8:9]
    v_pk_add_f32 v[64:65], v[64:65], s[50:51]
    v_pk_add_f32 v[66:67], v[66:67], s[50:51]
    v_cvt_pk_bf16_f32 v228, v36, v37
    v_cvt_pk_bf16_f32 v229, v38, v39
    v_cvt_pk_bf16_f32 v230, v64, v65
    v_cvt_pk_bf16_f32 v231, v66, v67
    ds_write_b128 v225, v[228:231] offset:0
    v_pk_mul_f32 v[6:7], v[92:93], s[54:55]
    v_pk_mul_f32 v[8:9], v[94:95], s[54:55]
    v_exp_f32_e64 v6, v6 clamp
    v_exp_f32_e64 v7, v7 clamp
    v_exp_f32_e64 v8, v8 clamp
    v_exp_f32_e64 v9, v9 clamp
    v_add_f32_e64 v92, v92, |v92|
    v_add_f32_e64 v93, v93, |v93|
    v_add_f32_e64 v94, v94, |v94|
    v_add_f32_e64 v95, v95, |v95|
    v_pk_fma_f32 v[92:93], v[92:93], s[52:53], v[6:7]
    v_pk_fma_f32 v[94:95], v[94:95], s[52:53], v[8:9]
    v_pk_add_f32 v[92:93], v[92:93], s[50:51]
    v_pk_add_f32 v[94:95], v[94:95], s[50:51]
    v_pk_mul_f32 v[6:7], v[120:121], s[54:55]
    v_pk_mul_f32 v[8:9], v[122:123], s[54:55]
    v_exp_f32_e64 v6, v6 clamp
    v_exp_f32_e64 v7, v7 clamp
    v_exp_f32_e64 v8, v8 clamp
    v_exp_f32_e64 v9, v9 clamp
    v_add_f32_e64 v120, v120, |v120|
    v_add_f32_e64 v121, v121, |v121|
    v_add_f32_e64 v122, v122, |v122|
    v_add_f32_e64 v123, v123, |v123|
    v_pk_fma_f32 v[120:121], v[120:121], s[52:53], v[6:7]
    v_pk_fma_f32 v[122:123], v[122:123], s[52:53], v[8:9]
    v_pk_add_f32 v[120:121], v[120:121], s[50:51]
    v_pk_add_f32 v[122:123], v[122:123], s[50:51]
    v_cvt_pk_bf16_f32 v232, v92, v93
    v_cvt_pk_bf16_f32 v233, v94, v95
    v_cvt_pk_bf16_f32 v234, v120, v121
    v_cvt_pk_bf16_f32 v235, v122, v123
    ds_write_b128 v225, v[232:235] offset:2368
    v_pk_mul_f32 v[6:7], v[40:41], s[54:55]
    v_pk_mul_f32 v[8:9], v[42:43], s[54:55]
    v_exp_f32_e64 v6, v6 clamp
    v_exp_f32_e64 v7, v7 clamp
    v_exp_f32_e64 v8, v8 clamp
    v_exp_f32_e64 v9, v9 clamp
    v_add_f32_e64 v40, v40, |v40|
    v_add_f32_e64 v41, v41, |v41|
    v_add_f32_e64 v42, v42, |v42|
    v_add_f32_e64 v43, v43, |v43|
    v_pk_fma_f32 v[40:41], v[40:41], s[52:53], v[6:7]
    v_pk_fma_f32 v[42:43], v[42:43], s[52:53], v[8:9]
    v_pk_add_f32 v[40:41], v[40:41], s[50:51]
    v_pk_add_f32 v[42:43], v[42:43], s[50:51]
    v_pk_mul_f32 v[6:7], v[68:69], s[54:55]
    v_pk_mul_f32 v[8:9], v[70:71], s[54:55]
    v_exp_f32_e64 v6, v6 clamp
    v_exp_f32_e64 v7, v7 clamp
    v_exp_f32_e64 v8, v8 clamp
    v_exp_f32_e64 v9, v9 clamp
    v_add_f32_e64 v68, v68, |v68|
    v_add_f32_e64 v69, v69, |v69|
    v_add_f32_e64 v70, v70, |v70|
    v_add_f32_e64 v71, v71, |v71|
    v_pk_fma_f32 v[68:69], v[68:69], s[52:53], v[6:7]
    v_pk_fma_f32 v[70:71], v[70:71], s[52:53], v[8:9]
    v_pk_add_f32 v[68:69], v[68:69], s[50:51]
    v_pk_add_f32 v[70:71], v[70:71], s[50:51]
    v_cvt_pk_bf16_f32 v236, v40, v41
    v_cvt_pk_bf16_f32 v237, v42, v43
    v_cvt_pk_bf16_f32 v238, v68, v69
    v_cvt_pk_bf16_f32 v239, v70, v71
    ds_write_b128 v226, v[236:239] offset:0
    v_pk_mul_f32 v[6:7], v[96:97], s[54:55]
    v_pk_mul_f32 v[8:9], v[98:99], s[54:55]
    v_exp_f32_e64 v6, v6 clamp
    v_exp_f32_e64 v7, v7 clamp
    v_exp_f32_e64 v8, v8 clamp
    v_exp_f32_e64 v9, v9 clamp
    v_add_f32_e64 v96, v96, |v96|
    v_add_f32_e64 v97, v97, |v97|
    v_add_f32_e64 v98, v98, |v98|
    v_add_f32_e64 v99, v99, |v99|
    v_pk_fma_f32 v[96:97], v[96:97], s[52:53], v[6:7]
    v_pk_fma_f32 v[98:99], v[98:99], s[52:53], v[8:9]
    v_pk_add_f32 v[96:97], v[96:97], s[50:51]
    v_pk_add_f32 v[98:99], v[98:99], s[50:51]
    v_pk_mul_f32 v[6:7], v[124:125], s[54:55]
    v_pk_mul_f32 v[8:9], v[126:127], s[54:55]
    v_exp_f32_e64 v6, v6 clamp
    v_exp_f32_e64 v7, v7 clamp
    v_exp_f32_e64 v8, v8 clamp
    v_exp_f32_e64 v9, v9 clamp
    v_add_f32_e64 v124, v124, |v124|
    v_add_f32_e64 v125, v125, |v125|
    v_add_f32_e64 v126, v126, |v126|
    v_add_f32_e64 v127, v127, |v127|
    v_pk_fma_f32 v[124:125], v[124:125], s[52:53], v[6:7]
    v_pk_fma_f32 v[126:127], v[126:127], s[52:53], v[8:9]
    v_pk_add_f32 v[124:125], v[124:125], s[50:51]
    v_pk_add_f32 v[126:127], v[126:127], s[50:51]
    v_cvt_pk_bf16_f32 v240, v96, v97
    v_cvt_pk_bf16_f32 v241, v98, v99
    v_cvt_pk_bf16_f32 v242, v124, v125
    v_cvt_pk_bf16_f32 v243, v126, v127
    ds_write_b128 v226, v[240:243] offset:2368
    v_cvt_pk_bf16_f32 v228, v32, v33
    v_cvt_pk_bf16_f32 v229, v34, v35
    v_cvt_pk_bf16_f32 v230, v60, v61
    v_cvt_pk_bf16_f32 v231, v62, v63
    s_mov_b32 exec_lo, 0xff00ff
    s_mov_b32 exec_hi, 0xff00ff
    buffer_store_dwordx4 v[228:231], v224, s[8:11], 0 offen offset:0
    s_mov_b64 exec, -1
    v_pk_mul_f32 v[6:7], v[32:33], s[54:55]
    v_pk_mul_f32 v[8:9], v[34:35], s[54:55]
    v_exp_f32_e64 v6, v6 clamp
    v_exp_f32_e64 v7, v7 clamp
    v_exp_f32_e64 v8, v8 clamp
    v_exp_f32_e64 v9, v9 clamp
    v_add_f32_e64 v32, v32, |v32|
    v_add_f32_e64 v33, v33, |v33|
    v_add_f32_e64 v34, v34, |v34|
    v_add_f32_e64 v35, v35, |v35|
    v_pk_fma_f32 v[32:33], v[32:33], s[52:53], v[6:7]
    v_pk_fma_f32 v[34:35], v[34:35], s[52:53], v[8:9]
    v_pk_add_f32 v[32:33], v[32:33], s[50:51]
    v_pk_add_f32 v[34:35], v[34:35], s[50:51]
    v_pk_mul_f32 v[6:7], v[60:61], s[54:55]
    v_pk_mul_f32 v[8:9], v[62:63], s[54:55]
    v_exp_f32_e64 v6, v6 clamp
    v_exp_f32_e64 v7, v7 clamp
    v_exp_f32_e64 v8, v8 clamp
    v_exp_f32_e64 v9, v9 clamp
    v_add_f32_e64 v60, v60, |v60|
    v_add_f32_e64 v61, v61, |v61|
    v_add_f32_e64 v62, v62, |v62|
    v_add_f32_e64 v63, v63, |v63|
    v_pk_fma_f32 v[60:61], v[60:61], s[52:53], v[6:7]
    v_pk_fma_f32 v[62:63], v[62:63], s[52:53], v[8:9]
    v_pk_add_f32 v[60:61], v[60:61], s[50:51]
    v_pk_add_f32 v[62:63], v[62:63], s[50:51]
    v_cvt_pk_bf16_f32 v232, v32, v33
    v_cvt_pk_bf16_f32 v233, v34, v35
    v_cvt_pk_bf16_f32 v234, v60, v61
    v_cvt_pk_bf16_f32 v235, v62, v63
    s_mov_b32 exec_lo, 0xff00ff00
    s_mov_b32 exec_hi, 0xff00ff00
    ds_write_b128 v224, v[232:235] offset:0
    s_mov_b64 exec, -1
    v_cvt_pk_bf16_f32 v236, v88, v89
    v_cvt_pk_bf16_f32 v237, v90, v91
    v_cvt_pk_bf16_f32 v238, v116, v117
    v_cvt_pk_bf16_f32 v239, v118, v119
    s_mov_b32 exec_lo, 0xff00ff
    s_mov_b32 exec_hi, 0xff00ff
    buffer_store_dwordx4 v[236:239], v224, s[8:11], 0 offen offset:1152
    s_mov_b64 exec, -1
    v_pk_mul_f32 v[6:7], v[88:89], s[54:55]
    v_pk_mul_f32 v[8:9], v[90:91], s[54:55]
    v_exp_f32_e64 v6, v6 clamp
    v_exp_f32_e64 v7, v7 clamp
    v_exp_f32_e64 v8, v8 clamp
    v_exp_f32_e64 v9, v9 clamp
    v_add_f32_e64 v88, v88, |v88|
    v_add_f32_e64 v89, v89, |v89|
    v_add_f32_e64 v90, v90, |v90|
    v_add_f32_e64 v91, v91, |v91|
    v_pk_fma_f32 v[88:89], v[88:89], s[52:53], v[6:7]
    v_pk_fma_f32 v[90:91], v[90:91], s[52:53], v[8:9]
    v_pk_add_f32 v[88:89], v[88:89], s[50:51]
    v_pk_add_f32 v[90:91], v[90:91], s[50:51]
    v_pk_mul_f32 v[6:7], v[116:117], s[54:55]
    v_pk_mul_f32 v[8:9], v[118:119], s[54:55]
    v_exp_f32_e64 v6, v6 clamp
    v_exp_f32_e64 v7, v7 clamp
    v_exp_f32_e64 v8, v8 clamp
    v_exp_f32_e64 v9, v9 clamp
    v_add_f32_e64 v116, v116, |v116|
    v_add_f32_e64 v117, v117, |v117|
    v_add_f32_e64 v118, v118, |v118|
    v_add_f32_e64 v119, v119, |v119|
    v_pk_fma_f32 v[116:117], v[116:117], s[52:53], v[6:7]
    v_pk_fma_f32 v[118:119], v[118:119], s[52:53], v[8:9]
    v_pk_add_f32 v[116:117], v[116:117], s[50:51]
    v_pk_add_f32 v[118:119], v[118:119], s[50:51]
    v_cvt_pk_bf16_f32 v240, v88, v89
    v_cvt_pk_bf16_f32 v241, v90, v91
    v_cvt_pk_bf16_f32 v242, v116, v117
    v_cvt_pk_bf16_f32 v243, v118, v119
    s_mov_b32 exec_lo, 0xff00ff00
    s_mov_b32 exec_hi, 0xff00ff00
    ds_write_b128 v224, v[240:243] offset:2368
    s_mov_b64 exec, -1
    s_waitcnt lgkmcnt(0)
    s_barrier
    v_cvt_pk_bf16_f32 v228, v16, v17
    v_cvt_pk_bf16_f32 v229, v18, v19
    v_cvt_pk_bf16_f32 v230, v44, v45
    v_cvt_pk_bf16_f32 v231, v46, v47
    buffer_store_dwordx4 v[228:231], v220, s[8:11], 0 offen offset:0
    v_cvt_pk_bf16_f32 v232, v72, v73
    v_cvt_pk_bf16_f32 v233, v74, v75
    v_cvt_pk_bf16_f32 v234, v100, v101
    v_cvt_pk_bf16_f32 v235, v102, v103
    buffer_store_dwordx4 v[232:235], v220, s[8:11], 0 offen offset:1152
    v_cvt_pk_bf16_f32 v236, v20, v21
    v_cvt_pk_bf16_f32 v237, v22, v23
    v_cvt_pk_bf16_f32 v238, v48, v49
    v_cvt_pk_bf16_f32 v239, v50, v51
    buffer_store_dwordx4 v[236:239], v221, s[8:11], 0 offen offset:0
    v_cvt_pk_bf16_f32 v240, v76, v77
    v_cvt_pk_bf16_f32 v241, v78, v79
    v_cvt_pk_bf16_f32 v242, v104, v105
    v_cvt_pk_bf16_f32 v243, v106, v107
    buffer_store_dwordx4 v[240:243], v221, s[8:11], 0 offen offset:1152
    v_cvt_pk_bf16_f32 v228, v24, v25
    v_cvt_pk_bf16_f32 v229, v26, v27
    v_cvt_pk_bf16_f32 v230, v52, v53
    v_cvt_pk_bf16_f32 v231, v54, v55
    buffer_store_dwordx4 v[228:231], v222, s[8:11], 0 offen offset:0
    v_cvt_pk_bf16_f32 v232, v80, v81
    v_cvt_pk_bf16_f32 v233, v82, v83
    v_cvt_pk_bf16_f32 v234, v108, v109
    v_cvt_pk_bf16_f32 v235, v110, v111
    buffer_store_dwordx4 v[232:235], v222, s[8:11], 0 offen offset:1152
    v_cvt_pk_bf16_f32 v236, v28, v29
    v_cvt_pk_bf16_f32 v237, v30, v31
    v_cvt_pk_bf16_f32 v238, v56, v57
    v_cvt_pk_bf16_f32 v239, v58, v59
    buffer_store_dwordx4 v[236:239], v223, s[8:11], 0 offen offset:0
    v_cvt_pk_bf16_f32 v240, v84, v85
    v_cvt_pk_bf16_f32 v241, v86, v87
    v_cvt_pk_bf16_f32 v242, v112, v113
    v_cvt_pk_bf16_f32 v243, v114, v115
    buffer_store_dwordx4 v[240:243], v223, s[8:11], 0 offen offset:1152
    s_branch P1_epiA3l
P1_epiA1l:
    v_cmp_le_u32 vcc, 8, v2
    v_mov_b32 v12, 0x3f803f80
    v_pk_mul_f32 v[6:7], v[16:17], s[54:55]
    v_pk_mul_f32 v[8:9], v[18:19], s[54:55]
    v_exp_f32_e64 v6, v6 clamp
    v_exp_f32_e64 v7, v7 clamp
    v_exp_f32_e64 v8, v8 clamp
    v_exp_f32_e64 v9, v9 clamp
    v_add_f32_e64 v16, v16, |v16|
    v_add_f32_e64 v17, v17, |v17|
    v_add_f32_e64 v18, v18, |v18|
    v_add_f32_e64 v19, v19, |v19|
    v_pk_fma_f32 v[16:17], v[16:17], s[52:53], v[6:7]
    v_pk_fma_f32 v[18:19], v[18:19], s[52:53], v[8:9]
    v_pk_add_f32 v[16:17], v[16:17], s[50:51]
    v_pk_add_f32 v[18:19], v[18:19], s[50:51]
    v_pk_mul_f32 v[6:7], v[44:45], s[54:55]
    v_pk_mul_f32 v[8:9], v[46:47], s[54:55]
    v_exp_f32_e64 v6, v6 clamp
    v_exp_f32_e64 v7, v7 clamp
    v_exp_f32_e64 v8, v8 clamp
    v_exp_f32_e64 v9, v9 clamp
    v_add_f32_e64 v44, v44, |v44|
    v_add_f32_e64 v45, v45, |v45|
    v_add_f32_e64 v46, v46, |v46|
    v_add_f32_e64 v47, v47, |v47|
    v_pk_fma_f32 v[44:45], v[44:45], s[52:53], v[6:7]
    v_pk_fma_f32 v[46:47], v[46:47], s[52:53], v[8:9]
    v_pk_add_f32 v[44:45], v[44:45], s[50:51]
    v_pk_add_f32 v[46:47], v[46:47], s[50:51]
    v_cvt_pk_bf16_f32 v228, v16, v17
    v_cvt_pk_bf16_f32 v229, v18, v19
    v_cvt_pk_bf16_f32 v230, v44, v45
    v_cvt_pk_bf16_f32 v231, v46, v47
    ds_write_b128 v220, v[228:231] offset:0
    v_pk_mul_f32 v[6:7], v[72:73], s[54:55]
    v_pk_mul_f32 v[8:9], v[74:75], s[54:55]
    v_exp_f32_e64 v6, v6 clamp
    v_exp_f32_e64 v7, v7 clamp
    v_exp_f32_e64 v8, v8 clamp
    v_exp_f32_e64 v9, v9 clamp
    v_add_f32_e64 v72, v72, |v72|
    v_add_f32_e64 v73, v73, |v73|
    v_add_f32_e64 v74, v74, |v74|
    v_add_f32_e64 v75, v75, |v75|
    v_pk_fma_f32 v[72:73], v[72:73], s[52:53], v[6:7]
    v_pk_fma_f32 v[74:75], v[74:75], s[52:53], v[8:9]
    v_pk_add_f32 v[72:73], v[72:73], s[50:51]
    v_pk_add_f32 v[74:75], v[74:75], s[50:51]
    v_pk_mul_f32 v[6:7], v[100:101], s[54:55]
    v_pk_mul_f32 v[8:9], v[102:103], s[54:55]
    v_exp_f32_e64 v6, v6 clamp
    v_exp_f32_e64 v7, v7 clamp
    v_exp_f32_e64 v8, v8 clamp
    v_exp_f32_e64 v9, v9 clamp
    v_add_f32_e64 v100, v100, |v100|
    v_add_f32_e64 v101, v101, |v101|
    v_add_f32_e64 v102, v102, |v102|
    v_add_f32_e64 v103, v103, |v103|
    v_pk_fma_f32 v[100:101], v[100:101], s[52:53], v[6:7]
    v_pk_fma_f32 v[102:103], v[102:103], s[52:53], v[8:9]
    v_pk_add_f32 v[100:101], v[100:101], s[50:51]
    v_pk_add_f32 v[102:103], v[102:103], s[50:51]
    v_cvt_pk_bf16_f32 v232, v72, v73
    v_cvt_pk_bf16_f32 v233, v74, v75
    v_cvt_pk_bf16_f32 v234, v100, v101
    v_cvt_pk_bf16_f32 v235, v102, v103
    ds_write_b128 v220, v[232:235] offset:2368
    v_pk_mul_f32 v[6:7], v[20:21], s[54:55]
    v_pk_mul_f32 v[8:9], v[22:23], s[54:55]
    v_exp_f32_e64 v6, v6 clamp
    v_exp_f32_e64 v7, v7 clamp
    v_exp_f32_e64 v8, v8 clamp
    v_exp_f32_e64 v9, v9 clamp
    v_add_f32_e64 v20, v20, |v20|
    v_add_f32_e64 v21, v21, |v21|
    v_add_f32_e64 v22, v22, |v22|
    v_add_f32_e64 v23, v23, |v23|
    v_pk_fma_f32 v[20:21], v[20:21], s[52:53], v[6:7]
    v_pk_fma_f32 v[22:23], v[22:23], s[52:53], v[8:9]
    v_pk_add_f32 v[20:21], v[20:21], s[50:51]
    v_pk_add_f32 v[22:23], v[22:23], s[50:51]
    v_pk_mul_f32 v[6:7], v[48:49], s[54:55]
    v_pk_mul_f32 v[8:9], v[50:51], s[54:55]
    v_exp_f32_e64 v6, v6 clamp
    v_exp_f32_e64 v7, v7 clamp
    v_exp_f32_e64 v8, v8 clamp
    v_exp_f32_e64 v9, v9 clamp
    v_add_f32_e64 v48, v48, |v48|
    v_add_f32_e64 v49, v49, |v49|
    v_add_f32_e64 v50, v50, |v50|
    v_add_f32_e64 v51, v51, |v51|
    v_pk_fma_f32 v[48:49], v[48:49], s[52:53], v[6:7]
    v_pk_fma_f32 v[50:51], v[50:51], s[52:53], v[8:9]
    v_pk_add_f32 v[48:49], v[48:49], s[50:51]
    v_pk_add_f32 v[50:51], v[50:51], s[50:51]
    v_cvt_pk_bf16_f32 v236, v20, v21
    v_cvt_pk_bf16_f32 v237, v22, v23
    v_cvt_pk_bf16_f32 v238, v48, v49
    v_cvt_pk_bf16_f32 v239, v50, v51
    ds_write_b128 v221, v[236:239] offset:0
    v_pk_mul_f32 v[6:7], v[76:77], s[54:55]
    v_pk_mul_f32 v[8:9], v[78:79], s[54:55]
    v_exp_f32_e64 v6, v6 clamp
    v_exp_f32_e64 v7, v7 clamp
    v_exp_f32_e64 v8, v8 clamp
    v_exp_f32_e64 v9, v9 clamp
    v_add_f32_e64 v76, v76, |v76|
    v_add_f32_e64 v77, v77, |v77|
    v_add_f32_e64 v78, v78, |v78|
    v_add_f32_e64 v79, v79, |v79|
    v_pk_fma_f32 v[76:77], v[76:77], s[52:53], v[6:7]
    v_pk_fma_f32 v[78:79], v[78:79], s[52:53], v[8:9]
    v_pk_add_f32 v[76:77], v[76:77], s[50:51]
    v_pk_add_f32 v[78:79], v[78:79], s[50:51]
    v_pk_mul_f32 v[6:7], v[104:105], s[54:55]
    v_pk_mul_f32 v[8:9], v[106:107], s[54:55]
    v_exp_f32_e64 v6, v6 clamp
    v_exp_f32_e64 v7, v7 clamp
    v_exp_f32_e64 v8, v8 clamp
    v_exp_f32_e64 v9, v9 clamp
    v_add_f32_e64 v104, v104, |v104|
    v_add_f32_e64 v105, v105, |v105|
    v_add_f32_e64 v106, v106, |v106|
    v_add_f32_e64 v107, v107, |v107|
    v_pk_fma_f32 v[104:105], v[104:105], s[52:53], v[6:7]
    v_pk_fma_f32 v[106:107], v[106:107], s[52:53], v[8:9]
    v_pk_add_f32 v[104:105], v[104:105], s[50:51]
    v_pk_add_f32 v[106:107], v[106:107], s[50:51]
    v_cvt_pk_bf16_f32 v240, v76, v77
    v_cvt_pk_bf16_f32 v241, v78, v79
    v_cvt_pk_bf16_f32 v242, v104, v105
    v_cvt_pk_bf16_f32 v243, v106, v107
    ds_write_b128 v221, v[240:243] offset:2368
    v_cvt_pk_bf16_f32 v228, v24, v25
    v_cvt_pk_bf16_f32 v229, v26, v27
    v_cvt_pk_bf16_f32 v230, v52, v53
    v_cvt_pk_bf16_f32 v231, v54, v55
    ds_write_b128 v222, v[228:231] offset:0
    v_cvt_pk_bf16_f32 v232, v80, v81
    v_cvt_pk_bf16_f32 v233, v82, v83
    v_cvt_pk_bf16_f32 v234, v108, v109
    v_cvt_pk_bf16_f32 v235, v110, v111
    ds_write_b128 v222, v[232:235] offset:2368
    v_cvt_pk_bf16_f32 v236, v28, v29
    v_cvt_pk_bf16_f32 v237, v30, v31
    v_cvt_pk_bf16_f32 v238, v56, v57
    v_cvt_pk_bf16_f32 v239, v58, v59
    ds_write_b128 v223, v[236:239] offset:0
    v_cvt_pk_bf16_f32 v240, v84, v85
    v_cvt_pk_bf16_f32 v241, v86, v87
    v_cvt_pk_bf16_f32 v242, v112, v113
    v_cvt_pk_bf16_f32 v243, v114, v115
    ds_write_b128 v223, v[240:243] offset:2368
    v_cvt_pk_bf16_f32 v228, v32, v33
    v_cvt_pk_bf16_f32 v229, v34, v35
    v_cvt_pk_bf16_f32 v230, v60, v61
    v_cvt_pk_bf16_f32 v231, v62, v63
    ds_write_b128 v224, v[228:231] offset:0
    v_cvt_pk_bf16_f32 v232, v88, v89
    v_cvt_pk_bf16_f32 v233, v90, v91
    v_cvt_pk_bf16_f32 v234, v116, v117
    v_cvt_pk_bf16_f32 v235, v118, v119
    ds_write_b128 v224, v[232:235] offset:2368
    v_cvt_pk_bf16_f32 v236, v36, v37
    v_cvt_pk_bf16_f32 v237, v38, v39
    v_cvt_pk_bf16_f32 v238, v64, v65
    v_cvt_pk_bf16_f32 v239, v66, v67
    ds_write_b128 v225, v[236:239] offset:0
    v_cvt_pk_bf16_f32 v240, v92, v93
    v_cvt_pk_bf16_f32 v241, v94, v95
    v_cvt_pk_bf16_f32 v242, v120, v121
    v_cvt_pk_bf16_f32 v243, v122, v123
    ds_write_b128 v225, v[240:243] offset:2368
    v_cvt_pk_bf16_f32 v228, v40, v41
    v_cvt_pk_bf16_f32 v229, v42, v43
    v_cvt_pk_bf16_f32 v230, v68, v69
    v_cvt_pk_bf16_f32 v231, v70, v71
    v_cndmask_b32 v228, v228, v12, vcc
    v_cndmask_b32 v229, v229, v12, vcc
    v_cndmask_b32 v230, v230, v12, vcc
    v_cndmask_b32 v231, v231, v12, vcc
    s_mov_b32 exec_lo, 0xfff0fff
    s_mov_b32 exec_hi, 0xfff0fff
    ds_write_b128 v226, v[228:231] offset:0
    s_mov_b64 exec, -1
    v_cvt_pk_bf16_f32 v232, v96, v97
    v_cvt_pk_bf16_f32 v233, v98, v99
    v_cvt_pk_bf16_f32 v234, v124, v125
    v_cvt_pk_bf16_f32 v235, v126, v127
    v_cndmask_b32 v232, v232, v12, vcc
    v_cndmask_b32 v233, v233, v12, vcc
    v_cndmask_b32 v234, v234, v12, vcc
    v_cndmask_b32 v235, v235, v12, vcc
    s_mov_b32 exec_lo, 0xfff0fff
    s_mov_b32 exec_hi, 0xfff0fff
    ds_write_b128 v226, v[232:235] offset:2368
    s_mov_b64 exec, -1
P1_epiA2l:
    s_waitcnt lgkmcnt(0)
    s_barrier
P1_epiA3l:
    v_and_b32 v2, 31, v1
    v_lshrrev_b32 v3, 5, v1
    v_min_u32 v4, 17, v2
    v_min_u32 v5, 18, v2
    s_mul_i32 s40, s3, 9472
    v_mul_u32_u24 v6, 288, v3
    v_lshlrev_b32 v4, 4, v4
    v_add3_u32 v4, v4, v6, s40
    v_mul_u32_u24 v6, 304, v3
    v_lshlrev_b32 v5, 4, v5
    v_add3_u32 v5, v5, v6, s40
    ds_read_b128 v[16:19], v4 offset:0
    ds_read_b128 v[48:51], v5 offset:1152
    ds_read_b128 v[20:23], v4 offset:576
    ds_read_b128 v[52:55], v5 offset:1760
    ds_read_b128 v[24:27], v4 offset:2368
    ds_read_b128 v[56:59], v5 offset:3520
    ds_read_b128 v[28:31], v4 offset:2944
    ds_read_b128 v[60:63], v5 offset:4128
    ds_read_b128 v[32:35], v4 offset:4736
    ds_read_b128 v[64:67], v5 offset:5888
    ds_read_b128 v[36:39], v4 offset:5312
    ds_read_b128 v[68:71], v5 offset:6496
    ds_read_b128 v[40:43], v4 offset:7104
    ds_read_b128 v[72:75], v5 offset:8256
    ds_read_b128 v[44:47], v4 offset:7680
    ds_read_b128 v[76:79], v5 offset:8864
    s_lshl_b32 s40, s32, 5
    s_lshl_b32 s41, s33, 2
    s_add_u32 s40, s40, s41
    s_add_u32 s40, s40, s3
    s_mul_i32 s40, s40, 1520
    s_add_u32 s40, s40, 9568256
    v_mul_u32_u24 v10, 80, v2
    v_lshlrev_b32 v11, 4, v3
    v_add3_u32 v10, v10, v11, s40
    v_mov_b32 v12, 1073741824
    v_cmp_gt_u32 vcc, 19, v2
    s_nop 1
    v_cndmask_b32 v10, v12, v10, vcc
    v_cmp_eq_u32 vcc, 0, v3
    s_nop 1
    v_cndmask_b32 v11, v12, v10, vcc
    s_waitcnt lgkmcnt(0)
    v_mfma_f32_32x32x16_bf16 v[80:95], v[16:19], v[48:51], 0
    v_mfma_f32_32x32x16_bf16 v[80:95], v[20:23], v[52:55], v[80:95]
    v_mfma_f32_32x32x16_bf16 v[80:95], v[24:27], v[56:59], v[80:95]
    v_mfma_f32_32x32x16_bf16 v[80:95], v[28:31], v[60:63], v[80:95]
    v_mfma_f32_32x32x16_bf16 v[80:95], v[32:35], v[64:67], v[80:95]
    v_mfma_f32_32x32x16_bf16 v[80:95], v[36:39], v[68:71], v[80:95]
    v_mfma_f32_32x32x16_bf16 v[80:95], v[40:43], v[72:75], v[80:95]
    v_mfma_f32_32x32x16_bf16 v[80:95], v[44:47], v[76:79], v[80:95]
    s_nop 11
    buffer_store_dwordx4 v[80:83], v10, s[8:11], 0 offen
    buffer_store_dwordx4 v[84:87], v10, s[8:11], 0 offen offset:32
    buffer_store_dwordx2 v[88:89], v11, s[8:11], 0 offen offset:64
    s_branch P1_fin
P1_loader:
    s_sub_u32 s38, s3, 4
    v_lshrrev_b32 v2, 3, v1
    v_and_b32 v3, 7, v1
    v_lshrrev_b32 v4, 4, v1
    v_xor_b32 v3, v3, v4
    v_mul_u32_u24 v5, 1152, v2
    v_lshlrev_b32 v6, 4, v3
    v_add_u32 v10, v5, v6
    v_xor_b32 v3, 4, v3
    v_lshlrev_b32 v6, 4, v3
    v_add_u32 v11, v5, v6
    s_lshl_b32 s45, s32, 7
    s_lshl_b32 s46, s38, 5
    s_add_u32 s45, s45, s46
    s_mul_i32 s40, s45, 1152
    s_mul_i32 s45, s38, 55296
    s_mul_i32 s46, s33, 144
    s_add_u32 s41, s45, s46
    s_lshl_b32 s42, s38, 12
    s_mul_i32 s43, s38, 7168
    s_add_u32 s43, s43, 16384
    s_mov_b32 s47, 0
    s_add_u32 s48, s47, s42
    s_add_u32 m0, s48, 0
    s_add_u32 s49, s40, 0
    buffer_load_dwordx4 v10, s[12:15], s49 offen lds
    s_add_u32 m0, s48, 1024
    s_add_u32 s49, s40, 18432
    buffer_load_dwordx4 v11, s[12:15], s49 offen lds
    s_add_u32 m0, s48, 2048
    s_add_u32 s49, s40, 9216
    buffer_load_dwordx4 v10, s[12:15], s49 offen lds
    s_add_u32 m0, s48, 3072
    s_add_u32 s49, s40, 27648
    buffer_load_dwordx4 v11, s[12:15], s49 offen lds
    v_add_u32 v2, 0, v1
    v_mul_u32_u24 v3, 2341, v2
    v_lshrrev_b32 v3, 16, v3
    v_mul_u32_u24 v4, 28, v3
    v_sub_u32 v4, v2, v4
    v_and_b32 v5, 8, v3
    v_lshrrev_b32 v5, 2, v5
    v_xor_b32 v4, v4, v5
    v_mul_u32_u24 v5, 7282, v4
    v_lshrrev_b32 v5, 16, v5
    v_mul_u32_u24 v6, 9, v5
    v_sub_u32 v6, v4, v6
    v_mul_u32_u24 v3, 3456, v3
    v_mul_u32_u24 v5, 1152, v5
    v_lshlrev_b32 v6, 4, v6
    v_cmp_eq_u32 vcc, 27, v4
    v_add3_u32 v3, v3, v5, v6
    v_mov_b32 v5, 1073741824
    v_cndmask_b32 v12, v3, v5, vcc
    s_add_u32 s48, s47, s43
    s_add_u32 m0, s48, 0
    s_nop 0
    buffer_load_dwordx4 v12, s[16:19], s41 offen lds
    v_add_u32 v2, 64, v1
    v_mul_u32_u24 v3, 2341, v2
    v_lshrrev_b32 v3, 16, v3
    v_mul_u32_u24 v4, 28, v3
    v_sub_u32 v4, v2, v4
    v_and_b32 v5, 8, v3
    v_lshrrev_b32 v5, 2, v5
    v_xor_b32 v4, v4, v5
    v_mul_u32_u24 v5, 7282, v4
    v_lshrrev_b32 v5, 16, v5
    v_mul_u32_u24 v6, 9, v5
    v_sub_u32 v6, v4, v6
    v_mul_u32_u24 v3, 3456, v3
    v_mul_u32_u24 v5, 1152, v5
    v_lshlrev_b32 v6, 4, v6
    v_cmp_eq_u32 vcc, 27, v4
    v_add3_u32 v3, v3, v5, v6
    v_mov_b32 v5, 1073741824
    v_cndmask_b32 v13, v3, v5, vcc
    s_add_u32 s48, s47, s43
    s_add_u32 m0, s48, 1024
    s_nop 0
    buffer_load_dwordx4 v13, s[16:19], s41 offen lds
    v_add_u32 v2, 128, v1
    v_mul_u32_u24 v3, 2341, v2
    v_lshrrev_b32 v3, 16, v3
    v_mul_u32_u24 v4, 28, v3
    v_sub_u32 v4, v2, v4
    v_and_b32 v5, 8, v3
    v_lshrrev_b32 v5, 2, v5
    v_xor_b32 v4, v4, v5
    v_mul_u32_u24 v5, 7282, v4
    v_lshrrev_b32 v5, 16, v5
    v_mul_u32_u24 v6, 9, v5
    v_sub_u32 v6, v4, v6
    v_mul_u32_u24 v3, 3456, v3
    v_mul_u32_u24 v5, 1152, v5
    v_lshlrev_b32 v6, 4, v6
    v_cmp_eq_u32 vcc, 27, v4
    v_add3_u32 v3, v3, v5, v6
    v_mov_b32 v5, 1073741824
    v_cndmask_b32 v14, v3, v5, vcc
    s_add_u32 s48, s47, s43
    s_add_u32 m0, s48, 2048
    s_nop 0
    buffer_load_dwordx4 v14, s[16:19], s41 offen lds
    v_add_u32 v2, 192, v1
    v_mul_u32_u24 v3, 2341, v2
    v_lshrrev_b32 v3, 16, v3
    v_mul_u32_u24 v4, 28, v3
    v_sub_u32 v4, v2, v4
    v_and_b32 v5, 8, v3
    v_lshrrev_b32 v5, 2, v5
    v_xor_b32 v4, v4, v5
    v_mul_u32_u24 v5, 7282, v4
    v_lshrrev_b32 v5, 16, v5
    v_mul_u32_u24 v6, 9, v5
    v_sub_u32 v6, v4, v6
    v_mul_u32_u24 v3, 3456, v3
    v_mul_u32_u24 v5, 1152, v5
    v_lshlrev_b32 v6, 4, v6
    v_cmp_eq_u32 vcc, 27, v4
    v_add3_u32 v3, v3, v5, v6
    v_mov_b32 v5, 1073741824
    v_cndmask_b32 v15, v3, v5, vcc
    s_add_u32 s48, s47, s43
    s_add_u32 m0, s48, 3072
    s_nop 0
    buffer_load_dwordx4 v15, s[16:19], s41 offen lds
    v_add_u32 v2, 256, v1
    v_mul_u32_u24 v3, 2341, v2
    v_lshrrev_b32 v3, 16, v3
    v_mul_u32_u24 v4, 28, v3
    v_sub_u32 v4, v2, v4
    v_and_b32 v5, 8, v3
    v_lshrrev_b32 v5, 2, v5
    v_xor_b32 v4, v4, v5
    v_mul_u32_u24 v5, 7282, v4
    v_lshrrev_b32 v5, 16, v5
    v_mul_u32_u24 v6, 9, v5
    v_sub_u32 v6, v4, v6
    v_mul_u32_u24 v3, 3456, v3
    v_mul_u32_u24 v5, 1152, v5
    v_lshlrev_b32 v6, 4, v6
    v_cmp_eq_u32 vcc, 27, v4
    v_add3_u32 v3, v3, v5, v6
    v_mov_b32 v5, 1073741824
    v_cndmask_b32 v16, v3, v5, vcc
    s_add_u32 s48, s47, s43
    s_add_u32 m0, s48, 4096
    s_nop 0
    buffer_load_dwordx4 v16, s[16:19], s41 offen lds
    v_add_u32 v2, 320, v1
    v_mul_u32_u24 v3, 2341, v2
    v_lshrrev_b32 v3, 16, v3
    v_mul_u32_u24 v4, 28, v3
    v_sub_u32 v4, v2, v4
    v_and_b32 v5, 8, v3
    v_lshrrev_b32 v5, 2, v5
    v_xor_b32 v4, v4, v5
    v_mul_u32_u24 v5, 7282, v4
    v_lshrrev_b32 v5, 16, v5
    v_mul_u32_u24 v6, 9, v5
    v_sub_u32 v6, v4, v6
    v_mul_u32_u24 v3, 3456, v3
    v_mul_u32_u24 v5, 1152, v5
    v_lshlrev_b32 v6, 4, v6
    v_cmp_eq_u32 vcc, 27, v4
    v_add3_u32 v3, v3, v5, v6
    v_mov_b32 v5, 1073741824
    v_cndmask_b32 v17, v3, v5, vcc
    s_add_u32 s48, s47, s43
    s_add_u32 m0, s48, 5120
    s_nop 0
    buffer_load_dwordx4 v17, s[16:19], s41 offen lds
    v_add_u32 v2, 384, v1
    v_mul_u32_u24 v3, 2341, v2
    v_lshrrev_b32 v3, 16, v3
    v_mul_u32_u24 v4, 28, v3
    v_sub_u32 v4, v2, v4
    v_and_b32 v5, 8, v3
    v_lshrrev_b32 v5, 2, v5
    v_xor_b32 v4, v4, v5
    v_mul_u32_u24 v5, 7282, v4
    v_lshrrev_b32 v5, 16, v5
    v_mul_u32_u24 v6, 9, v5
    v_sub_u32 v6, v4, v6
    v_mul_u32_u24 v3, 3456, v3
    v_mul_u32_u24 v5, 1152, v5
    v_lshlrev_b32 v6, 4, v6
    v_cmp_eq_u32 vcc, 27, v4
    v_add3_u32 v3, v3, v5, v6
    v_mov_b32 v5, 1073741824
    v_cndmask_b32 v18, v3, v5, vcc
    s_add_u32 s48, s47, s43
    s_add_u32 m0, s48, 6144
    s_nop 0
    buffer_load_dwordx4 v18, s[16:19], s41 offen lds
    s_add_u32 s40, s40, 128
    s_add_u32 s41, s41, 221184
    s_add_u32 s47, s47, 45056
    s_cmp_eq_u32 s47, 135168
    s_cselect_b32 s47, 0, s47
    s_add_u32 s48, s47, s42
    s_add_u32 m0, s48, 0
    s_add_u32 s49, s40, 0
    buffer_load_dwordx4 v10, s[12:15], s49 offen lds
    s_add_u32 m0, s48, 1024
    s_add_u32 s49, s40, 18432
    buffer_load_dwordx4 v11, s[12:15], s49 offen lds
    s_add_u32 m0, s48, 2048
    s_add_u32 s49, s40, 9216
    buffer_load_dwordx4 v10, s[12:15], s49 offen lds
    s_add_u32 m0, s48, 3072
    s_add_u32 s49, s40, 27648
    buffer_load_dwordx4 v11, s[12:15], s49 offen lds
    s_add_u32 s48, s47, s43
    s_add_u32 m0, s48, 0
    s_nop 0
    buffer_load_dwordx4 v12, s[16:19], s41 offen lds
    s_add_u32 m0, s48, 1024
    s_nop 0
    buffer_load_dwordx4 v13, s[16:19], s41 offen lds
    s_add_u32 m0, s48, 2048
    s_nop 0
    buffer_load_dwordx4 v14, s[16:19], s41 offen lds
    s_add_u32 m0, s48, 3072
    s_nop 0
    buffer_load_dwordx4 v15, s[16:19], s41 offen lds
    s_add_u32 m0, s48, 4096
    s_nop 0
    buffer_load_dwordx4 v16, s[16:19], s41 offen lds
    s_add_u32 m0, s48, 5120
    s_nop 0
    buffer_load_dwordx4 v17, s[16:19], s41 offen lds
    s_add_u32 m0, s48, 6144
    s_nop 0
    buffer_load_dwordx4 v18, s[16:19], s41 offen lds
    s_add_u32 s40, s40, 128
    s_add_u32 s41, s41, 221184
    s_add_u32 s47, s47, 45056
    s_cmp_eq_u32 s47, 135168
    s_cselect_b32 s47, 0, s47
    s_waitcnt vmcnt(11)
    s_barrier
    s_mov_b32 s44, 0
P1_lloop:
    s_add_u32 s48, s47, s42
    s_add_u32 m0, s48, 0
    s_add_u32 s49, s40, 0
    buffer_load_dwordx4 v10, s[12:15], s49 offen lds
    s_add_u32 m0, s48, 1024
    s_add_u32 s49, s40, 18432
    buffer_load_dwordx4 v11, s[12:15], s49 offen lds
    s_add_u32 m0, s48, 2048
    s_add_u32 s49, s40, 9216
    buffer_load_dwordx4 v10, s[12:15], s49 offen lds
    s_add_u32 m0, s48, 3072
    s_add_u32 s49, s40, 27648
    buffer_load_dwordx4 v11, s[12:15], s49 offen lds
    s_add_u32 s48, s47, s43
    s_add_u32 m0, s48, 0
    s_nop 0
    buffer_load_dwordx4 v12, s[16:19], s41 offen lds
    s_add_u32 m0, s48, 1024
    s_nop 0
    buffer_load_dwordx4 v13, s[16:19], s41 offen lds
    s_add_u32 m0, s48, 2048
    s_nop 0
    buffer_load_dwordx4 v14, s[16:19], s41 offen lds
    s_add_u32 m0, s48, 3072
    s_nop 0
    buffer_load_dwordx4 v15, s[16:19], s41 offen lds
    s_add_u32 m0, s48, 4096
    s_nop 0
    buffer_load_dwordx4 v16, s[16:19], s41 offen lds
    s_add_u32 m0, s48, 5120
    s_nop 0
    buffer_load_dwordx4 v17, s[16:19], s41 offen lds
    s_add_u32 m0, s48, 6144
    s_nop 0
    buffer_load_dwordx4 v18, s[16:19], s41 offen lds
    s_add_u32 s40, s40, 128
    s_add_u32 s41, s41, 221184
    s_add_u32 s47, s47, 45056
    s_cmp_eq_u32 s47, 135168
    s_cselect_b32 s47, 0, s47
    s_waitcnt vmcnt(11)
    s_barrier
    s_add_u32 s44, s44, 1
    s_cmp_lt_u32 s44, 7
    s_cbranch_scc1 P1_lloop
    v_lshlrev_b32 v24, 2, v1
    s_lshl_b32 s40, s29, 4
    s_add_u32 s40, s40, 128
    v_mov_b32 v25, 1073741824
    v_cmp_gt_u32 vcc, 4, v1
    s_nop 1
    v_cndmask_b32 v24, v25, v24, vcc
    buffer_load_dword v26, v24, s[20:23], s40 offen sc1
    v_mov_b32 v30, 0
    buffer_load_dword v31, v30, s[20:23], 0 offen sc1
    s_lshl_b32 s40, s30, 2
    s_add_u32 s40, s40, s38
    s_add_u32 s41, s40, 128
    s_mul_i32 s42, s29, 180
    s_cmp_ge_u32 s41, 180
    s_cselect_b32 s41, 1440, s41
    s_cselect_b32 s43, 0, s42
    s_add_u32 s40, s40, s42
    s_add_u32 s41, s41, s43
    v_and_b32 v2, 15, v1
    v_lshrrev_b32 v3, 4, v1
    v_lshrrev_b32 v4, 2, v2
    v_lshlrev_b32 v4, 3, v4
    v_and_b32 v5, 3, v2
    v_add_u32 v4, v4, v5
    v_add_u32 v5, 64, v2
    v_lshrrev_b32 v6, 1, v3
    v_mul_u32_u24 v6, 18, v6
    v_and_b32 v7, 1, v3
    v_lshl_add_u32 v6, v7, 2, v6
    v_mul_u32_u24 v7, 72, v3
    v_add_u32 v7, 16, v7
    s_mul_hi_u32 s42, s40, 23860930
    s_mul_i32 s43, s42, 180
    s_sub_u32 s43, s40, s43
    s_mul_hi_u32 s44, s43, 858993460
    s_mul_i32 s45, s44, 5
    s_sub_u32 s45, s43, s45
    s_cmp_ge_u32 s44, 18
    s_cselect_b32 s46, 18, 0
    s_cselect_b32 s20, s66, s60
    s_cselect_b32 s21, s67, s61
    s_and_b32 s21, s21, 0xffff
    s_mov_b32 s22, 663552
    s_mov_b32 s23, 0x00020000
    s_sub_u32 s44, s44, s46
    s_lshr_b32 s46, s45, 1
    s_lshl_b32 s46, s46, 5
    s_and_b32 s47, s45, 1
    s_lshl_b32 s47, s47, 2
    s_add_u32 s46, s46, s47
    v_add_u32 v8, s46, v4
    s_cmp_eq_u32 s45, 4
    s_cselect_b64 vcc, -1, 0
    v_cndmask_b32 v8, v8, v5, vcc
    s_mul_i32 s46, s42, 72
    v_add_u32 v8, s46, v8
    s_add_u32 s46, s46, 72
    v_cmp_gt_u32 s[48:49], s46, v8
    s_mul_i32 s46, s44, 36
    s_sub_u32 s47, s44, 16
    s_mul_i32 s47, s47, 288
    s_cmp_ge_u32 s44, 16
    s_cselect_b32 s46, s47, s46
    s_cselect_b64 vcc, -1, 0
    v_cndmask_b32 v9, v6, v7, vcc
    v_add_u32 v9, s46, v9
    v_mul_u32_u24 v9, 1152, v9
    v_lshl_add_u32 v9, v8, 1, v9
    v_mov_b32 v10, 1073741824
    v_cndmask_b32 v9, v10, v9, s[48:49]
    s_cmp_ge_u32 s40, 1440
    s_cselect_b64 vcc, -1, 0
    v_cndmask_b32 v20, v9, v10, vcc
    s_cmp_ge_u32 s44, 16
    s_mov_b32 s47, 0
    s_cselect_b32 s47, 0, s47
    buffer_load_ushort v32, v20, s[20:23], s47 offen
    s_cmp_ge_u32 s44, 16
    s_mov_b32 s47, 1152
    s_cselect_b32 s47, 1152, s47
    buffer_load_ushort v36, v20, s[20:23], s47 offen
    s_cmp_ge_u32 s44, 16
    s_mov_b32 s47, 2304
    s_cselect_b32 s47, 20736, s47
    buffer_load_ushort v33, v20, s[20:23], s47 offen
    s_cmp_ge_u32 s44, 16
    s_mov_b32 s47, 3456
    s_cselect_b32 s47, 21888, s47
    buffer_load_ushort v37, v20, s[20:23], s47 offen
    s_cmp_ge_u32 s44, 16
    s_mov_b32 s47, 9216
    s_cselect_b32 s47, 41472, s47
    buffer_load_ushort v34, v20, s[20:23], s47 offen
    s_cmp_ge_u32 s44, 16
    s_mov_b32 s47, 10368
    s_cselect_b32 s47, 42624, s47
    buffer_load_ushort v38, v20, s[20:23], s47 offen
    s_cmp_ge_u32 s44, 16
    s_mov_b32 s47, 11520
    s_cselect_b32 s47, 62208, s47
    buffer_load_ushort v35, v20, s[20:23], s47 offen
    s_cmp_ge_u32 s44, 16
    s_mov_b32 s47, 12672
    s_cselect_b32 s47, 63360, s47
    buffer_load_ushort v39, v20, s[20:23], s47 offen
    s_mul_hi_u32 s42, s41, 23860930
    s_mul_i32 s43, s42, 180
    s_sub_u32 s43, s41, s43
    s_mul_hi_u32 s44, s43, 858993460
    s_mul_i32 s45, s44, 5
    s_sub_u32 s45, s43, s45
    s_cmp_ge_u32 s44, 18
    s_cselect_b32 s46, 18, 0
    s_cselect_b32 s24, s66, s60
    s_cselect_b32 s25, s67, s61
    s_and_b32 s25, s25, 0xffff
    s_mov_b32 s26, 663552
    s_mov_b32 s27, 0x00020000
    s_sub_u32 s44, s44, s46
    s_lshr_b32 s46, s45, 1
    s_lshl_b32 s46, s46, 5
    s_and_b32 s47, s45, 1
    s_lshl_b32 s47, s47, 2
    s_add_u32 s46, s46, s47
    v_add_u32 v8, s46, v4
    s_cmp_eq_u32 s45, 4
    s_cselect_b64 vcc, -1, 0
    v_cndmask_b32 v8, v8, v5, vcc
    s_mul_i32 s46, s42, 72
    v_add_u32 v8, s46, v8
    s_add_u32 s46, s46, 72
    v_cmp_gt_u32 s[48:49], s46, v8
    s_mul_i32 s46, s44, 36
    s_sub_u32 s47, s44, 16
    s_mul_i32 s47, s47, 288
    s_cmp_ge_u32 s44, 16
    s_cselect_b32 s46, s47, s46
    s_cselect_b64 vcc, -1, 0
    v_cndmask_b32 v9, v6, v7, vcc
    v_add_u32 v9, s46, v9
    v_mul_u32_u24 v9, 1152, v9
    v_lshl_add_u32 v9, v8, 1, v9
    v_mov_b32 v10, 1073741824
    v_cndmask_b32 v9, v10, v9, s[48:49]
    s_cmp_ge_u32 s41, 1440
    s_cselect_b64 vcc, -1, 0
    v_cndmask_b32 v21, v9, v10, vcc
    s_cmp_ge_u32 s44, 16
    s_mov_b32 s47, 0
    s_cselect_b32 s47, 0, s47
    buffer_load_ushort v40, v21, s[24:27], s47 offen
    s_cmp_ge_u32 s44, 16
    s_mov_b32 s47, 1152
    s_cselect_b32 s47, 1152, s47
    buffer_load_ushort v44, v21, s[24:27], s47 offen
    s_cmp_ge_u32 s44, 16
    s_mov_b32 s47, 2304
    s_cselect_b32 s47, 20736, s47
    buffer_load_ushort v41, v21, s[24:27], s47 offen
    s_cmp_ge_u32 s44, 16
    s_mov_b32 s47, 3456
    s_cselect_b32 s47, 21888, s47
    buffer_load_ushort v45, v21, s[24:27], s47 offen
    s_cmp_ge_u32 s44, 16
    s_mov_b32 s47, 9216
    s_cselect_b32 s47, 41472, s47
    buffer_load_ushort v42, v21, s[24:27], s47 offen
    s_cmp_ge_u32 s44, 16
    s_mov_b32 s47, 10368
    s_cselect_b32 s47, 42624, s47
    buffer_load_ushort v46, v21, s[24:27], s47 offen
    s_cmp_ge_u32 s44, 16
    s_mov_b32 s47, 11520
    s_cselect_b32 s47, 62208, s47
    buffer_load_ushort v43, v21, s[24:27], s47 offen
    s_cmp_ge_u32 s44, 16
    s_mov_b32 s47, 12672
    s_cselect_b32 s47, 63360, s47
    buffer_load_ushort v47, v21, s[24:27], s47 offen
    s_mov_b32 s44, s68
    s_and_b32 s45, s69, 0xffff
    s_mov_b32 s46, 1152
    s_mov_b32 s47, 0x00020000
    s_lshl_b32 s42, s2, 3
    s_lshl_b32 s43, s38, 1
    s_add_u32 s42, s42, s43
    s_mul_i32 s43, s42, 1152
    v_lshlrev_b32 v11, 4, v1
    v_add_u32 v12, 1024, v11
    v_mov_b32 v10, 1073741824
    v_cmp_gt_u32 vcc, 8, v1
    s_nop 1
    v_cndmask_b32 v12, v10, v12, vcc
    buffer_load_dwordx4 v[48:51], v11, s[12:15], s43 offen
    buffer_load_dwordx4 v[52:55], v12, s[12:15], s43 offen
    s_add_u32 s43, s43, 1152
    buffer_load_dwordx4 v[56:59], v11, s[12:15], s43 offen
    buffer_load_dwordx4 v[60:63], v12, s[12:15], s43 offen
    buffer_load_dwordx4 v[64:67], v11, s[44:47], 0 offen
    buffer_load_dwordx4 v[68:71], v12, s[44:47], 0 offen
    v_lshlrev_b32 v27, 20, v1
    v_mov_b32 v28, 1073741824
    v_cmp_gt_u32 vcc, 16, v1
    s_nop 1
    v_cndmask_b32 v27, v28, v27, vcc
    buffer_load_dword v29, v27, s[8:11], 0 offen
    s_waitcnt vmcnt(23)
    s_getreg_b32 s48, hwreg(HW_REG_XCC_ID, 0, 4)
    s_add_u32 s48, s48, 1
    s_mul_i32 s48, s48, 0x11111111
    v_cmp_eq_u32 vcc, s48, v26
    s_nop 3
    s_and_b32 s48, vcc_lo, 15
    s_cmp_eq_u32 s48, 15
    s_cselect_b32 s48, 1, 0
    s_and_b32 s48, s48, 1
    v_mov_b32 v24, 163812
    v_mov_b32 v25, s48
    ds_write_b32 v24, v25
    s_waitcnt lgkmcnt(0)
    s_barrier
    s_barrier
    s_waitcnt vmcnt(0)
    v_lshl_or_b32 v32, v36, 16, v32
    v_lshl_or_b32 v33, v37, 16, v33
    v_lshl_or_b32 v34, v38, 16, v34
    v_lshl_or_b32 v35, v39, 16, v35
    s_lshl_b32 s43, s40, 10
    s_add_u32 s43, s43, 15073280
    s_cmp_ge_u32 s40, 1440
    s_cselect_b32 s43, 1073741824, s43
    buffer_store_dwordx4 v[32:35], v11, s[8:11], s43 offen sc1
    v_lshl_or_b32 v40, v44, 16, v40
    v_lshl_or_b32 v41, v45, 16, v41
    v_lshl_or_b32 v42, v46, 16, v42
    v_lshl_or_b32 v43, v47, 16, v43
    s_lshl_b32 s43, s41, 10
    s_add_u32 s43, s43, 15073280
    s_cmp_ge_u32 s41, 1440
    s_cselect_b32 s43, 1073741824, s43
    buffer_store_dwordx4 v[40:43], v11, s[8:11], s43 offen sc1
    v_mov_b32 v8, 0
    v_mov_b32 v9, 0
    v_dot2c_f32_bf16 v8, v48, v64
    v_dot2c_f32_bf16 v8, v49, v65
    v_dot2c_f32_bf16 v8, v50, v66
    v_dot2c_f32_bf16 v8, v51, v67
    v_dot2c_f32_bf16 v8, v52, v68
    v_dot2c_f32_bf16 v8, v53, v69
    v_dot2c_f32_bf16 v8, v54, v70
    v_dot2c_f32_bf16 v8, v55, v71
    v_dot2c_f32_bf16 v9, v56, v64
    v_dot2c_f32_bf16 v9, v57, v65
    v_dot2c_f32_bf16 v9, v58, v66
    v_dot2c_f32_bf16 v9, v59, v67
    v_dot2c_f32_bf16 v9, v60, v68
    v_dot2c_f32_bf16 v9, v61, v69
    v_dot2c_f32_bf16 v9, v62, v70
    v_dot2c_f32_bf16 v9, v63, v71
    s_nop 3
    v_add_f32_dpp v8, v8, v8 quad_perm:[1,0,3,2] row_mask:0xf bank_mask:0xf
    v_add_f32_dpp v9, v9, v9 quad_perm:[1,0,3,2] row_mask:0xf bank_mask:0xf
    s_nop 0
    v_add_f32_dpp v8, v8, v8 quad_perm:[2,3,0,1] row_mask:0xf bank_mask:0xf
    v_add_f32_dpp v9, v9, v9 quad_perm:[2,3,0,1] row_mask:0xf bank_mask:0xf
    s_nop 0
    v_add_f32_dpp v8, v8, v8 row_half_mirror row_mask:0xf bank_mask:0xf
    v_add_f32_dpp v9, v9, v9 row_half_mirror row_mask:0xf bank_mask:0xf
    s_nop 0
    v_add_f32_dpp v8, v8, v8 row_mirror row_mask:0xf bank_mask:0xf
    v_add_f32_dpp v9, v9, v9 row_mirror row_mask:0xf bank_mask:0xf
    s_nop 0
    v_readlane_b32 s43, v8, 0
    v_readlane_b32 s44, v8, 16
    v_readlane_b32 s45, v8, 32
    v_readlane_b32 s46, v8, 48
    v_readlane_b32 s47, v9, 0
    v_readlane_b32 s48, v9, 16
    v_readlane_b32 s49, v9, 32
    v_readlane_b32 s50, v9, 48
    s_nop 1
    v_mov_b32 v8, s43
    v_add_f32 v8, s44, v8
    v_add_f32 v8, s45, v8
    v_add_f32 v8, s46, v8
    v_mov_b32 v9, s47
    v_add_f32 v9, s48, v9
    v_add_f32 v9, s49, v9
    v_add_f32 v9, s50, v9
    v_cmp_eq_u32 vcc, 1, v1
    s_nop 1
    v_cndmask_b32 v8, v8, v9, vcc
    v_cvt_pk_bf16_f32 v8, v8, v8
    v_lshlrev_b32 v8, 16, v8
    v_mul_f32 v8, 0xbfb8aa3b, v8
    v_exp_f32 v8, v8
    s_nop 0
    v_add_f32 v8, 1.0, v8
    v_rcp_f32 v8, v8
    s_nop 0
    v_cvt_pk_bf16_f32 v8, v8, v8
    v_lshlrev_b32 v8, 16, v8
    s_lshl_b32 s43, s42, 2
    s_add_u32 s43, s43, 10346496
    v_lshlrev_b32 v9, 2, v1
    v_mov_b32 v10, 1073741824
    v_cmp_gt_u32 vcc, 2, v1
    s_nop 1
    v_cndmask_b32 v9, v10, v9, vcc
    buffer_store_dword v8, v9, s[8:11], s43 offen sc1
    s_mov_b32 s20, s72
    s_and_b32 s21, s73, 0xffff
    s_mov_b32 s22, 256
    s_mov_b32 s23, 0x00020000
    s_cmp_eq_u32 s3, 4
    s_cbranch_scc0 P1_notag
    v_readfirstlane_b32 s28, v31
    s_cmp_lg_u32 s28, 0
    s_cbranch_scc1 P1_notag
    v_mov_b32 v2, 0
    s_mov_b32 s50, 300000
P1_tagloop:
    buffer_load_dword v3, v2, s[20:23], 0 offen sc1
    s_waitcnt vmcnt(0)
    v_readfirstlane_b32 s28, v3
    s_cmp_lg_u32 s28, 0
    s_cbranch_scc1 P1_notag
    s_sleep 2
    s_sub_u32 s50, s50, 1
    s_cmp_lg_u32 s50, 0
    s_cbranch_scc1 P1_tagloop
P1_notag:
    s_cmp_eq_u32 s3, 4
    s_cbranch_scc0 P1_notag2
    v_mov_b32 v2, 163808
    v_mov_b32 v3, s28
    ds_write_b32 v2, v3
    s_waitcnt lgkmcnt(0)
P1_notag2:
    s_barrier
P1_fin:
    s_lshl_b32 s55, s31, 3
    s_add_u32 s55, s55, s33
    s_lshl_b32 s55, s55, 4
    s_add_u32 s55, s55, s32
    s_waitcnt vmcnt(0)
    s_barrier
    s_cmp_eq_u32 s3, 4
    s_cbranch_scc0 P1_nosig
    v_mov_b32 v8, 163812
    ds_read_b32 v9, v8
    s_waitcnt lgkmcnt(0)
    v_readfirstlane_b32 s54, v9
    s_cmp_eq_u32 s54, 1
    s_cbranch_scc0 P1_nolocsig
    s_lshl_b32 s50, s55, 2
    s_add_u32 s50, s50, 16550912
    v_mov_b32 v250, 0
    v_mov_b32 v251, s28
    s_mov_b64 exec, 1
    buffer_store_dword v251, v250, s[8:11], s50 offen
    s_mov_b64 exec, -1
P1_nolocsig:
    s_lshl_b32 s50, s55, 2
    s_add_u32 s50, s50, 16547840
    v_mov_b32 v250, 0
    v_mov_b32 v251, s28
    s_mov_b64 exec, 1
    buffer_store_dword v251, v250, s[8:11], s50 offen sc1
    s_mov_b64 exec, -1
P1_nosig:
    v_mov_b32 v8, 163808
    ds_read_b32 v9, v8
    s_waitcnt lgkmcnt(0)
    v_readfirstlane_b32 s28, v9
    s_and_b32 s47, s30, 3
    s_lshl_b32 s31, s29, 2
    s_add_u32 s31, s31, s47
    s_lshr_b32 s32, s30, 2
    s_and_b32 s33, s3, 3
    s_lshr_b32 s34, s3, 2
    v_and_b32 v1, 63, v0
    v_lshlrev_b32 v2, 4, v1
    s_mul_i32 s35, s31, 151552
    s_add_u32 s35, s35, 0
    s_mul_i32 s47, s31, 73728
    s_mul_i32 s48, s32, 9216
    s_add_u32 s47, s47, s48
    s_add_u32 s36, s47, 4849664
    s_add_u32 s37, s47, 7208960
    s_lshl_b32 s38, s3, 10
    s_lshl_b32 s40, s33, 12
    s_mul_i32 s47, s34, 75776
    s_add_u32 s40, s40, s47
    s_add_u32 s39, s35, s40
    s_lshr_b32 s44, s30, 3
    s_and_b32 s45, s30, 7
    s_mul_i32 s46, s45, 184320
    s_add_u32 s46, s46, 15073280
    s_lshl_b32 s47, s3, 2
    s_add_u32 s47, s47, 152736
    v_mov_b32 v150, s47
    s_lshl_b32 s47, s34, 4
    s_add_u32 s47, s47, 152736
    v_mov_b32 v151, s47
    v_mov_b32 v8, 0
    v_lshlrev_b32 v9, 2, v1
    v_add_u32 v9, 152736, v9
    v_cmp_gt_u32 vcc, 9, v1
    s_and_saveexec_b64 s[96:97], vcc
    ds_write_b32 v9, v8
    s_mov_b64 exec, s[96:97]
    s_waitcnt lgkmcnt(0)
    v_mov_b32 v8, 163812
    ds_read_b32 v9, v8
    s_waitcnt lgkmcnt(0)
    v_readfirstlane_b32 s42, v9
    s_cmp_eq_u32 s3, 4
    s_cbranch_scc0 P2_nopoll
    s_add_u32 s47, s29, 8
    s_lshl_b32 s47, s47, 6
    s_add_u32 s47, s47, 16547840
    v_mov_b32 v8, 163812
    ds_read_b32 v9, v8
    v_lshlrev_b32 v8, 2, v1
    s_mov_b32 s50, 300000
    s_add_u32 s51, s47, 3072
    s_waitcnt lgkmcnt(0)
    v_readfirstlane_b32 s53, v9
    s_mov_b32 s54, 0
p0_1:
    s_cmp_eq_u32 s53, 1
    s_cbranch_scc0 p0_1_glob
    buffer_load_dword v9, v8, s[8:11], s51 offen sc1
    s_waitcnt vmcnt(0)
    v_cmp_eq_u32 vcc, s28, v9
    s_nop 3
    s_or_b32 s54, s54, vcc_lo
    s_and_b32 s52, s54, 0xffff
    s_cmp_eq_u32 s52, 0xffff
    s_cbranch_scc1 p0_1_done
    s_and_b32 s52, s50, 15
    s_cmp_eq_u32 s52, 4
    s_cbranch_scc0 p0_1_next
p0_1_glob:
    buffer_load_dword v10, v8, s[8:11], s47 offen sc1
    s_waitcnt vmcnt(0)
    v_cmp_eq_u32 vcc, s28, v10
    s_nop 3
    s_or_b32 s54, s54, vcc_lo
    s_and_b32 s52, s54, 0xffff
    s_cmp_eq_u32 s52, 0xffff
    s_cbranch_scc1 p0_1_done
p0_1_next:
    s_sleep 1
    s_sub_u32 s50, s50, 1
    s_cmp_lg_u32 s50, 0
    s_cbranch_scc1 p0_1
p0_1_done:
P2_nopoll:
    s_barrier
    s_mov_b32 m0, s40
    s_nop 0
    buffer_load_dwordx4 v2, s[8:11], s39 offen offset:0 sc1 lds
    buffer_load_dwordx4 v2, s[8:11], s39 offen offset:1024 sc1 lds
    s_add_u32 s50, s36, s38
    s_add_u32 s51, s38, 66560
    s_mov_b32 m0, s51
    s_nop 0
    buffer_load_dwordx4 v2, s[8:11], s50 offen sc1 lds
    s_add_u32 s50, s36, 8192
    s_cmp_eq_u32 s3, 0
    s_cselect_b32 s50, s50, 1073741824
    s_mov_b32 s51, 162816
    s_cselect_b32 s51, 74752, s51
    s_mov_b32 m0, s51
    s_nop 0
    buffer_load_dwordx4 v2, s[8:11], s50 offen sc1 lds
    s_mov_b32 m0, s40
    s_nop 0
    buffer_load_dwordx4 v2, s[8:11], s39 offen offset:2048 sc1 lds
    buffer_load_dwordx4 v2, s[8:11], s39 offen offset:3072 sc1 lds
    s_add_u32 s40, s40, 16384
    s_add_u32 s39, s39, 16384
    s_lshl_b32 s41, s29, 6
    s_add_u32 s41, s41, 16547840
    s_add_u32 s50, s41, 3072
    s_cmp_eq_u32 s42, 1
    s_cselect_b32 s42, s50, s41
    v_lshrrev_b32 v8, 4, v1
    v_and_b32 v9, 1, v8
    v_lshrrev_b32 v10, 1, v8
    v_bfe_u32 v11, v1, 2, 2
    v_and_b32 v12, 3, v1
    v_and_b32 v13, 1, v12
    v_lshl_add_u32 v13, v9, 1, v13
    v_mul_u32_u24 v13, 288, v13
    v_lshrrev_b32 v14, 1, v12
    v_lshl_add_u32 v13, v14, 3, v13
    v_and_b32 v14, 1, v11
    v_lshrrev_b32 v15, 1, v11
    v_lshl_add_u32 v14, v15, 3, v14
    v_lshl_add_u32 v14, v10, 2, v14
    v_lshl_add_u32 v4, v14, 4, v13
    v_and_b32 v15, 1, v11
    v_lshl_add_u32 v14, v15, 4, v13
    v_add_u32 v3, 256, v14
    v_mul_u32_u24 v8, 1152, v10
    v_add_u32 v15, v3, v8
    v_cmp_gt_u32 vcc, 2, v11
    v_mov_b32 v8, 3200
    v_add_u32 v9, 1152, v3
    v_cndmask_b32 v5, v8, v3, vcc
    v_mov_b32 v8, 2592
    v_cndmask_b32 v7, v8, v9, vcc
    v_and_b32 v8, 31, v1
    v_lshrrev_b32 v9, 5, v1
    v_min_u32 v10, 18, v8
    v_mul_u32_u24 v9, 304, v9
    v_lshl_add_u32 v9, v10, 4, v9
    v_add_u32 v9, 2304, v9
    v_mov_b32 v11, 0x40000
    v_cmp_lt_u32 vcc, 18, v8
    v_cmp_ne_u32 s[48:49], 28, v8
    s_nop 1
    s_and_b64 vcc, vcc, s[48:49]
    s_nop 1
    v_cndmask_b32 v6, v9, v11, vcc
    s_lshl_b32 s47, s29, 8
    s_lshl_b32 s48, s44, 6
    s_add_u32 s47, s47, s48
    s_lshl_b32 s48, s33, 4
    s_add_u32 s47, s47, s48
    v_and_b32 v8, 15, v1
    v_lshrrev_b32 v9, 4, v1
    v_add_u32 v244, s47, v8
    v_lshrrev_b32 v10, 1, v9
    v_lshlrev_b32 v10, 16, v10
    v_lshl_add_u32 v10, v244, 5, v10
    v_and_b32 v11, 1, v9
    v_lshl_add_u32 v246, v11, 4, v10
    v_lshlrev_b32 v10, 15, v9
    v_lshl_add_u32 v247, v244, 2, v10
    v_mov_b32 v32, 0
    v_mov_b32 v33, 0
    v_mov_b32 v34, 0
    v_mov_b32 v35, 0
    v_mov_b32 v36, 0
    v_mov_b32 v37, 0
    v_mov_b32 v38, 0
    v_mov_b32 v39, 0
    v_mov_b32 v40, 0
    v_mov_b32 v41, 0
    v_mov_b32 v42, 0
    v_mov_b32 v43, 0
    v_mov_b32 v44, 0
    v_mov_b32 v45, 0
    v_mov_b32 v46, 0
    v_mov_b32 v47, 0
    v_mov_b32 v48, 0
    v_mov_b32 v49, 0
    v_mov_b32 v50, 0
    v_mov_b32 v51, 0
    v_mov_b32 v52, 0
    v_mov_b32 v53, 0
    v_mov_b32 v54, 0
    v_mov_b32 v55, 0
    v_mov_b32 v56, 0
    v_mov_b32 v57, 0
    v_mov_b32 v58, 0
    v_mov_b32 v59, 0
    v_mov_b32 v60, 0
    v_mov_b32 v61, 0
    v_mov_b32 v62, 0
    v_mov_b32 v63, 0
    v_mov_b32 v120, 0
    v_mov_b32 v121, 0
    v_mov_b32 v122, 0
    v_mov_b32 v123, 0
    v_mov_b32 v124, 0
    v_mov_b32 v125, 0
    v_mov_b32 v126, 0
    v_mov_b32 v127, 0
    v_mov_b32 v156, 0
    v_mov_b32 v157, 0
    v_mov_b32 v158, 0
    v_mov_b32 v159, 0
    v_mul_u32_u24 v8, 13108, v0
    v_lshrrev_b32 v8, 16, v8
    v_mul_u32_u24 v9, 5, v8
    v_sub_u32 v9, v0, v9
    v_mul_u32_u24 v10, 80, v8
    v_lshl_add_u32 v10, v9, 4, v10
    v_mov_b32 v11, 1073741824
    v_cmp_gt_u32 vcc, 95, v0
    v_lshrrev_b32 v12, 4, v8
    v_lshlrev_b32 v12, 1, v12
    v_cndmask_b32 v255, v11, v10, vcc
    v_bfe_u32 v11, v8, 2, 1
    v_add_u32 v12, v12, v11
    v_mul_u32_u24 v12, 288, v12
    v_lshl_add_u32 v12, v9, 6, v12
    v_bfe_u32 v11, v8, 3, 1
    v_lshl_add_u32 v12, v11, 3, v12
    v_and_b32 v11, 3, v8
    v_lshl_add_u32 v12, v11, 1, v12
    v_add_u32 v253, 151552, v12
    v_lshlrev_b32 v12, 6, v9
    v_add_u32 v254, 152424, v12
    s_waitcnt vmcnt(0)
    s_barrier
    s_mul_i32 s50, s33, 2304
    s_add_u32 s50, s50, 66560
    v_add_u32 v8, s50, v4
    v_add_u32 v9, s50, v15
    ds_read_b64_tr_b16 v[16:17], v8
    ds_read_b64_tr_b16 v[18:19], v8 offset:32
    ds_read_b64_tr_b16 v[20:21], v8 offset:1152
    ds_read_b64_tr_b16 v[22:23], v8 offset:1184
    ds_read_b64_tr_b16 v[24:25], v9
    v_mov_b32 v249, v4
    s_mul_i32 s50, s34, 75776
    v_add_u32 v4, s50, v4
    v_add_u32 v5, s50, v5
    v_add_u32 v7, s50, v7
    v_add_u32 v6, s50, v6
    s_cmp_eq_u32 s34, 0
    s_cselect_b32 s92, 0, -1
    s_mov_b32 s93, s92
    ds_read_b64_tr_b16 v[148:149], v5 offset:0
    ds_read_b64_tr_b16 v[144:145], v4 offset:0
    ds_read_b64_tr_b16 v[146:147], v4 offset:32
    s_waitcnt lgkmcnt(0)
    s_barrier
    v_mov_b32 v25, 0
    s_nop 1
    v_mfma_f32_32x32x4bf16_1k v[64:95], v[148:149], v[24:25], 0
    ds_read_b64_tr_b16 v[148:149], v7 offset:0
    ds_read_b128 v[152:155], v6 offset:0
    s_nop 15
    s_nop 3
    v_mfma_f32_32x32x16_bf16 v[64:79], v[144:147], v[16:19], v[64:79]
    v_mfma_f32_32x32x16_bf16 v[80:95], v[144:147], v[20:23], v[80:95]
    ds_read_b64_tr_b16 v[144:145], v4 offset:1152
    ds_read_b64_tr_b16 v[146:147], v4 offset:1184
    s_nop 9
    s_waitcnt lgkmcnt(0)
    s_mov_b64 vcc, s[92:93]
    s_cbranch_vccz cy_2
    s_setprio 1
cy_2:
    v_exp_f32 v64, v64
    v_cvt_pk_bf16_f32 v140, v120, v121
    v_cvt_pk_bf16_f32 v141, v122, v123
    v_exp_f32 v65, v65
    v_cvt_pk_bf16_f32 v142, v124, v125
    v_cvt_pk_bf16_f32 v143, v126, v127
    v_mfma_f32_32x32x4bf16_1k v[96:127], v[148:149], v[24:25], 0
    ds_read_b64_tr_b16 v[148:149], v5 offset:4736
    v_exp_f32 v66, v66
    s_mov_b32 m0, s40
    s_nop 0
    buffer_load_dwordx4 v2, s[8:11], s39 offen offset:0 sc1 lds
    v_exp_f32 v67, v67
    v_exp_f32 v68, v68
    v_exp_f32 v69, v69
    v_exp_f32 v70, v70
    v_exp_f32 v71, v71
    v_exp_f32 v72, v72
    v_mfma_f32_32x32x16_bf16 v[48:63], v[156:159], v[140:143], v[48:63]
    ds_read_b128 v[156:159], v6 offset:608
    v_cvt_pk_bf16_f32 v128, v64, v65
    v_cvt_pk_bf16_f32 v129, v66, v67
    v_exp_f32 v73, v73
    v_cvt_pk_bf16_f32 v130, v68, v69
    buffer_load_dwordx4 v2, s[8:11], s39 offen offset:1024 sc1 lds
    v_cvt_pk_bf16_f32 v131, v70, v71
    v_exp_f32 v74, v74
    v_exp_f32 v75, v75
    s_waitcnt lgkmcnt(2)
    v_mfma_f32_32x32x16_bf16 v[32:47], v[152:155], v[128:131], v[32:47]
    v_exp_f32 v76, v76
    v_exp_f32 v77, v77
    v_exp_f32 v78, v78
    v_exp_f32 v79, v79
    v_mfma_f32_32x32x16_bf16 v[96:111], v[144:147], v[16:19], v[96:111]
    v_exp_f32 v80, v80
    v_cvt_pk_bf16_f32 v132, v72, v73
    v_cvt_pk_bf16_f32 v133, v74, v75
    buffer_load_dwordx4 v2, s[8:11], s39 offen offset:2048 sc1 lds
    v_exp_f32 v81, v81
    v_cvt_pk_bf16_f32 v134, v76, v77
    v_cvt_pk_bf16_f32 v135, v78, v79
    v_exp_f32 v82, v82
    v_exp_f32 v83, v83
    s_waitcnt lgkmcnt(0)
    v_mfma_f32_32x32x16_bf16 v[32:47], v[156:159], v[132:135], v[32:47]
    v_exp_f32 v84, v84
    v_exp_f32 v85, v85
    v_exp_f32 v86, v86
    v_exp_f32 v87, v87
    v_mfma_f32_32x32x16_bf16 v[112:127], v[144:147], v[20:23], v[112:127]
    ds_read_b64_tr_b16 v[144:145], v4 offset:4736
    ds_read_b64_tr_b16 v[146:147], v4 offset:4768
    v_exp_f32 v88, v88
    v_cvt_pk_bf16_f32 v136, v80, v81
    v_cvt_pk_bf16_f32 v137, v82, v83
    v_exp_f32 v89, v89
    v_cvt_pk_bf16_f32 v138, v84, v85
    v_cvt_pk_bf16_f32 v139, v86, v87
    v_exp_f32 v90, v90
    buffer_load_dwordx4 v2, s[8:11], s39 offen offset:3072 sc1 lds
    s_add_u32 s40, s40, 16384
    s_add_u32 s39, s39, 16384
    v_exp_f32 v91, v91
    v_exp_f32 v92, v92
    v_exp_f32 v93, v93
    v_exp_f32 v94, v94
    v_exp_f32 v95, v95
    v_mfma_f32_32x32x16_bf16 v[48:63], v[152:155], v[136:139], v[48:63]
    ds_read_b128 v[152:155], v6 offset:1216
    v_exp_f32 v96, v96
    v_cvt_pk_bf16_f32 v140, v88, v89
    v_cvt_pk_bf16_f32 v141, v90, v91
    v_exp_f32 v97, v97
    v_cvt_pk_bf16_f32 v142, v92, v93
    v_cvt_pk_bf16_f32 v143, v94, v95
    v_mfma_f32_32x32x4bf16_1k v[64:95], v[148:149], v[24:25], 0
    ds_read_b64_tr_b16 v[148:149], v7 offset:4736
    v_exp_f32 v98, v98
    s_mov_b32 m0, s40
    s_nop 0
    buffer_load_dwordx4 v2, s[8:11], s39 offen offset:0 sc1 lds
    v_exp_f32 v99, v99
    v_exp_f32 v100, v100
    v_exp_f32 v101, v101
    v_exp_f32 v102, v102
    v_exp_f32 v103, v103
    v_exp_f32 v104, v104
    v_mfma_f32_32x32x16_bf16 v[48:63], v[156:159], v[140:143], v[48:63]
    ds_read_b128 v[156:159], v6 offset:1824
    v_cvt_pk_bf16_f32 v128, v96, v97
    v_cvt_pk_bf16_f32 v129, v98, v99
    v_exp_f32 v105, v105
    v_cvt_pk_bf16_f32 v130, v100, v101
    buffer_load_dwordx4 v2, s[8:11], s39 offen offset:1024 sc1 lds
    v_cvt_pk_bf16_f32 v131, v102, v103
    v_exp_f32 v106, v106
    v_exp_f32 v107, v107
    s_waitcnt lgkmcnt(2)
    v_mfma_f32_32x32x16_bf16 v[32:47], v[152:155], v[128:131], v[32:47]
    v_exp_f32 v108, v108
    v_exp_f32 v109, v109
    v_exp_f32 v110, v110
    v_exp_f32 v111, v111
    v_mfma_f32_32x32x16_bf16 v[64:79], v[144:147], v[16:19], v[64:79]
    v_exp_f32 v112, v112
    v_cvt_pk_bf16_f32 v132, v104, v105
    v_cvt_pk_bf16_f32 v133, v106, v107
    buffer_load_dwordx4 v2, s[8:11], s39 offen offset:2048 sc1 lds
    v_exp_f32 v113, v113
    v_cvt_pk_bf16_f32 v134, v108, v109
    v_cvt_pk_bf16_f32 v135, v110, v111
    v_exp_f32 v114, v114
    v_exp_f32 v115, v115
    s_waitcnt lgkmcnt(0)
    v_mfma_f32_32x32x16_bf16 v[32:47], v[156:159], v[132:135], v[32:47]
    v_exp_f32 v116, v116
    v_exp_f32 v117, v117
    v_exp_f32 v118, v118
    v_exp_f32 v119, v119
    v_mfma_f32_32x32x16_bf16 v[80:95], v[144:147], v[20:23], v[80:95]
    ds_read_b64_tr_b16 v[144:145], v4 offset:5888
    ds_read_b64_tr_b16 v[146:147], v4 offset:5920
    v_exp_f32 v120, v120
    v_cvt_pk_bf16_f32 v136, v112, v113
    v_cvt_pk_bf16_f32 v137, v114, v115
    v_exp_f32 v121, v121
    v_cvt_pk_bf16_f32 v138, v116, v117
    v_cvt_pk_bf16_f32 v139, v118, v119
    v_exp_f32 v122, v122
    buffer_load_dwordx4 v2, s[8:11], s39 offen offset:3072 sc1 lds
    s_add_u32 s40, s40, 16384
    s_add_u32 s39, s39, 16384
    v_exp_f32 v123, v123
    v_exp_f32 v124, v124
    v_exp_f32 v125, v125
    v_exp_f32 v126, v126
    v_exp_f32 v127, v127
    v_mfma_f32_32x32x16_bf16 v[48:63], v[152:155], v[136:139], v[48:63]
    ds_read_b128 v[152:155], v6 offset:4736
    v_exp_f32 v64, v64
    v_cvt_pk_bf16_f32 v140, v120, v121
    v_cvt_pk_bf16_f32 v141, v122, v123
    v_exp_f32 v65, v65
    v_cvt_pk_bf16_f32 v142, v124, v125
    v_cvt_pk_bf16_f32 v143, v126, v127
    v_mfma_f32_32x32x4bf16_1k v[96:127], v[148:149], v[24:25], 0
    ds_read_b64_tr_b16 v[148:149], v5 offset:9472
    v_exp_f32 v66, v66
    s_mov_b32 m0, s40
    s_nop 0
    buffer_load_dwordx4 v2, s[8:11], s39 offen offset:0 sc1 lds
    v_exp_f32 v67, v67
    v_exp_f32 v68, v68
    v_exp_f32 v69, v69
    v_exp_f32 v70, v70
    v_exp_f32 v71, v71
    v_exp_f32 v72, v72
    v_mfma_f32_32x32x16_bf16 v[48:63], v[156:159], v[140:143], v[48:63]
    ds_read_b128 v[156:159], v6 offset:5344
    v_cvt_pk_bf16_f32 v128, v64, v65
    v_cvt_pk_bf16_f32 v129, v66, v67
    v_exp_f32 v73, v73
    v_cvt_pk_bf16_f32 v130, v68, v69
    buffer_load_dwordx4 v2, s[8:11], s39 offen offset:1024 sc1 lds
    v_cvt_pk_bf16_f32 v131, v70, v71
    v_exp_f32 v74, v74
    v_exp_f32 v75, v75
    s_waitcnt lgkmcnt(2)
    v_mfma_f32_32x32x16_bf16 v[32:47], v[152:155], v[128:131], v[32:47]
    v_exp_f32 v76, v76
    v_lshlrev_b32 v8, 2, v1
    buffer_load_dword v252, v8, s[8:11], s42 offen sc1
    v_exp_f32 v77, v77
    v_exp_f32 v78, v78
    v_exp_f32 v79, v79
    v_mfma_f32_32x32x16_bf16 v[96:111], v[144:147], v[16:19], v[96:111]
    v_exp_f32 v80, v80
    v_cvt_pk_bf16_f32 v132, v72, v73
    v_cvt_pk_bf16_f32 v133, v74, v75
    buffer_load_dwordx4 v2, s[8:11], s39 offen offset:2048 sc1 lds
    v_exp_f32 v81, v81
    v_cvt_pk_bf16_f32 v134, v76, v77
    v_cvt_pk_bf16_f32 v135, v78, v79
    v_exp_f32 v82, v82
    v_exp_f32 v83, v83
    s_waitcnt lgkmcnt(0)
    v_mfma_f32_32x32x16_bf16 v[32:47], v[156:159], v[132:135], v[32:47]
    v_exp_f32 v84, v84
    v_exp_f32 v85, v85
    v_exp_f32 v86, v86
    v_exp_f32 v87, v87
    v_mfma_f32_32x32x16_bf16 v[112:127], v[144:147], v[20:23], v[112:127]
    ds_read_b64_tr_b16 v[144:145], v4 offset:9472
    ds_read_b64_tr_b16 v[146:147], v4 offset:9504
    v_exp_f32 v88, v88
    v_cvt_pk_bf16_f32 v136, v80, v81
    v_cvt_pk_bf16_f32 v137, v82, v83
    v_exp_f32 v89, v89
    v_cvt_pk_bf16_f32 v138, v84, v85
    v_cvt_pk_bf16_f32 v139, v86, v87
    v_exp_f32 v90, v90
    buffer_load_dwordx4 v2, s[8:11], s39 offen offset:3072 sc1 lds
    s_add_u32 s40, s40, 16384
    s_add_u32 s39, s39, 16384
    v_exp_f32 v91, v91
    v_exp_f32 v92, v92
    v_exp_f32 v93, v93
    v_exp_f32 v94, v94
    v_exp_f32 v95, v95
    v_mfma_f32_32x32x16_bf16 v[48:63], v[152:155], v[136:139], v[48:63]
    ds_read_b128 v[152:155], v6 offset:5952
    s_cbranch_vccz cy_3
    s_setprio 0
cy_3:
    v_exp_f32 v96, v96
    v_cvt_pk_bf16_f32 v140, v88, v89
    v_cvt_pk_bf16_f32 v141, v90, v91
    v_exp_f32 v97, v97
    v_cvt_pk_bf16_f32 v142, v92, v93
    s_mov_b32 m0, s40
    s_nop 0
    s_cmp_lt_u32 s33, 3
    s_cselect_b32 s50, s39, 1073741824
    s_cselect_b32 s51, s40, 162816
    s_mov_b32 m0, s51
    s_nop 0
    buffer_load_dwordx4 v2, s[8:11], s50 offen offset:0 sc1 lds
    v_cvt_pk_bf16_f32 v143, v94, v95
    v_mfma_f32_32x32x4bf16_1k v[64:95], v[148:149], v[24:25], 0
    ds_read_b64_tr_b16 v[148:149], v7 offset:9472
    v_exp_f32 v98, v98
    v_exp_f32 v99, v99
    v_exp_f32 v100, v100
    v_exp_f32 v101, v101
    v_exp_f32 v102, v102
    v_exp_f32 v103, v103
    v_exp_f32 v104, v104
    v_mfma_f32_32x32x16_bf16 v[48:63], v[156:159], v[140:143], v[48:63]
    ds_read_b128 v[156:159], v6 offset:6560
    v_cvt_pk_bf16_f32 v128, v96, v97
    v_cvt_pk_bf16_f32 v129, v98, v99
    s_cmp_lt_u32 s33, 3
    s_cselect_b32 s50, s39, 1073741824
    s_cselect_b32 s51, s40, 161792
    s_mov_b32 m0, s51
    s_nop 0
    buffer_load_dwordx4 v2, s[8:11], s50 offen offset:1024 sc1 lds
    v_exp_f32 v105, v105
    v_cvt_pk_bf16_f32 v130, v100, v101
    v_cvt_pk_bf16_f32 v131, v102, v103
    v_exp_f32 v106, v106
    v_exp_f32 v107, v107
    s_waitcnt lgkmcnt(2)
    v_mfma_f32_32x32x16_bf16 v[32:47], v[152:155], v[128:131], v[32:47]
    v_exp_f32 v108, v108
    v_exp_f32 v109, v109
    v_exp_f32 v110, v110
    v_exp_f32 v111, v111
    v_mfma_f32_32x32x16_bf16 v[64:79], v[144:147], v[16:19], v[64:79]
    v_exp_f32 v112, v112
    v_cvt_pk_bf16_f32 v132, v104, v105
    v_cvt_pk_bf16_f32 v133, v106, v107
    v_exp_f32 v113, v113
    v_cvt_pk_bf16_f32 v134, v108, v109
    v_cvt_pk_bf16_f32 v135, v110, v111
    v_exp_f32 v114, v114
    s_waitcnt vmcnt(7)
    v_exp_f32 v115, v115
    s_waitcnt lgkmcnt(0)
    v_mfma_f32_32x32x16_bf16 v[32:47], v[156:159], v[132:135], v[32:47]
    v_exp_f32 v116, v116
    v_exp_f32 v117, v117
    v_mov_b32 v8, 1
    s_mov_b64 exec, 1
    ds_write_b32 v150, v8
    s_mov_b64 exec, -1
    v_exp_f32 v118, v118
    v_exp_f32 v119, v119
    v_mfma_f32_32x32x16_bf16 v[80:95], v[144:147], v[20:23], v[80:95]
    ds_read_b64_tr_b16 v[144:145], v4 offset:10624
    ds_read_b64_tr_b16 v[146:147], v4 offset:10656
    v_exp_f32 v120, v120
    s_cmp_lt_u32 s33, 2
    s_cselect_b32 s50, s39, 1073741824
    s_cselect_b32 s51, s40, 160768
    s_mov_b32 m0, s51
    s_nop 0
    buffer_load_dwordx4 v2, s[8:11], s50 offen offset:2048 sc1 lds
    v_cvt_pk_bf16_f32 v136, v112, v113
    v_cvt_pk_bf16_f32 v137, v114, v115
    v_exp_f32 v121, v121
    v_cvt_pk_bf16_f32 v138, v116, v117
    v_cvt_pk_bf16_f32 v139, v118, v119
    v_exp_f32 v122, v122
    v_exp_f32 v123, v123
    v_exp_f32 v124, v124
    s_cmp_lt_u32 s33, 2
    s_cselect_b32 s50, s39, 1073741824
    s_cselect_b32 s51, s40, 159744
    s_mov_b32 m0, s51
    s_nop 0
    buffer_load_dwordx4 v2, s[8:11], s50 offen offset:3072 sc1 lds
    v_exp_f32 v125, v125
    v_exp_f32 v126, v126
    v_exp_f32 v127, v127
    v_mfma_f32_32x32x16_bf16 v[48:63], v[152:155], v[136:139], v[48:63]
    ds_read_b128 v[152:155], v6 offset:9472
    v_add_u32 v4, 9472, v4
    v_add_u32 v5, 9472, v5
    v_add_u32 v7, 9472, v7
    v_add_u32 v6, 9472, v6
    s_waitcnt vmcnt(6)
    s_mov_b32 s50, 300000
    s_mov_b32 s52, 0
pa_4:
    v_cmp_eq_u32 vcc, s28, v252
    s_nop 3
    s_or_b32 s52, s52, vcc_lo
    s_and_b32 s51, s52, 0xffff
    s_cmp_eq_u32 s51, 0xffff
    s_cbranch_scc1 pa_4_done
    s_sleep 1
    s_and_b32 s51, s50, 7
    s_cmp_eq_u32 s51, 3
    s_cselect_b32 s51, s41, s42
    v_lshlrev_b32 v8, 2, v1
    buffer_load_dword v252, v8, s[8:11], s51 offen sc1
    s_waitcnt vmcnt(0)
    s_sub_u32 s50, s50, 1
    s_cmp_lg_u32 s50, 0
    s_cbranch_scc1 pa_4
pa_4_done:
    s_add_u32 s50, s37, s38
    s_add_u32 s51, s38, 152832
    s_mov_b32 m0, s51
    s_nop 0
    buffer_load_dwordx4 v2, s[8:11], s50 offen sc1 lds
    s_add_u32 s50, s37, 8192
    s_cmp_eq_u32 s3, 0
    s_cselect_b32 s50, s50, 1073741824
    s_mov_b32 s51, 162816
    s_cselect_b32 s51, 161024, s51
    s_mov_b32 m0, s51
    s_nop 0
    buffer_load_dwordx4 v2, s[8:11], s50 offen sc1 lds
    s_cmp_ge_u32 s3, 2
    s_cbranch_scc1 P2_nokvl
    s_mul_i32 s50, s31, 1520
    s_add_u32 s50, s50, 9568256
    buffer_load_dwordx4 v[160:163], v255, s[8:11], s50 offen sc1
    s_add_u32 s50, s50, 48640
    buffer_load_dwordx4 v[164:167], v255, s[8:11], s50 offen sc1
    s_add_u32 s50, s50, 48640
    buffer_load_dwordx4 v[168:171], v255, s[8:11], s50 offen sc1
    s_add_u32 s50, s50, 48640
    buffer_load_dwordx4 v[172:175], v255, s[8:11], s50 offen sc1
    s_add_u32 s50, s50, 48640
    buffer_load_dwordx4 v[176:179], v255, s[8:11], s50 offen sc1
    s_add_u32 s50, s50, 48640
    buffer_load_dwordx4 v[180:183], v255, s[8:11], s50 offen sc1
    s_add_u32 s50, s50, 48640
    buffer_load_dwordx4 v[184:187], v255, s[8:11], s50 offen sc1
    s_add_u32 s50, s50, 48640
    buffer_load_dwordx4 v[188:191], v255, s[8:11], s50 offen sc1
    s_add_u32 s50, s50, 48640
    buffer_load_dwordx4 v[192:195], v255, s[8:11], s50 offen sc1
    s_add_u32 s50, s50, 48640
    buffer_load_dwordx4 v[196:199], v255, s[8:11], s50 offen sc1
    s_add_u32 s50, s50, 48640
    buffer_load_dwordx4 v[200:203], v255, s[8:11], s50 offen sc1
    s_add_u32 s50, s50, 48640
    buffer_load_dwordx4 v[204:207], v255, s[8:11], s50 offen sc1
    s_add_u32 s50, s50, 48640
    buffer_load_dwordx4 v[208:211], v255, s[8:11], s50 offen sc1
    s_add_u32 s50, s50, 48640
    buffer_load_dwordx4 v[212:215], v255, s[8:11], s50 offen sc1
    s_add_u32 s50, s50, 48640
    buffer_load_dwordx4 v[216:219], v255, s[8:11], s50 offen sc1
    s_add_u32 s50, s50, 48640
    buffer_load_dwordx4 v[220:223], v255, s[8:11], s50 offen sc1
P2_nokvl:
    s_setprio 0
    s_mov_b64 vcc, s[92:93]
    v_exp_f32 v64, v64
    v_cvt_pk_bf16_f32 v140, v120, v121
    v_cvt_pk_bf16_f32 v141, v122, v123
    v_exp_f32 v65, v65
    v_cvt_pk_bf16_f32 v142, v124, v125
    v_cvt_pk_bf16_f32 v143, v126, v127
    v_mfma_f32_32x32x4bf16_1k v[96:127], v[148:149], v[24:25], 0
    ds_read_b64_tr_b16 v[148:149], v5 offset:4736
    v_exp_f32 v66, v66
    v_exp_f32 v67, v67
    v_exp_f32 v68, v68
    v_exp_f32 v69, v69
    v_exp_f32 v70, v70
    v_exp_f32 v71, v71
    v_exp_f32 v72, v72
    v_mfma_f32_32x32x16_bf16 v[48:63], v[156:159], v[140:143], v[48:63]
    ds_read_b128 v[156:159], v6 offset:608
    v_cvt_pk_bf16_f32 v128, v64, v65
    v_cvt_pk_bf16_f32 v129, v66, v67
    v_exp_f32 v73, v73
    v_cvt_pk_bf16_f32 v130, v68, v69
    v_cvt_pk_bf16_f32 v131, v70, v71
    v_exp_f32 v74, v74
    v_exp_f32 v75, v75
    s_waitcnt lgkmcnt(2)
    v_mfma_f32_32x32x16_bf16 v[32:47], v[152:155], v[128:131], v[32:47]
    v_exp_f32 v76, v76
    v_exp_f32 v77, v77
    v_exp_f32 v78, v78
    v_exp_f32 v79, v79
    v_mfma_f32_32x32x16_bf16 v[96:111], v[144:147], v[16:19], v[96:111]
    v_exp_f32 v80, v80
    v_cvt_pk_bf16_f32 v132, v72, v73
    v_cvt_pk_bf16_f32 v133, v74, v75
    v_exp_f32 v81, v81
    v_cvt_pk_bf16_f32 v134, v76, v77
    v_cvt_pk_bf16_f32 v135, v78, v79
    v_exp_f32 v82, v82
    ds_read_b128 v[12:15], v151
    v_exp_f32 v83, v83
    s_waitcnt lgkmcnt(0)
    v_mfma_f32_32x32x16_bf16 v[32:47], v[156:159], v[132:135], v[32:47]
    v_exp_f32 v84, v84
    v_min3_u32 v12, v12, v13, v14
    v_min_u32 v12, v12, v15
    s_nop 0
    v_readfirstlane_b32 s50, v12
    s_cmp_ge_u32 s50, 1
    s_cbranch_scc0 chk_5_spin
chk_5_back:
    v_exp_f32 v85, v85
    v_exp_f32 v86, v86
    v_exp_f32 v87, v87
    v_mfma_f32_32x32x16_bf16 v[112:127], v[144:147], v[20:23], v[112:127]
    ds_read_b64_tr_b16 v[144:145], v4 offset:4736
    ds_read_b64_tr_b16 v[146:147], v4 offset:4768
    v_exp_f32 v88, v88
    v_cvt_pk_bf16_f32 v136, v80, v81
    v_cvt_pk_bf16_f32 v137, v82, v83
    v_exp_f32 v89, v89
    v_cvt_pk_bf16_f32 v138, v84, v85
    v_cvt_pk_bf16_f32 v139, v86, v87
    v_exp_f32 v90, v90
    v_exp_f32 v91, v91
    v_exp_f32 v92, v92
    v_exp_f32 v93, v93
    v_exp_f32 v94, v94
    v_exp_f32 v95, v95
    v_mfma_f32_32x32x16_bf16 v[48:63], v[152:155], v[136:139], v[48:63]
    ds_read_b128 v[152:155], v6 offset:1216
    v_exp_f32 v96, v96
    v_cvt_pk_bf16_f32 v140, v88, v89
    v_cvt_pk_bf16_f32 v141, v90, v91
    v_exp_f32 v97, v97
    v_cvt_pk_bf16_f32 v142, v92, v93
    v_cvt_pk_bf16_f32 v143, v94, v95
    v_mfma_f32_32x32x4bf16_1k v[64:95], v[148:149], v[24:25], 0
    ds_read_b64_tr_b16 v[148:149], v7 offset:4736
    v_exp_f32 v98, v98
    v_exp_f32 v99, v99
    v_exp_f32 v100, v100
    v_exp_f32 v101, v101
    v_exp_f32 v102, v102
    v_exp_f32 v103, v103
    v_exp_f32 v104, v104
    v_mfma_f32_32x32x16_bf16 v[48:63], v[156:159], v[140:143], v[48:63]
    ds_read_b128 v[156:159], v6 offset:1824
    v_cvt_pk_bf16_f32 v128, v96, v97
    v_cvt_pk_bf16_f32 v129, v98, v99
    v_exp_f32 v105, v105
    v_cvt_pk_bf16_f32 v130, v100, v101
    v_cvt_pk_bf16_f32 v131, v102, v103
    v_exp_f32 v106, v106
    v_exp_f32 v107, v107
    s_waitcnt lgkmcnt(2)
    v_mfma_f32_32x32x16_bf16 v[32:47], v[152:155], v[128:131], v[32:47]
    v_exp_f32 v108, v108
    v_exp_f32 v109, v109
    v_exp_f32 v110, v110
    v_exp_f32 v111, v111
    v_mfma_f32_32x32x16_bf16 v[64:79], v[144:147], v[16:19], v[64:79]
    v_exp_f32 v112, v112
    v_cvt_pk_bf16_f32 v132, v104, v105
    v_cvt_pk_bf16_f32 v133, v106, v107
    v_exp_f32 v113, v113
    v_cvt_pk_bf16_f32 v134, v108, v109
    v_cvt_pk_bf16_f32 v135, v110, v111
    v_exp_f32 v114, v114
    v_exp_f32 v115, v115
    s_waitcnt lgkmcnt(0)
    v_mfma_f32_32x32x16_bf16 v[32:47], v[156:159], v[132:135], v[32:47]
    v_exp_f32 v116, v116
    v_exp_f32 v117, v117
    v_exp_f32 v118, v118
    v_exp_f32 v119, v119
    v_mfma_f32_32x32x16_bf16 v[80:95], v[144:147], v[20:23], v[80:95]
    ds_read_b64_tr_b16 v[144:145], v4 offset:5888
    ds_read_b64_tr_b16 v[146:147], v4 offset:5920
    v_exp_f32 v120, v120
    v_cvt_pk_bf16_f32 v136, v112, v113
    v_cvt_pk_bf16_f32 v137, v114, v115
    v_exp_f32 v121, v121
    v_cvt_pk_bf16_f32 v138, v116, v117
    v_cvt_pk_bf16_f32 v139, v118, v119
    v_exp_f32 v122, v122
    v_exp_f32 v123, v123
    v_exp_f32 v124, v124
    v_exp_f32 v125, v125
    v_exp_f32 v126, v126
    v_exp_f32 v127, v127
    v_mfma_f32_32x32x16_bf16 v[48:63], v[152:155], v[136:139], v[48:63]
    ds_read_b128 v[152:155], v6 offset:4736
    v_exp_f32 v64, v64
    v_cvt_pk_bf16_f32 v140, v120, v121
    v_cvt_pk_bf16_f32 v141, v122, v123
    v_exp_f32 v65, v65
    v_cvt_pk_bf16_f32 v142, v124, v125
    v_cvt_pk_bf16_f32 v143, v126, v127
    v_mfma_f32_32x32x4bf16_1k v[96:127], v[148:149], v[24:25], 0
    ds_read_b64_tr_b16 v[148:149], v5 offset:9472
    v_exp_f32 v66, v66
    v_exp_f32 v67, v67
    v_exp_f32 v68, v68
    v_exp_f32 v69, v69
    v_exp_f32 v70, v70
    v_exp_f32 v71, v71
    v_exp_f32 v72, v72
    v_mfma_f32_32x32x16_bf16 v[48:63], v[156:159], v[140:143], v[48:63]
    ds_read_b128 v[156:159], v6 offset:5344
    v_cvt_pk_bf16_f32 v128, v64, v65
    v_cvt_pk_bf16_f32 v129, v66, v67
    v_exp_f32 v73, v73
    v_cvt_pk_bf16_f32 v130, v68, v69
    v_cvt_pk_bf16_f32 v131, v70, v71
    v_exp_f32 v74, v74
    v_exp_f32 v75, v75
    s_waitcnt lgkmcnt(2)
    v_mfma_f32_32x32x16_bf16 v[32:47], v[152:155], v[128:131], v[32:47]
    v_exp_f32 v76, v76
    v_exp_f32 v77, v77
    v_exp_f32 v78, v78
    v_exp_f32 v79, v79
    v_mfma_f32_32x32x16_bf16 v[96:111], v[144:147], v[16:19], v[96:111]
    v_exp_f32 v80, v80
    s_waitcnt vmcnt(0)
    v_cvt_pk_bf16_f32 v132, v72, v73
    v_cvt_pk_bf16_f32 v133, v74, v75
    s_cmp_ge_u32 s3, 2
    s_cbranch_scc1 kvr_6
    v_pk_add_f32 v[160:161], v[160:161], v[164:165]
    v_pk_add_f32 v[162:163], v[162:163], v[166:167]
    v_pk_add_f32 v[160:161], v[160:161], v[168:169]
    v_pk_add_f32 v[162:163], v[162:163], v[170:171]
    v_pk_add_f32 v[160:161], v[160:161], v[172:173]
    v_pk_add_f32 v[162:163], v[162:163], v[174:175]
    v_pk_add_f32 v[160:161], v[160:161], v[176:177]
    v_pk_add_f32 v[162:163], v[162:163], v[178:179]
    v_pk_add_f32 v[160:161], v[160:161], v[180:181]
    v_pk_add_f32 v[162:163], v[162:163], v[182:183]
    v_pk_add_f32 v[160:161], v[160:161], v[184:185]
    v_pk_add_f32 v[162:163], v[162:163], v[186:187]
    v_pk_add_f32 v[160:161], v[160:161], v[188:189]
    v_pk_add_f32 v[162:163], v[162:163], v[190:191]
    v_pk_add_f32 v[160:161], v[160:161], v[192:193]
    v_pk_add_f32 v[162:163], v[162:163], v[194:195]
    v_pk_add_f32 v[160:161], v[160:161], v[196:197]
    v_pk_add_f32 v[162:163], v[162:163], v[198:199]
    v_pk_add_f32 v[160:161], v[160:161], v[200:201]
    v_pk_add_f32 v[162:163], v[162:163], v[202:203]
    v_pk_add_f32 v[160:161], v[160:161], v[204:205]
    v_pk_add_f32 v[162:163], v[162:163], v[206:207]
    v_pk_add_f32 v[160:161], v[160:161], v[208:209]
    v_pk_add_f32 v[162:163], v[162:163], v[210:211]
    v_pk_add_f32 v[160:161], v[160:161], v[212:213]
    v_pk_add_f32 v[162:163], v[162:163], v[214:215]
    v_pk_add_f32 v[160:161], v[160:161], v[216:217]
    v_pk_add_f32 v[162:163], v[162:163], v[218:219]
    v_pk_add_f32 v[160:161], v[160:161], v[220:221]
    v_pk_add_f32 v[162:163], v[162:163], v[222:223]
    v_cvt_pk_bf16_f32 v160, v160, v161
    v_cvt_pk_bf16_f32 v161, v162, v163
    v_mul_u32_u24 v8, 13108, v0
    v_lshrrev_b32 v8, 16, v8
    v_mul_u32_u24 v9, 5, v8
    v_sub_u32 v9, v0, v9
    v_cmp_gt_u32 vcc, 95, v0
    s_nop 3
    s_mov_b64 s[48:49], vcc
    v_cmp_gt_u32 s[52:53], 4, v9
    v_cmp_eq_u32 vcc, 18, v8
    s_nop 3
    s_and_b64 s[52:53], s[52:53], s[48:49]
    s_mov_b64 exec, s[48:49]
    ds_write_b16 v253, v160
    ds_write_b16_d16_hi v253, v160 offset:16
    s_mov_b64 exec, s[52:53]
    ds_write_b16 v253, v161 offset:32
    ds_write_b16_d16_hi v253, v161 offset:48
    s_and_b64 s[48:49], s[48:49], vcc
    s_and_b64 s[52:53], s[52:53], vcc
    s_cmp_eq_u64 s[48:49], 0
    s_cbranch_scc1 kvr_6_nd
    s_mov_b64 exec, s[48:49]
    ds_write_b16 v254, v160
    ds_write_b16_d16_hi v254, v160 offset:16
    s_mov_b64 exec, s[52:53]
    ds_write_b16 v254, v161 offset:32
    ds_write_b16_d16_hi v254, v161 offset:48
kvr_6_nd:
    s_mov_b64 exec, -1
    s_mov_b64 vcc, s[92:93]
kvr_6:
    v_exp_f32 v81, v81
    v_cvt_pk_bf16_f32 v134, v76, v77
    v_cvt_pk_bf16_f32 v135, v78, v79
    v_exp_f32 v82, v82
    v_exp_f32 v83, v83
    s_waitcnt lgkmcnt(0)
    v_mfma_f32_32x32x16_bf16 v[32:47], v[156:159], v[132:135], v[32:47]
    v_exp_f32 v84, v84
    v_exp_f32 v85, v85
    v_mov_b32 v8, 2
    s_mov_b64 exec, 1
    ds_write_b32 v150, v8
    s_mov_b64 exec, -1
    v_exp_f32 v86, v86
    v_exp_f32 v87, v87
    v_mfma_f32_32x32x16_bf16 v[112:127], v[144:147], v[20:23], v[112:127]
    ds_read_b64_tr_b16 v[144:145], v4 offset:9472
    ds_read_b64_tr_b16 v[146:147], v4 offset:9504
    v_exp_f32 v88, v88
    v_cvt_pk_bf16_f32 v136, v80, v81
    v_cvt_pk_bf16_f32 v137, v82, v83
    v_exp_f32 v89, v89
    v_cvt_pk_bf16_f32 v138, v84, v85
    v_cvt_pk_bf16_f32 v139, v86, v87
    v_exp_f32 v90, v90
    v_exp_f32 v91, v91
    v_exp_f32 v92, v92
    v_exp_f32 v93, v93
    v_exp_f32 v94, v94
    v_exp_f32 v95, v95
    v_mfma_f32_32x32x16_bf16 v[48:63], v[152:155], v[136:139], v[48:63]
    ds_read_b128 v[152:155], v6 offset:5952
    v_exp_f32 v96, v96
    v_cvt_pk_bf16_f32 v140, v88, v89
    v_cvt_pk_bf16_f32 v141, v90, v91
    v_exp_f32 v97, v97
    v_cvt_pk_bf16_f32 v142, v92, v93
    v_cvt_pk_bf16_f32 v143, v94, v95
    v_mfma_f32_32x32x4bf16_1k v[64:95], v[148:149], v[24:25], 0
    ds_read_b64_tr_b16 v[148:149], v7 offset:9472
    v_exp_f32 v98, v98
    v_exp_f32 v99, v99
    v_exp_f32 v100, v100
    v_exp_f32 v101, v101
    v_exp_f32 v102, v102
    v_exp_f32 v103, v103
    v_exp_f32 v104, v104
    v_mfma_f32_32x32x16_bf16 v[48:63], v[156:159], v[140:143], v[48:63]
    ds_read_b128 v[156:159], v6 offset:6560
    v_cvt_pk_bf16_f32 v128, v96, v97
    v_cvt_pk_bf16_f32 v129, v98, v99
    v_exp_f32 v105, v105
    v_cvt_pk_bf16_f32 v130, v100, v101
    v_cvt_pk_bf16_f32 v131, v102, v103
    v_exp_f32 v106, v106
    v_exp_f32 v107, v107
    s_waitcnt lgkmcnt(2)
    v_mfma_f32_32x32x16_bf16 v[32:47], v[152:155], v[128:131], v[32:47]
    v_exp_f32 v108, v108
    v_exp_f32 v109, v109
    v_exp_f32 v110, v110
    v_exp_f32 v111, v111
    v_mfma_f32_32x32x16_bf16 v[64:79], v[144:147], v[16:19], v[64:79]
    v_exp_f32 v112, v112
    v_cvt_pk_bf16_f32 v132, v104, v105
    v_cvt_pk_bf16_f32 v133, v106, v107
    v_exp_f32 v113, v113
    v_cvt_pk_bf16_f32 v134, v108, v109
    v_cvt_pk_bf16_f32 v135, v110, v111
    v_exp_f32 v114, v114
    v_exp_f32 v115, v115
    s_waitcnt lgkmcnt(0)
    v_mfma_f32_32x32x16_bf16 v[32:47], v[156:159], v[132:135], v[32:47]
    v_exp_f32 v116, v116
    v_exp_f32 v117, v117
    v_exp_f32 v118, v118
    v_exp_f32 v119, v119
    v_mfma_f32_32x32x16_bf16 v[80:95], v[144:147], v[20:23], v[80:95]
    ds_read_b64_tr_b16 v[144:145], v4 offset:10624
    ds_read_b64_tr_b16 v[146:147], v4 offset:10656
    v_exp_f32 v120, v120
    v_cvt_pk_bf16_f32 v136, v112, v113
    v_cvt_pk_bf16_f32 v137, v114, v115
    v_exp_f32 v121, v121
    v_cvt_pk_bf16_f32 v138, v116, v117
    v_cvt_pk_bf16_f32 v139, v118, v119
    v_exp_f32 v122, v122
    v_exp_f32 v123, v123
    v_exp_f32 v124, v124
    v_exp_f32 v125, v125
    v_exp_f32 v126, v126
    v_exp_f32 v127, v127
    v_mfma_f32_32x32x16_bf16 v[48:63], v[152:155], v[136:139], v[48:63]
    ds_read_b128 v[152:155], v6 offset:9472
    v_add_u32 v4, 9472, v4
    v_add_u32 v5, 9472, v5
    v_add_u32 v7, 9472, v7
    v_add_u32 v6, 9472, v6
    s_mov_b32 s48, 0x3fb8aa3b
    s_mov_b32 s49, 0x3fb8aa3b
    s_mov_b32 s52, 0x358637bd
    s_mov_b32 s53, 0x358637bd
    s_mov_b32 s54, 0.5
    s_mov_b32 s55, 0.5
    s_lshl_b32 s47, s32, 8
    s_lshl_b32 s51, s3, 5
    s_add_u32 s47, s47, s51
    s_mul_i32 s43, s3, 1152
    s_add_u32 s43, s43, 152832
    s_mov_b64 vcc, s[92:93]
    s_cbranch_vccz cy_8
    s_setprio 1
cy_8:
    v_exp_f32 v64, v64
    v_cvt_pk_bf16_f32 v140, v120, v121
    v_cvt_pk_bf16_f32 v141, v122, v123
    v_exp_f32 v65, v65
    v_cvt_pk_bf16_f32 v142, v124, v125
    v_cvt_pk_bf16_f32 v143, v126, v127
    v_mfma_f32_32x32x4bf16_1k v[96:127], v[148:149], v[24:25], 0
    ds_read_b64_tr_b16 v[148:149], v5 offset:4736
    v_exp_f32 v66, v66
    v_exp_f32 v67, v67
    v_exp_f32 v68, v68
    v_exp_f32 v69, v69
    v_exp_f32 v70, v70
    v_exp_f32 v71, v71
    v_exp_f32 v72, v72
    v_mfma_f32_32x32x16_bf16 v[48:63], v[156:159], v[140:143], v[48:63]
    ds_read_b128 v[156:159], v6 offset:608
    v_cvt_pk_bf16_f32 v128, v64, v65
    v_cvt_pk_bf16_f32 v129, v66, v67
    v_exp_f32 v73, v73
    v_cvt_pk_bf16_f32 v130, v68, v69
    v_cvt_pk_bf16_f32 v131, v70, v71
    v_exp_f32 v74, v74
    v_exp_f32 v75, v75
    s_waitcnt lgkmcnt(2)
    v_mfma_f32_32x32x16_bf16 v[32:47], v[152:155], v[128:131], v[32:47]
    v_exp_f32 v76, v76
    v_mov_b32 v9, 152736
    ds_read_b128 v[12:15], v9
    ds_read_b128 v[8:11], v9 offset:16
    v_exp_f32 v77, v77
    v_exp_f32 v78, v78
    v_exp_f32 v79, v79
    v_mfma_f32_32x32x16_bf16 v[96:111], v[144:147], v[16:19], v[96:111]
    v_exp_f32 v80, v80
    v_cvt_pk_bf16_f32 v132, v72, v73
    v_cvt_pk_bf16_f32 v133, v74, v75
    v_exp_f32 v81, v81
    v_cvt_pk_bf16_f32 v134, v76, v77
    v_cvt_pk_bf16_f32 v135, v78, v79
    v_exp_f32 v82, v82
    v_exp_f32 v83, v83
    s_waitcnt lgkmcnt(0)
    v_mfma_f32_32x32x16_bf16 v[32:47], v[156:159], v[132:135], v[32:47]
    v_exp_f32 v84, v84
    v_min3_u32 v12, v12, v13, v14
    v_min_u32 v12, v12, v15
    v_min3_u32 v8, v8, v9, v10
    v_min3_u32 v12, v12, v8, v11
    s_nop 0
    v_readfirstlane_b32 s50, v12
    s_cmp_ge_u32 s50, 2
    s_cbranch_scc0 chk_7_spin
chk_7_back:
    v_exp_f32 v85, v85
    v_add_u32 v8, s43, v249
    v_add_u32 v9, s43, v3
    v_add_u32 v10, 151552, v249
    v_add_u32 v11, 151552, v3
    v_exp_f32 v86, v86
    v_exp_f32 v87, v87
    v_mfma_f32_32x32x16_bf16 v[112:127], v[144:147], v[20:23], v[112:127]
    ds_read_b64_tr_b16 v[144:145], v4 offset:4736
    ds_read_b64_tr_b16 v[146:147], v4 offset:4768
    v_exp_f32 v88, v88
    ds_read_b64_tr_b16 v[26:27], v8
    ds_read_b64_tr_b16 v[28:29], v8 offset:32
    ds_read_b64_tr_b16 v[30:31], v9
    ds_read_b64_tr_b16 v[192:193], v10
    ds_read_b64_tr_b16 v[194:195], v10 offset:32
    ds_read_b64_tr_b16 v[196:197], v11
    v_cvt_pk_bf16_f32 v136, v80, v81
    v_cvt_pk_bf16_f32 v137, v82, v83
    v_exp_f32 v89, v89
    v_cvt_pk_bf16_f32 v138, v84, v85
    v_cvt_pk_bf16_f32 v139, v86, v87
    v_exp_f32 v90, v90
    v_exp_f32 v91, v91
    v_exp_f32 v92, v92
    v_exp_f32 v93, v93
    v_exp_f32 v94, v94
    v_exp_f32 v95, v95
    v_mfma_f32_32x32x16_bf16 v[48:63], v[152:155], v[136:139], v[48:63]
    ds_read_b128 v[152:155], v6 offset:1216
    v_exp_f32 v96, v96
    v_cvt_pk_bf16_f32 v140, v88, v89
    v_cvt_pk_bf16_f32 v141, v90, v91
    v_exp_f32 v97, v97
    v_cvt_pk_bf16_f32 v142, v92, v93
    v_cvt_pk_bf16_f32 v143, v94, v95
    v_mfma_f32_32x32x4bf16_1k v[64:95], v[148:149], v[24:25], 0
    ds_read_b64_tr_b16 v[148:149], v7 offset:4736
    v_exp_f32 v98, v98
    v_exp_f32 v99, v99
    v_exp_f32 v100, v100
    v_exp_f32 v101, v101
    v_exp_f32 v102, v102
    v_exp_f32 v103, v103
    v_exp_f32 v104, v104
    v_mfma_f32_32x32x16_bf16 v[48:63], v[156:159], v[140:143], v[48:63]
    ds_read_b128 v[156:159], v6 offset:1824
    v_cvt_pk_bf16_f32 v128, v96, v97
    v_cvt_pk_bf16_f32 v129, v98, v99
    v_exp_f32 v105, v105
    v_cvt_pk_bf16_f32 v130, v100, v101
    v_cvt_pk_bf16_f32 v131, v102, v103
    v_exp_f32 v106, v106
    v_exp_f32 v107, v107
    s_waitcnt lgkmcnt(2)
    v_mfma_f32_32x32x16_bf16 v[32:47], v[152:155], v[128:131], v[32:47]
    v_exp_f32 v108, v108
    v_exp_f32 v109, v109
    v_lshlrev_b32 v160, 16, v26
    v_and_b32 v161, 0xffff0000, v26
    v_lshlrev_b32 v162, 16, v27
    v_and_b32 v163, 0xffff0000, v27
    v_lshlrev_b32 v164, 16, v28
    v_and_b32 v165, 0xffff0000, v28
    v_exp_f32 v110, v110
    v_exp_f32 v111, v111
    v_mfma_f32_32x32x16_bf16 v[64:79], v[144:147], v[16:19], v[64:79]
    v_exp_f32 v112, v112
    v_cvt_pk_bf16_f32 v132, v104, v105
    v_cvt_pk_bf16_f32 v133, v106, v107
    v_exp_f32 v113, v113
    v_lshlrev_b32 v166, 16, v29
    v_and_b32 v167, 0xffff0000, v29
    v_lshlrev_b32 v168, 16, v30
    v_and_b32 v169, 0xffff0000, v30
    v_pk_mul_f32 v[176:177], v[160:161], s[48:49]
    v_pk_mul_f32 v[178:179], v[162:163], s[48:49]
    v_cvt_pk_bf16_f32 v134, v108, v109
    v_cvt_pk_bf16_f32 v135, v110, v111
    v_exp_f32 v114, v114
    v_exp_f32 v115, v115
    s_waitcnt lgkmcnt(0)
    v_mfma_f32_32x32x16_bf16 v[32:47], v[156:159], v[132:135], v[32:47]
    v_exp_f32 v116, v116
    v_exp_f32 v117, v117
    v_pk_mul_f32 v[180:181], v[164:165], s[48:49]
    v_pk_mul_f32 v[182:183], v[166:167], s[48:49]
    v_pk_mul_f32 v[184:185], v[168:169], s[48:49]
    v_exp_f32_e64 v176, v176 clamp
    v_exp_f32_e64 v177, v177 clamp
    v_exp_f32_e64 v178, v178 clamp
    v_exp_f32 v118, v118
    v_exp_f32 v119, v119
    v_mfma_f32_32x32x16_bf16 v[80:95], v[144:147], v[20:23], v[80:95]
    ds_read_b64_tr_b16 v[144:145], v4 offset:5888
    ds_read_b64_tr_b16 v[146:147], v4 offset:5920
    v_exp_f32 v120, v120
    v_cvt_pk_bf16_f32 v136, v112, v113
    v_cvt_pk_bf16_f32 v137, v114, v115
    v_exp_f32 v121, v121
    v_exp_f32_e64 v179, v179 clamp
    v_exp_f32_e64 v180, v180 clamp
    v_exp_f32_e64 v181, v181 clamp
    v_exp_f32_e64 v182, v182 clamp
    v_exp_f32_e64 v183, v183 clamp
    v_exp_f32_e64 v184, v184 clamp
    v_cvt_pk_bf16_f32 v138, v116, v117
    v_cvt_pk_bf16_f32 v139, v118, v119
    v_exp_f32 v122, v122
    v_exp_f32 v123, v123
    v_exp_f32 v124, v124
    v_exp_f32 v125, v125
    v_exp_f32_e64 v185, v185 clamp
    v_add_f32_e64 v160, v160, |v160|
    v_exp_f32 v126, v126
    v_exp_f32 v127, v127
    v_mfma_f32_32x32x16_bf16 v[48:63], v[152:155], v[136:139], v[48:63]
    ds_read_b128 v[152:155], v6 offset:4736
    v_exp_f32 v64, v64
    v_cvt_pk_bf16_f32 v140, v120, v121
    v_add_f32_e64 v161, v161, |v161|
    v_add_f32_e64 v162, v162, |v162|
    v_add_f32_e64 v163, v163, |v163|
    v_add_f32_e64 v164, v164, |v164|
    v_add_f32_e64 v165, v165, |v165|
    v_add_f32_e64 v166, v166, |v166|
    v_cvt_pk_bf16_f32 v141, v122, v123
    v_exp_f32 v65, v65
    v_cvt_pk_bf16_f32 v142, v124, v125
    v_cvt_pk_bf16_f32 v143, v126, v127
    v_mfma_f32_32x32x4bf16_1k v[96:127], v[148:149], v[24:25], 0
    ds_read_b64_tr_b16 v[148:149], v5 offset:9472
    v_exp_f32 v66, v66
    v_exp_f32 v67, v67
    v_add_f32_e64 v167, v167, |v167|
    v_add_f32_e64 v168, v168, |v168|
    v_add_f32_e64 v169, v169, |v169|
    v_pk_fma_f32 v[160:161], v[160:161], s[54:55], v[176:177]
    v_pk_fma_f32 v[162:163], v[162:163], s[54:55], v[178:179]
    v_pk_fma_f32 v[164:165], v[164:165], s[54:55], v[180:181]
    v_exp_f32 v68, v68
    v_exp_f32 v69, v69
    v_exp_f32 v70, v70
    v_exp_f32 v71, v71
    v_exp_f32 v72, v72
    v_mfma_f32_32x32x16_bf16 v[48:63], v[156:159], v[140:143], v[48:63]
    ds_read_b128 v[156:159], v6 offset:5344
    v_cvt_pk_bf16_f32 v128, v64, v65
    v_pk_fma_f32 v[166:167], v[166:167], s[54:55], v[182:183]
    v_pk_fma_f32 v[168:169], v[168:169], s[54:55], v[184:185]
    v_pk_add_f32 v[160:161], v[160:161], s[52:53]
    v_pk_add_f32 v[162:163], v[162:163], s[52:53]
    v_pk_add_f32 v[164:165], v[164:165], s[52:53]
    v_pk_add_f32 v[166:167], v[166:167], s[52:53]
    v_cvt_pk_bf16_f32 v129, v66, v67
    v_exp_f32 v73, v73
    v_cvt_pk_bf16_f32 v130, v68, v69
    v_cvt_pk_bf16_f32 v131, v70, v71
    v_exp_f32 v74, v74
    v_exp_f32 v75, v75
    s_waitcnt lgkmcnt(2)
    v_mfma_f32_32x32x16_bf16 v[32:47], v[152:155], v[128:131], v[32:47]
    v_exp_f32 v76, v76
    v_exp_f32 v77, v77
    v_pk_add_f32 v[168:169], v[168:169], s[52:53]
    v_cvt_pk_bf16_f32 v26, v160, v161
    v_cvt_pk_bf16_f32 v27, v162, v163
    v_cvt_pk_bf16_f32 v28, v164, v165
    v_cvt_pk_bf16_f32 v29, v166, v167
    v_cvt_pk_bf16_f32 v30, v168, v169
    v_exp_f32 v78, v78
    v_exp_f32 v79, v79
    v_mfma_f32_32x32x16_bf16 v[96:111], v[144:147], v[16:19], v[96:111]
    v_exp_f32 v80, v80
    v_cvt_pk_bf16_f32 v132, v72, v73
    v_cvt_pk_bf16_f32 v133, v74, v75
    v_exp_f32 v81, v81
    v_mov_b32 v31, 0
    v_mov_b32 v197, 0
    v_cvt_pk_bf16_f32 v134, v76, v77
    v_cvt_pk_bf16_f32 v135, v78, v79
    v_exp_f32 v82, v82
    v_exp_f32 v83, v83
    s_waitcnt lgkmcnt(0)
    v_mfma_f32_32x32x16_bf16 v[32:47], v[156:159], v[132:135], v[32:47]
    v_exp_f32 v84, v84
    v_exp_f32 v85, v85
    v_mfma_f32_32x32x4bf16_1k v[208:239], v[196:197], v[30:31], 0
    v_exp_f32 v86, v86
    v_exp_f32 v87, v87
    v_mfma_f32_32x32x16_bf16 v[112:127], v[144:147], v[20:23], v[112:127]
    ds_read_b64_tr_b16 v[144:145], v4 offset:9472
    ds_read_b64_tr_b16 v[146:147], v4 offset:9504
    v_exp_f32 v88, v88
    v_cvt_pk_bf16_f32 v136, v80, v81
    v_cvt_pk_bf16_f32 v137, v82, v83
    v_exp_f32 v89, v89
    v_cvt_pk_bf16_f32 v138, v84, v85
    v_cvt_pk_bf16_f32 v139, v86, v87
    v_exp_f32 v90, v90
    v_exp_f32 v91, v91
    v_exp_f32 v92, v92
    v_exp_f32 v93, v93
    v_exp_f32 v94, v94
    v_exp_f32 v95, v95
    v_mfma_f32_32x32x16_bf16 v[48:63], v[152:155], v[136:139], v[48:63]
    ds_read_b128 v[152:155], v6 offset:5952
    v_exp_f32 v96, v96
    v_cvt_pk_bf16_f32 v140, v88, v89
    v_cvt_pk_bf16_f32 v141, v90, v91
    v_exp_f32 v97, v97
    v_cvt_pk_bf16_f32 v142, v92, v93
    v_cvt_pk_bf16_f32 v143, v94, v95
    v_mfma_f32_32x32x4bf16_1k v[64:95], v[148:149], v[24:25], 0
    ds_read_b64_tr_b16 v[148:149], v7 offset:9472
    v_exp_f32 v98, v98
    v_exp_f32 v99, v99
    v_exp_f32 v100, v100
    v_mfma_f32_32x32x16_bf16 v[208:223], v[192:195], v[26:29], v[208:223]
    v_exp_f32 v101, v101
    v_exp_f32 v102, v102
    v_exp_f32 v103, v103
    v_exp_f32 v104, v104
    v_mfma_f32_32x32x16_bf16 v[48:63], v[156:159], v[140:143], v[48:63]
    ds_read_b128 v[156:159], v6 offset:6560
    v_cvt_pk_bf16_f32 v128, v96, v97
    v_cvt_pk_bf16_f32 v129, v98, v99
    v_exp_f32 v105, v105
    v_cvt_pk_bf16_f32 v130, v100, v101
    v_cvt_pk_bf16_f32 v131, v102, v103
    v_exp_f32 v106, v106
    v_exp_f32 v107, v107
    s_waitcnt lgkmcnt(2)
    v_mfma_f32_32x32x16_bf16 v[32:47], v[152:155], v[128:131], v[32:47]
    v_exp_f32 v108, v108
    v_exp_f32 v109, v109
    v_exp_f32 v110, v110
    v_cmp_gt_u32 s[96:97], 32, v1
    v_and_b32 v12, 31, v1
    v_add_u32 v12, s47, v12
    v_lshrrev_b32 v13, 5, v1
    v_cndmask_b32 v14, v220, v218, s[96:97]
    v_exp_f32 v111, v111
    v_mfma_f32_32x32x16_bf16 v[64:79], v[144:147], v[16:19], v[64:79]
    v_exp_f32 v112, v112
    v_cvt_pk_bf16_f32 v132, v104, v105
    v_cvt_pk_bf16_f32 v133, v106, v107
    v_exp_f32 v113, v113
    v_lshlrev_b32 v13, 4, v13
    v_add_f32 v14, 0x358637bd, v14
    v_lshl_add_u32 v10, v12, 5, v13
    v_rcp_f32 v14, v14
    v_lshlrev_b32 v12, 2, v12
    v_cvt_pk_bf16_f32 v134, v108, v109
    v_cvt_pk_bf16_f32 v135, v110, v111
    v_exp_f32 v114, v114
    v_exp_f32 v115, v115
    s_waitcnt lgkmcnt(0)
    v_mfma_f32_32x32x16_bf16 v[32:47], v[156:159], v[132:135], v[32:47]
    v_exp_f32 v116, v116
    v_exp_f32 v117, v117
    v_mov_b32 v13, 1073741824
    v_cndmask_b32 v11, v13, v12, s[96:97]
    v_mov_b32 v15, v14
    v_pk_mul_f32 v[208:209], v[208:209], v[14:15]
    v_pk_mul_f32 v[210:211], v[210:211], v[14:15]
    v_exp_f32 v118, v118
    v_exp_f32 v119, v119
    v_mfma_f32_32x32x16_bf16 v[80:95], v[144:147], v[20:23], v[80:95]
    ds_read_b64_tr_b16 v[144:145], v4 offset:10624
    ds_read_b64_tr_b16 v[146:147], v4 offset:10656
    v_exp_f32 v120, v120
    v_cvt_pk_bf16_f32 v136, v112, v113
    v_cvt_pk_bf16_f32 v137, v114, v115
    v_pk_mul_f32 v[212:213], v[212:213], v[14:15]
    v_pk_mul_f32 v[214:215], v[214:215], v[14:15]
    v_pk_mul_f32 v[216:217], v[216:217], v[14:15]
    v_cvt_pk_bf16_f32 v12, v208, v209
    v_cvt_pk_bf16_f32 v13, v210, v211
    v_exp_f32 v121, v121
    v_cvt_pk_bf16_f32 v138, v116, v117
    v_cvt_pk_bf16_f32 v139, v118, v119
    v_exp_f32 v122, v122
    v_exp_f32 v123, v123
    v_cvt_pk_bf16_f32 v14, v212, v213
    v_cvt_pk_bf16_f32 v15, v214, v215
    v_cvt_pk_bf16_f32 v9, v216, v217
    v_exp_f32 v124, v124
    v_exp_f32 v125, v125
    v_exp_f32 v126, v126
    v_exp_f32 v127, v127
    v_mfma_f32_32x32x16_bf16 v[48:63], v[152:155], v[136:139], v[48:63]
    ds_read_b128 v[152:155], v6 offset:9472
    v_add_u32 v4, 9472, v4
    v_add_u32 v5, 9472, v5
    v_add_u32 v7, 9472, v7
    v_add_u32 v6, 9472, v6
    s_mov_b64 vcc, s[92:93]
    s_cbranch_vccz cy_10
    s_setprio 1
cy_10:
    v_exp_f32 v64, v64
    v_cvt_pk_bf16_f32 v140, v120, v121
    v_cvt_pk_bf16_f32 v141, v122, v123
    v_exp_f32 v65, v65
    v_cvt_pk_bf16_f32 v142, v124, v125
    s_mul_i32 s51, s31, 65536
    s_add_u32 s51, s51, 10354688
    buffer_store_dwordx4 v[12:15], v10, s[8:11], s51 offen sc1
    s_mul_i32 s51, s31, 8192
    s_add_u32 s51, s51, 14548992
    buffer_store_dword v9, v11, s[8:11], s51 offen sc1
    v_cvt_pk_bf16_f32 v143, v126, v127
    v_mfma_f32_32x32x4bf16_1k v[96:127], v[148:149], v[24:25], 0
    ds_read_b64_tr_b16 v[148:149], v5 offset:4736
    v_exp_f32 v66, v66
    v_exp_f32 v67, v67
    v_exp_f32 v68, v68
    v_exp_f32 v69, v69
    v_exp_f32 v70, v70
    v_exp_f32 v71, v71
    v_exp_f32 v72, v72
    v_mfma_f32_32x32x16_bf16 v[48:63], v[156:159], v[140:143], v[48:63]
    ds_read_b128 v[156:159], v6 offset:608
    v_cvt_pk_bf16_f32 v128, v64, v65
    v_cvt_pk_bf16_f32 v129, v66, v67
    v_exp_f32 v73, v73
    v_cvt_pk_bf16_f32 v130, v68, v69
    v_cvt_pk_bf16_f32 v131, v70, v71
    v_exp_f32 v74, v74
    v_exp_f32 v75, v75
    s_waitcnt lgkmcnt(2)
    v_mfma_f32_32x32x16_bf16 v[32:47], v[152:155], v[128:131], v[32:47]
    v_exp_f32 v76, v76
    v_lshlrev_b32 v8, 4, v1
    s_mov_b32 s50, 16547840
    buffer_load_dwordx4 v[164:167], v8, s[8:11], s50 offen sc1
    v_exp_f32 v77, v77
    v_exp_f32 v78, v78
    v_exp_f32 v79, v79
    v_mfma_f32_32x32x16_bf16 v[96:111], v[144:147], v[16:19], v[96:111]
    v_exp_f32 v80, v80
    v_cvt_pk_bf16_f32 v132, v72, v73
    v_cvt_pk_bf16_f32 v133, v74, v75
    v_exp_f32 v81, v81
    v_cvt_pk_bf16_f32 v134, v76, v77
    v_cvt_pk_bf16_f32 v135, v78, v79
    v_exp_f32 v82, v82
    v_exp_f32 v83, v83
    s_waitcnt lgkmcnt(0)
    v_mfma_f32_32x32x16_bf16 v[32:47], v[156:159], v[132:135], v[32:47]
    v_exp_f32 v84, v84
    v_exp_f32 v85, v85
    v_exp_f32 v86, v86
    v_exp_f32 v87, v87
    v_mfma_f32_32x32x16_bf16 v[112:127], v[144:147], v[20:23], v[112:127]
    ds_read_b64_tr_b16 v[144:145], v4 offset:4736
    ds_read_b64_tr_b16 v[146:147], v4 offset:4768
    v_exp_f32 v88, v88
    v_cvt_pk_bf16_f32 v136, v80, v81
    v_cvt_pk_bf16_f32 v137, v82, v83
    v_exp_f32 v89, v89
    v_cvt_pk_bf16_f32 v138, v84, v85
    v_cvt_pk_bf16_f32 v139, v86, v87
    v_exp_f32 v90, v90
    v_exp_f32 v91, v91
    v_exp_f32 v92, v92
    v_exp_f32 v93, v93
    v_exp_f32 v94, v94
    v_exp_f32 v95, v95
    v_mfma_f32_32x32x16_bf16 v[48:63], v[152:155], v[136:139], v[48:63]
    ds_read_b128 v[152:155], v6 offset:1216
    v_exp_f32 v96, v96
    v_cvt_pk_bf16_f32 v140, v88, v89
    v_cvt_pk_bf16_f32 v141, v90, v91
    v_exp_f32 v97, v97
    v_cvt_pk_bf16_f32 v142, v92, v93
    v_cvt_pk_bf16_f32 v143, v94, v95
    v_mfma_f32_32x32x4bf16_1k v[64:95], v[148:149], v[24:25], 0
    ds_read_b64_tr_b16 v[148:149], v7 offset:4736
    v_exp_f32 v98, v98
    v_exp_f32 v99, v99
    v_exp_f32 v100, v100
    v_exp_f32 v101, v101
    v_exp_f32 v102, v102
    v_exp_f32 v103, v103
    v_exp_f32 v104, v104
    v_mfma_f32_32x32x16_bf16 v[48:63], v[156:159], v[140:143], v[48:63]
    ds_read_b128 v[156:159], v6 offset:1824
    v_cvt_pk_bf16_f32 v128, v96, v97
    v_cvt_pk_bf16_f32 v129, v98, v99
    v_exp_f32 v105, v105
    v_cvt_pk_bf16_f32 v130, v100, v101
    v_cvt_pk_bf16_f32 v131, v102, v103
    v_exp_f32 v106, v106
    v_exp_f32 v107, v107
    s_waitcnt lgkmcnt(2)
    v_mfma_f32_32x32x16_bf16 v[32:47], v[152:155], v[128:131], v[32:47]
    v_exp_f32 v108, v108
    v_exp_f32 v109, v109
    v_exp_f32 v110, v110
    v_exp_f32 v111, v111
    v_mfma_f32_32x32x16_bf16 v[64:79], v[144:147], v[16:19], v[64:79]
    v_exp_f32 v112, v112
    v_cvt_pk_bf16_f32 v132, v104, v105
    v_cvt_pk_bf16_f32 v133, v106, v107
    v_exp_f32 v113, v113
    v_cvt_pk_bf16_f32 v134, v108, v109
    v_cvt_pk_bf16_f32 v135, v110, v111
    v_exp_f32 v114, v114
    v_exp_f32 v115, v115
    s_waitcnt lgkmcnt(0)
    v_mfma_f32_32x32x16_bf16 v[32:47], v[156:159], v[132:135], v[32:47]
    v_exp_f32 v116, v116
    v_exp_f32 v117, v117
    v_exp_f32 v118, v118
    v_exp_f32 v119, v119
    v_mfma_f32_32x32x16_bf16 v[80:95], v[144:147], v[20:23], v[80:95]
    ds_read_b64_tr_b16 v[144:145], v4 offset:5888
    ds_read_b64_tr_b16 v[146:147], v4 offset:5920
    v_exp_f32 v120, v120
    v_cvt_pk_bf16_f32 v136, v112, v113
    v_cvt_pk_bf16_f32 v137, v114, v115
    v_exp_f32 v121, v121
    v_cvt_pk_bf16_f32 v138, v116, v117
    v_cvt_pk_bf16_f32 v139, v118, v119
    v_exp_f32 v122, v122
    v_exp_f32 v123, v123
    v_exp_f32 v124, v124
    v_exp_f32 v125, v125
    v_exp_f32 v126, v126
    v_exp_f32 v127, v127
    v_mfma_f32_32x32x16_bf16 v[48:63], v[152:155], v[136:139], v[48:63]
    ds_read_b128 v[152:155], v6 offset:4736
    v_exp_f32 v64, v64
    v_cvt_pk_bf16_f32 v140, v120, v121
    v_cvt_pk_bf16_f32 v141, v122, v123
    v_exp_f32 v65, v65
    v_cvt_pk_bf16_f32 v142, v124, v125
    v_cvt_pk_bf16_f32 v143, v126, v127
    v_mfma_f32_32x32x4bf16_1k v[96:127], v[148:149], v[24:25], 0
    ds_read_b64_tr_b16 v[148:149], v5 offset:9472
    v_exp_f32 v66, v66
    v_exp_f32 v67, v67
    v_exp_f32 v68, v68
    v_exp_f32 v69, v69
    v_exp_f32 v70, v70
    v_exp_f32 v71, v71
    v_exp_f32 v72, v72
    v_mfma_f32_32x32x16_bf16 v[48:63], v[156:159], v[140:143], v[48:63]
    ds_read_b128 v[156:159], v6 offset:5344
    v_cvt_pk_bf16_f32 v128, v64, v65
    v_cvt_pk_bf16_f32 v129, v66, v67
    v_exp_f32 v73, v73
    v_cvt_pk_bf16_f32 v130, v68, v69
    v_cvt_pk_bf16_f32 v131, v70, v71
    v_exp_f32 v74, v74
    v_exp_f32 v75, v75
    s_waitcnt lgkmcnt(2)
    v_mfma_f32_32x32x16_bf16 v[32:47], v[152:155], v[128:131], v[32:47]
    v_exp_f32 v76, v76
    v_exp_f32 v77, v77
    v_exp_f32 v78, v78
    v_exp_f32 v79, v79
    v_mfma_f32_32x32x16_bf16 v[96:111], v[144:147], v[16:19], v[96:111]
    v_exp_f32 v80, v80
    v_cvt_pk_bf16_f32 v132, v72, v73
    v_cvt_pk_bf16_f32 v133, v74, v75
    s_waitcnt vmcnt(0)
    v_mov_b32 v8, 1
    v_mov_b32 v9, 152768
    s_mov_b64 exec, 1
    ds_add_rtn_u32 v10, v9, v8
    s_mov_b64 exec, -1
    v_exp_f32 v81, v81
    v_cvt_pk_bf16_f32 v134, v76, v77
    v_cvt_pk_bf16_f32 v135, v78, v79
    v_exp_f32 v82, v82
    v_exp_f32 v83, v83
    s_waitcnt lgkmcnt(0)
    v_mfma_f32_32x32x16_bf16 v[32:47], v[156:159], v[132:135], v[32:47]
    v_exp_f32 v84, v84
    s_nop 0
    v_readfirstlane_b32 s50, v10
    s_cmp_eq_u32 s50, 7
    s_cbranch_scc1 sga_9_do
sga_9_back:
    v_exp_f32 v85, v85
    v_exp_f32 v86, v86
    v_exp_f32 v87, v87
    v_mfma_f32_32x32x16_bf16 v[112:127], v[144:147], v[20:23], v[112:127]
    ds_read_b64_tr_b16 v[144:145], v4 offset:9472
    ds_read_b64_tr_b16 v[146:147], v4 offset:9504
    v_exp_f32 v88, v88
    v_cvt_pk_bf16_f32 v136, v80, v81
    v_cvt_pk_bf16_f32 v137, v82, v83
    v_exp_f32 v89, v89
    v_cvt_pk_bf16_f32 v138, v84, v85
    v_cvt_pk_bf16_f32 v139, v86, v87
    v_exp_f32 v90, v90
    v_exp_f32 v91, v91
    v_exp_f32 v92, v92
    v_exp_f32 v93, v93
    v_exp_f32 v94, v94
    v_exp_f32 v95, v95
    v_mfma_f32_32x32x16_bf16 v[48:63], v[152:155], v[136:139], v[48:63]
    ds_read_b128 v[152:155], v6 offset:5952
    s_cbranch_vccz cy_11
    s_setprio 0
cy_11:
    v_exp_f32 v96, v96
    v_cvt_pk_bf16_f32 v140, v88, v89
    v_cvt_pk_bf16_f32 v141, v90, v91
    v_exp_f32 v97, v97
    v_cvt_pk_bf16_f32 v142, v92, v93
    v_cvt_pk_bf16_f32 v143, v94, v95
    v_mfma_f32_32x32x4bf16_1k v[64:95], v[148:149], v[24:25], 0
    ds_read_b64_tr_b16 v[148:149], v7 offset:9472
    v_exp_f32 v98, v98
    v_exp_f32 v99, v99
    v_exp_f32 v100, v100
    v_exp_f32 v101, v101
    v_exp_f32 v102, v102
    v_exp_f32 v103, v103
    v_exp_f32 v104, v104
    v_mfma_f32_32x32x16_bf16 v[48:63], v[156:159], v[140:143], v[48:63]
    ds_read_b128 v[156:159], v6 offset:6560
    v_cvt_pk_bf16_f32 v128, v96, v97
    v_cvt_pk_bf16_f32 v129, v98, v99
    v_exp_f32 v105, v105
    v_cvt_pk_bf16_f32 v130, v100, v101
    v_cvt_pk_bf16_f32 v131, v102, v103
    v_exp_f32 v106, v106
    v_exp_f32 v107, v107
    s_waitcnt lgkmcnt(2)
    v_mfma_f32_32x32x16_bf16 v[32:47], v[152:155], v[128:131], v[32:47]
    v_exp_f32 v108, v108
    v_exp_f32 v109, v109
    v_exp_f32 v110, v110
    v_exp_f32 v111, v111
    v_mfma_f32_32x32x16_bf16 v[64:79], v[144:147], v[16:19], v[64:79]
    v_exp_f32 v112, v112
    v_cvt_pk_bf16_f32 v132, v104, v105
    v_cvt_pk_bf16_f32 v133, v106, v107
    v_exp_f32 v113, v113
    v_cvt_pk_bf16_f32 v134, v108, v109
    v_cvt_pk_bf16_f32 v135, v110, v111
    v_exp_f32 v114, v114
    v_exp_f32 v115, v115
    s_waitcnt lgkmcnt(0)
    v_mfma_f32_32x32x16_bf16 v[32:47], v[156:159], v[132:135], v[32:47]
    v_exp_f32 v116, v116
    v_exp_f32 v117, v117
    v_exp_f32 v118, v118
    v_exp_f32 v119, v119
    v_mfma_f32_32x32x16_bf16 v[80:95], v[144:147], v[20:23], v[80:95]
    ds_read_b64_tr_b16 v[144:145], v4 offset:10624
    ds_read_b64_tr_b16 v[146:147], v4 offset:10656
    v_exp_f32 v120, v120
    v_cvt_pk_bf16_f32 v136, v112, v113
    v_cvt_pk_bf16_f32 v137, v114, v115
    v_exp_f32 v121, v121
    v_cvt_pk_bf16_f32 v138, v116, v117
    v_cvt_pk_bf16_f32 v139, v118, v119
    v_exp_f32 v122, v122
    v_exp_f32 v123, v123
    v_exp_f32 v124, v124
    v_exp_f32 v125, v125
    v_exp_f32 v126, v126
    v_exp_f32 v127, v127
    v_mfma_f32_32x32x16_bf16 v[48:63], v[152:155], v[136:139], v[48:63]
    ds_read_b128 v[152:155], v6 offset:9472
    v_add_u32 v4, 9472, v4
    v_add_u32 v5, 9472, v5
    v_add_u32 v7, 9472, v7
    v_add_u32 v6, 9472, v6
    v_xor_b32 v164, s28, v164
    v_xor_b32 v165, s28, v165
    v_xor_b32 v166, s28, v166
    v_xor_b32 v167, s28, v167
    v_or3_b32 v164, v164, v165, v166
    v_or_b32 v164, v164, v167
    v_cmp_eq_u32 vcc, 0, v164
    s_nop 3
    s_cmp_eq_u64 vcc, -1
    s_cbranch_scc1 P2_fl1ok
    v_and_b32 v8, 63, v0
    v_lshlrev_b32 v8, 4, v8
    s_mov_b32 s51, 16547840
    s_mov_b32 s50, 300000
    s_mov_b32 s52, 0xffffffff
    s_mov_b32 s53, 0xffffffff
poll_12:
    buffer_load_dwordx4 v[12:15], v8, s[8:11], s51 offen sc1
    s_waitcnt vmcnt(0)
    v_xor_b32 v12, s28, v12
    v_xor_b32 v13, s28, v13
    v_xor_b32 v14, s28, v14
    v_xor_b32 v15, s28, v15
    v_or3_b32 v12, v12, v13, v14
    v_or_b32 v12, v12, v15
    v_cmp_eq_u32 vcc, 0, v12
    s_nop 3
    s_andn2_b64 vcc, s[52:53], vcc
    s_cbranch_scc0 poll_12_done
    s_sleep 2
    s_sub_u32 s50, s50, 1
    s_cmp_lg_u32 s50, 0
    s_cbranch_scc1 poll_12
poll_12_done:
P2_fl1ok:
    s_lshl_b32 s47, s44, 3
    s_add_u32 s47, s47, s3
    s_lshl_b32 s47, s47, 6
    v_add_u32 v8, s47, v1
    v_lshlrev_b32 v9, 7, v8
    v_mov_b32 v10, 1073741824
    v_cmp_gt_u32 vcc, 1440, v8
    s_nop 1
    v_cndmask_b32 v9, v10, v9, vcc
    buffer_load_dword v248, v9, s[8:11], s46 offen
    s_lshl_b32 s47, s29, 7
    s_add_u32 s47, s47, 16548864
    s_mov_b64 vcc, s[92:93]
    s_cbranch_vccz cy_13
    s_setprio 1
cy_13:
    v_exp_f32 v64, v64
    v_cvt_pk_bf16_f32 v140, v120, v121
    v_cvt_pk_bf16_f32 v141, v122, v123
    v_exp_f32 v65, v65
    v_cvt_pk_bf16_f32 v142, v124, v125
    v_cvt_pk_bf16_f32 v143, v126, v127
    v_mfma_f32_32x32x4bf16_1k v[96:127], v[148:149], v[24:25], 0
    ds_read_b64_tr_b16 v[148:149], v5 offset:4736
    v_exp_f32 v66, v66
    v_exp_f32 v67, v67
    v_exp_f32 v68, v68
    v_exp_f32 v69, v69
    v_exp_f32 v70, v70
    v_exp_f32 v71, v71
    v_exp_f32 v72, v72
    v_mfma_f32_32x32x16_bf16 v[48:63], v[156:159], v[140:143], v[48:63]
    ds_read_b128 v[156:159], v6 offset:608
    v_cvt_pk_bf16_f32 v128, v64, v65
    v_cvt_pk_bf16_f32 v129, v66, v67
    v_exp_f32 v73, v73
    v_cvt_pk_bf16_f32 v130, v68, v69
    v_cvt_pk_bf16_f32 v131, v70, v71
    v_exp_f32 v74, v74
    v_exp_f32 v75, v75
    s_waitcnt lgkmcnt(2)
    v_mfma_f32_32x32x16_bf16 v[32:47], v[152:155], v[128:131], v[32:47]
    v_exp_f32 v76, v76
    v_exp_f32 v77, v77
    v_exp_f32 v78, v78
    v_exp_f32 v79, v79
    v_mfma_f32_32x32x16_bf16 v[96:111], v[144:147], v[16:19], v[96:111]
    v_exp_f32 v80, v80
    v_cvt_pk_bf16_f32 v132, v72, v73
    v_cvt_pk_bf16_f32 v133, v74, v75
    v_exp_f32 v81, v81
    v_cvt_pk_bf16_f32 v134, v76, v77
    v_cvt_pk_bf16_f32 v135, v78, v79
    v_exp_f32 v82, v82
    v_exp_f32 v83, v83
    s_waitcnt lgkmcnt(0)
    v_mfma_f32_32x32x16_bf16 v[32:47], v[156:159], v[132:135], v[32:47]
    v_exp_f32 v84, v84
    v_exp_f32 v85, v85
    v_exp_f32 v86, v86
    v_exp_f32 v87, v87
    v_mfma_f32_32x32x16_bf16 v[112:127], v[144:147], v[20:23], v[112:127]
    ds_read_b64_tr_b16 v[144:145], v4 offset:4736
    ds_read_b64_tr_b16 v[146:147], v4 offset:4768
    v_exp_f32 v88, v88
    v_cvt_pk_bf16_f32 v136, v80, v81
    v_cvt_pk_bf16_f32 v137, v82, v83
    v_exp_f32 v89, v89
    v_cvt_pk_bf16_f32 v138, v84, v85
    v_cvt_pk_bf16_f32 v139, v86, v87
    v_exp_f32 v90, v90
    v_exp_f32 v91, v91
    v_exp_f32 v92, v92
    v_exp_f32 v93, v93
    v_exp_f32 v94, v94
    v_exp_f32 v95, v95
    v_mfma_f32_32x32x16_bf16 v[48:63], v[152:155], v[136:139], v[48:63]
    ds_read_b128 v[152:155], v6 offset:1216
    v_exp_f32 v96, v96
    v_cvt_pk_bf16_f32 v140, v88, v89
    v_cvt_pk_bf16_f32 v141, v90, v91
    v_exp_f32 v97, v97
    v_cvt_pk_bf16_f32 v142, v92, v93
    v_cvt_pk_bf16_f32 v143, v94, v95
    v_mfma_f32_32x32x4bf16_1k v[64:95], v[148:149], v[24:25], 0
    ds_read_b64_tr_b16 v[148:149], v7 offset:4736
    v_exp_f32 v98, v98
    v_exp_f32 v99, v99
    v_exp_f32 v100, v100
    v_exp_f32 v101, v101
    v_exp_f32 v102, v102
    v_exp_f32 v103, v103
    v_exp_f32 v104, v104
    v_mfma_f32_32x32x16_bf16 v[48:63], v[156:159], v[140:143], v[48:63]
    ds_read_b128 v[156:159], v6 offset:1824
    v_cvt_pk_bf16_f32 v128, v96, v97
    v_cvt_pk_bf16_f32 v129, v98, v99
    v_exp_f32 v105, v105
    v_cvt_pk_bf16_f32 v130, v100, v101
    v_cvt_pk_bf16_f32 v131, v102, v103
    v_exp_f32 v106, v106
    v_exp_f32 v107, v107
    s_waitcnt lgkmcnt(2)
    v_mfma_f32_32x32x16_bf16 v[32:47], v[152:155], v[128:131], v[32:47]
    v_exp_f32 v108, v108
    v_exp_f32 v109, v109
    v_exp_f32 v110, v110
    v_exp_f32 v111, v111
    v_mfma_f32_32x32x16_bf16 v[64:79], v[144:147], v[16:19], v[64:79]
    v_exp_f32 v112, v112
    v_cvt_pk_bf16_f32 v132, v104, v105
    v_cvt_pk_bf16_f32 v133, v106, v107
    v_exp_f32 v113, v113
    v_cvt_pk_bf16_f32 v134, v108, v109
    v_cvt_pk_bf16_f32 v135, v110, v111
    v_exp_f32 v114, v114
    v_exp_f32 v115, v115
    s_waitcnt lgkmcnt(0)
    v_mfma_f32_32x32x16_bf16 v[32:47], v[156:159], v[132:135], v[32:47]
    v_exp_f32 v116, v116
    v_exp_f32 v117, v117
    v_exp_f32 v118, v118
    v_exp_f32 v119, v119
    v_mfma_f32_32x32x16_bf16 v[80:95], v[144:147], v[20:23], v[80:95]
    ds_read_b64_tr_b16 v[144:145], v4 offset:5888
    ds_read_b64_tr_b16 v[146:147], v4 offset:5920
    v_exp_f32 v120, v120
    v_cvt_pk_bf16_f32 v136, v112, v113
    v_cvt_pk_bf16_f32 v137, v114, v115
    v_exp_f32 v121, v121
    v_cvt_pk_bf16_f32 v138, v116, v117
    v_cvt_pk_bf16_f32 v139, v118, v119
    v_exp_f32 v122, v122
    v_exp_f32 v123, v123
    v_exp_f32 v124, v124
    v_exp_f32 v125, v125
    v_exp_f32 v126, v126
    v_exp_f32 v127, v127
    v_mfma_f32_32x32x16_bf16 v[48:63], v[152:155], v[136:139], v[48:63]
    ds_read_b128 v[152:155], v6 offset:4736
    v_exp_f32 v64, v64
    v_cvt_pk_bf16_f32 v140, v120, v121
    v_cvt_pk_bf16_f32 v141, v122, v123
    v_exp_f32 v65, v65
    v_cvt_pk_bf16_f32 v142, v124, v125
    v_cvt_pk_bf16_f32 v143, v126, v127
    v_mfma_f32_32x32x4bf16_1k v[96:127], v[148:149], v[24:25], 0
    ds_read_b64_tr_b16 v[148:149], v5 offset:9472
    v_exp_f32 v66, v66
    v_exp_f32 v67, v67
    v_exp_f32 v68, v68
    v_exp_f32 v69, v69
    v_exp_f32 v70, v70
    v_exp_f32 v71, v71
    v_exp_f32 v72, v72
    v_mfma_f32_32x32x16_bf16 v[48:63], v[156:159], v[140:143], v[48:63]
    ds_read_b128 v[156:159], v6 offset:5344
    v_cvt_pk_bf16_f32 v128, v64, v65
    v_cvt_pk_bf16_f32 v129, v66, v67
    v_exp_f32 v73, v73
    v_cvt_pk_bf16_f32 v130, v68, v69
    v_cvt_pk_bf16_f32 v131, v70, v71
    v_exp_f32 v74, v74
    v_exp_f32 v75, v75
    s_waitcnt lgkmcnt(2)
    v_mfma_f32_32x32x16_bf16 v[32:47], v[152:155], v[128:131], v[32:47]
    v_exp_f32 v76, v76
    v_exp_f32 v77, v77
    v_exp_f32 v78, v78
    v_exp_f32 v79, v79
    v_mfma_f32_32x32x16_bf16 v[96:111], v[144:147], v[16:19], v[96:111]
    v_exp_f32 v80, v80
    v_cvt_pk_bf16_f32 v132, v72, v73
    v_cvt_pk_bf16_f32 v133, v74, v75
    v_exp_f32 v81, v81
    v_cvt_pk_bf16_f32 v134, v76, v77
    v_cvt_pk_bf16_f32 v135, v78, v79
    v_exp_f32 v82, v82
    v_exp_f32 v83, v83
    s_waitcnt lgkmcnt(0)
    v_mfma_f32_32x32x16_bf16 v[32:47], v[156:159], v[132:135], v[32:47]
    v_exp_f32 v84, v84
    v_exp_f32 v85, v85
    v_exp_f32 v86, v86
    v_exp_f32 v87, v87
    v_mfma_f32_32x32x16_bf16 v[112:127], v[144:147], v[20:23], v[112:127]
    ds_read_b64_tr_b16 v[144:145], v4 offset:9472
    ds_read_b64_tr_b16 v[146:147], v4 offset:9504
    v_exp_f32 v88, v88
    v_cvt_pk_bf16_f32 v136, v80, v81
    v_cvt_pk_bf16_f32 v137, v82, v83
    v_exp_f32 v89, v89
    v_cvt_pk_bf16_f32 v138, v84, v85
    v_cvt_pk_bf16_f32 v139, v86, v87
    v_exp_f32 v90, v90
    v_exp_f32 v91, v91
    v_exp_f32 v92, v92
    v_exp_f32 v93, v93
    v_exp_f32 v94, v94
    v_exp_f32 v95, v95
    v_mfma_f32_32x32x16_bf16 v[48:63], v[152:155], v[136:139], v[48:63]
    ds_read_b128 v[152:155], v6 offset:5952
    s_cbranch_vccz cy_14
    s_setprio 0
cy_14:
    v_exp_f32 v96, v96
    v_cvt_pk_bf16_f32 v140, v88, v89
    v_cvt_pk_bf16_f32 v141, v90, v91
    v_exp_f32 v97, v97
    v_cvt_pk_bf16_f32 v142, v92, v93
    v_cvt_pk_bf16_f32 v143, v94, v95
    v_mfma_f32_32x32x4bf16_1k v[64:95], v[148:149], v[24:25], 0
    ds_read_b64_tr_b16 v[148:149], v7 offset:9472
    v_exp_f32 v98, v98
    v_exp_f32 v99, v99
    v_exp_f32 v100, v100
    v_exp_f32 v101, v101
    v_exp_f32 v102, v102
    v_exp_f32 v103, v103
    v_exp_f32 v104, v104
    v_mfma_f32_32x32x16_bf16 v[48:63], v[156:159], v[140:143], v[48:63]
    ds_read_b128 v[156:159], v6 offset:6560
    v_cvt_pk_bf16_f32 v128, v96, v97
    v_cvt_pk_bf16_f32 v129, v98, v99
    v_exp_f32 v105, v105
    v_cvt_pk_bf16_f32 v130, v100, v101
    v_cvt_pk_bf16_f32 v131, v102, v103
    v_exp_f32 v106, v106
    v_exp_f32 v107, v107
    s_waitcnt lgkmcnt(2)
    v_mfma_f32_32x32x16_bf16 v[32:47], v[152:155], v[128:131], v[32:47]
    v_exp_f32 v108, v108
    v_exp_f32 v109, v109
    v_exp_f32 v110, v110
    v_exp_f32 v111, v111
    v_mfma_f32_32x32x16_bf16 v[64:79], v[144:147], v[16:19], v[64:79]
    v_exp_f32 v112, v112
    v_cvt_pk_bf16_f32 v132, v104, v105
    v_cvt_pk_bf16_f32 v133, v106, v107
    v_exp_f32 v113, v113
    v_cvt_pk_bf16_f32 v134, v108, v109
    v_cvt_pk_bf16_f32 v135, v110, v111
    v_exp_f32 v114, v114
    v_exp_f32 v115, v115
    s_waitcnt lgkmcnt(0)
    v_mfma_f32_32x32x16_bf16 v[32:47], v[156:159], v[132:135], v[32:47]
    v_exp_f32 v116, v116
    v_exp_f32 v117, v117
    v_exp_f32 v118, v118
    v_exp_f32 v119, v119
    v_mfma_f32_32x32x16_bf16 v[80:95], v[144:147], v[20:23], v[80:95]
    ds_read_b64_tr_b16 v[144:145], v4 offset:10624
    ds_read_b64_tr_b16 v[146:147], v4 offset:10656
    v_exp_f32 v120, v120
    v_cvt_pk_bf16_f32 v136, v112, v113
    v_cvt_pk_bf16_f32 v137, v114, v115
    v_exp_f32 v121, v121
    v_cvt_pk_bf16_f32 v138, v116, v117
    v_cvt_pk_bf16_f32 v139, v118, v119
    v_exp_f32 v122, v122
    v_exp_f32 v123, v123
    v_exp_f32 v124, v124
    v_exp_f32 v125, v125
    v_exp_f32 v126, v126
    v_exp_f32 v127, v127
    v_mfma_f32_32x32x16_bf16 v[48:63], v[152:155], v[136:139], v[48:63]
    ds_read_b128 v[152:155], v6 offset:9472
    v_add_u32 v4, 9472, v4
    v_add_u32 v5, 9472, v5
    v_add_u32 v7, 9472, v7
    v_add_u32 v6, 9472, v6
    s_mov_b64 vcc, s[92:93]
    s_cbranch_vccz cy_15
    s_setprio 1
cy_15:
    v_exp_f32 v64, v64
    v_cvt_pk_bf16_f32 v140, v120, v121
    v_cvt_pk_bf16_f32 v141, v122, v123
    v_exp_f32 v65, v65
    v_cvt_pk_bf16_f32 v142, v124, v125
    v_cvt_pk_bf16_f32 v143, v126, v127
    v_mfma_f32_32x32x4bf16_1k v[96:127], v[148:149], v[24:25], 0
    ds_read_b64_tr_b16 v[148:149], v5 offset:4736
    v_exp_f32 v66, v66
    v_exp_f32 v67, v67
    v_exp_f32 v68, v68
    v_exp_f32 v69, v69
    v_exp_f32 v70, v70
    v_exp_f32 v71, v71
    v_exp_f32 v72, v72
    v_mfma_f32_32x32x16_bf16 v[48:63], v[156:159], v[140:143], v[48:63]
    ds_read_b128 v[156:159], v6 offset:608
    v_cvt_pk_bf16_f32 v128, v64, v65
    v_cvt_pk_bf16_f32 v129, v66, v67
    v_exp_f32 v73, v73
    v_cvt_pk_bf16_f32 v130, v68, v69
    v_cvt_pk_bf16_f32 v131, v70, v71
    v_exp_f32 v74, v74
    v_exp_f32 v75, v75
    s_waitcnt lgkmcnt(2)
    v_mfma_f32_32x32x16_bf16 v[32:47], v[152:155], v[128:131], v[32:47]
    v_exp_f32 v76, v76
    v_exp_f32 v77, v77
    v_exp_f32 v78, v78
    v_exp_f32 v79, v79
    v_mfma_f32_32x32x16_bf16 v[96:111], v[144:147], v[16:19], v[96:111]
    v_exp_f32 v80, v80
    v_cvt_pk_bf16_f32 v132, v72, v73
    v_cvt_pk_bf16_f32 v133, v74, v75
    v_exp_f32 v81, v81
    v_cvt_pk_bf16_f32 v134, v76, v77
    v_cvt_pk_bf16_f32 v135, v78, v79
    v_exp_f32 v82, v82
    v_exp_f32 v83, v83
    s_waitcnt lgkmcnt(0)
    v_mfma_f32_32x32x16_bf16 v[32:47], v[156:159], v[132:135], v[32:47]
    v_exp_f32 v84, v84
    v_exp_f32 v85, v85
    v_exp_f32 v86, v86
    v_exp_f32 v87, v87
    v_mfma_f32_32x32x16_bf16 v[112:127], v[144:147], v[20:23], v[112:127]
    ds_read_b64_tr_b16 v[144:145], v4 offset:4736
    ds_read_b64_tr_b16 v[146:147], v4 offset:4768
    v_exp_f32 v88, v88
    v_cvt_pk_bf16_f32 v136, v80, v81
    v_cvt_pk_bf16_f32 v137, v82, v83
    v_exp_f32 v89, v89
    v_cvt_pk_bf16_f32 v138, v84, v85
    v_cvt_pk_bf16_f32 v139, v86, v87
    v_exp_f32 v90, v90
    v_exp_f32 v91, v91
    v_exp_f32 v92, v92
    v_exp_f32 v93, v93
    v_exp_f32 v94, v94
    v_exp_f32 v95, v95
    v_mfma_f32_32x32x16_bf16 v[48:63], v[152:155], v[136:139], v[48:63]
    ds_read_b128 v[152:155], v6 offset:1216
    v_exp_f32 v96, v96
    v_cvt_pk_bf16_f32 v140, v88, v89
    v_cvt_pk_bf16_f32 v141, v90, v91
    v_exp_f32 v97, v97
    v_cvt_pk_bf16_f32 v142, v92, v93
    v_cvt_pk_bf16_f32 v143, v94, v95
    v_mfma_f32_32x32x4bf16_1k v[64:95], v[148:149], v[24:25], 0
    ds_read_b64_tr_b16 v[148:149], v7 offset:4736
    v_exp_f32 v98, v98
    v_exp_f32 v99, v99
    v_exp_f32 v100, v100
    v_exp_f32 v101, v101
    v_exp_f32 v102, v102
    v_exp_f32 v103, v103
    v_exp_f32 v104, v104
    v_mfma_f32_32x32x16_bf16 v[48:63], v[156:159], v[140:143], v[48:63]
    ds_read_b128 v[156:159], v6 offset:1824
    v_cvt_pk_bf16_f32 v128, v96, v97
    v_cvt_pk_bf16_f32 v129, v98, v99
    v_exp_f32 v105, v105
    v_cvt_pk_bf16_f32 v130, v100, v101
    v_cvt_pk_bf16_f32 v131, v102, v103
    v_exp_f32 v106, v106
    v_exp_f32 v107, v107
    s_waitcnt lgkmcnt(2)
    v_mfma_f32_32x32x16_bf16 v[32:47], v[152:155], v[128:131], v[32:47]
    v_exp_f32 v108, v108
    v_exp_f32 v109, v109
    v_exp_f32 v110, v110
    v_exp_f32 v111, v111
    v_mfma_f32_32x32x16_bf16 v[64:79], v[144:147], v[16:19], v[64:79]
    v_exp_f32 v112, v112
    v_cvt_pk_bf16_f32 v132, v104, v105
    v_cvt_pk_bf16_f32 v133, v106, v107
    v_exp_f32 v113, v113
    v_cvt_pk_bf16_f32 v134, v108, v109
    v_cvt_pk_bf16_f32 v135, v110, v111
    v_exp_f32 v114, v114
    v_exp_f32 v115, v115
    s_waitcnt lgkmcnt(0)
    v_mfma_f32_32x32x16_bf16 v[32:47], v[156:159], v[132:135], v[32:47]
    v_exp_f32 v116, v116
    v_exp_f32 v117, v117
    v_exp_f32 v118, v118
    v_exp_f32 v119, v119
    v_mfma_f32_32x32x16_bf16 v[80:95], v[144:147], v[20:23], v[80:95]
    ds_read_b64_tr_b16 v[144:145], v4 offset:5888
    ds_read_b64_tr_b16 v[146:147], v4 offset:5920
    v_exp_f32 v120, v120
    v_cvt_pk_bf16_f32 v136, v112, v113
    v_cvt_pk_bf16_f32 v137, v114, v115
    v_exp_f32 v121, v121
    v_cvt_pk_bf16_f32 v138, v116, v117
    v_cvt_pk_bf16_f32 v139, v118, v119
    v_exp_f32 v122, v122
    v_exp_f32 v123, v123
    v_exp_f32 v124, v124
    v_exp_f32 v125, v125
    v_exp_f32 v126, v126
    v_exp_f32 v127, v127
    v_mfma_f32_32x32x16_bf16 v[48:63], v[152:155], v[136:139], v[48:63]
    ds_read_b128 v[152:155], v6 offset:4736
    v_exp_f32 v64, v64
    v_cvt_pk_bf16_f32 v140, v120, v121
    v_cvt_pk_bf16_f32 v141, v122, v123
    v_exp_f32 v65, v65
    v_cvt_pk_bf16_f32 v142, v124, v125
    v_cvt_pk_bf16_f32 v143, v126, v127
    v_mfma_f32_32x32x4bf16_1k v[96:127], v[148:149], v[24:25], 0
    ds_read_b64_tr_b16 v[148:149], v5 offset:9472
    v_exp_f32 v66, v66
    v_exp_f32 v67, v67
    v_exp_f32 v68, v68
    v_exp_f32 v69, v69
    v_exp_f32 v70, v70
    v_exp_f32 v71, v71
    v_exp_f32 v72, v72
    v_mfma_f32_32x32x16_bf16 v[48:63], v[156:159], v[140:143], v[48:63]
    ds_read_b128 v[156:159], v6 offset:5344
    v_cvt_pk_bf16_f32 v128, v64, v65
    v_cvt_pk_bf16_f32 v129, v66, v67
    v_exp_f32 v73, v73
    v_cvt_pk_bf16_f32 v130, v68, v69
    v_cvt_pk_bf16_f32 v131, v70, v71
    v_exp_f32 v74, v74
    v_exp_f32 v75, v75
    s_waitcnt lgkmcnt(2)
    v_mfma_f32_32x32x16_bf16 v[32:47], v[152:155], v[128:131], v[32:47]
    v_exp_f32 v76, v76
    v_lshlrev_b32 v8, 2, v1
    buffer_load_dword v252, v8, s[8:11], s47 offen sc1
    v_exp_f32 v77, v77
    v_exp_f32 v78, v78
    v_exp_f32 v79, v79
    v_mfma_f32_32x32x16_bf16 v[96:111], v[144:147], v[16:19], v[96:111]
    v_exp_f32 v80, v80
    v_cvt_pk_bf16_f32 v132, v72, v73
    v_cvt_pk_bf16_f32 v133, v74, v75
    v_exp_f32 v81, v81
    v_cvt_pk_bf16_f32 v134, v76, v77
    v_cvt_pk_bf16_f32 v135, v78, v79
    v_exp_f32 v82, v82
    v_exp_f32 v83, v83
    s_waitcnt lgkmcnt(0)
    v_mfma_f32_32x32x16_bf16 v[32:47], v[156:159], v[132:135], v[32:47]
    v_exp_f32 v84, v84
    v_exp_f32 v85, v85
    v_exp_f32 v86, v86
    v_exp_f32 v87, v87
    v_mfma_f32_32x32x16_bf16 v[112:127], v[144:147], v[20:23], v[112:127]
    ds_read_b64_tr_b16 v[144:145], v4 offset:9472
    ds_read_b64_tr_b16 v[146:147], v4 offset:9504
    v_exp_f32 v88, v88
    v_cvt_pk_bf16_f32 v136, v80, v81
    v_cvt_pk_bf16_f32 v137, v82, v83
    v_exp_f32 v89, v89
    v_cvt_pk_bf16_f32 v138, v84, v85
    v_cvt_pk_bf16_f32 v139, v86, v87
    v_exp_f32 v90, v90
    v_exp_f32 v91, v91
    v_exp_f32 v92, v92
    v_exp_f32 v93, v93
    v_exp_f32 v94, v94
    v_exp_f32 v95, v95
    v_mfma_f32_32x32x16_bf16 v[48:63], v[152:155], v[136:139], v[48:63]
    ds_read_b128 v[152:155], v6 offset:5952
    s_cbranch_vccz cy_16
    s_setprio 0
cy_16:
    v_exp_f32 v96, v96
    v_cvt_pk_bf16_f32 v140, v88, v89
    v_cvt_pk_bf16_f32 v141, v90, v91
    v_exp_f32 v97, v97
    v_cvt_pk_bf16_f32 v142, v92, v93
    v_cvt_pk_bf16_f32 v143, v94, v95
    v_mfma_f32_32x32x4bf16_1k v[64:95], v[148:149], v[24:25], 0
    ds_read_b64_tr_b16 v[148:149], v7 offset:9472
    v_exp_f32 v98, v98
    v_exp_f32 v99, v99
    v_exp_f32 v100, v100
    v_exp_f32 v101, v101
    v_exp_f32 v102, v102
    v_exp_f32 v103, v103
    v_exp_f32 v104, v104
    v_mfma_f32_32x32x16_bf16 v[48:63], v[156:159], v[140:143], v[48:63]
    ds_read_b128 v[156:159], v6 offset:6560
    v_cvt_pk_bf16_f32 v128, v96, v97
    v_cvt_pk_bf16_f32 v129, v98, v99
    v_exp_f32 v105, v105
    v_cvt_pk_bf16_f32 v130, v100, v101
    v_cvt_pk_bf16_f32 v131, v102, v103
    v_exp_f32 v106, v106
    v_exp_f32 v107, v107
    s_waitcnt lgkmcnt(2)
    v_mfma_f32_32x32x16_bf16 v[32:47], v[152:155], v[128:131], v[32:47]
    v_exp_f32 v108, v108
    v_exp_f32 v109, v109
    v_exp_f32 v110, v110
    v_exp_f32 v111, v111
    v_mfma_f32_32x32x16_bf16 v[64:79], v[144:147], v[16:19], v[64:79]
    v_exp_f32 v112, v112
    v_cvt_pk_bf16_f32 v132, v104, v105
    v_cvt_pk_bf16_f32 v133, v106, v107
    v_exp_f32 v113, v113
    v_cvt_pk_bf16_f32 v134, v108, v109
    v_cvt_pk_bf16_f32 v135, v110, v111
    v_exp_f32 v114, v114
    v_exp_f32 v115, v115
    s_waitcnt lgkmcnt(0)
    v_mfma_f32_32x32x16_bf16 v[32:47], v[156:159], v[132:135], v[32:47]
    v_exp_f32 v116, v116
    v_exp_f32 v117, v117
    v_mov_b32 v8, 3
    s_mov_b64 exec, 1
    ds_write_b32 v150, v8
    s_mov_b64 exec, -1
    v_exp_f32 v118, v118
    v_exp_f32 v119, v119
    v_mfma_f32_32x32x16_bf16 v[80:95], v[144:147], v[20:23], v[80:95]
    ds_read_b64_tr_b16 v[144:145], v4 offset:10624
    ds_read_b64_tr_b16 v[146:147], v4 offset:10656
    v_exp_f32 v120, v120
    v_cvt_pk_bf16_f32 v136, v112, v113
    v_cvt_pk_bf16_f32 v137, v114, v115
    v_exp_f32 v121, v121
    v_cvt_pk_bf16_f32 v138, v116, v117
    v_cvt_pk_bf16_f32 v139, v118, v119
    v_exp_f32 v122, v122
    v_exp_f32 v123, v123
    v_exp_f32 v124, v124
    v_exp_f32 v125, v125
    v_exp_f32 v126, v126
    v_exp_f32 v127, v127
    v_mfma_f32_32x32x16_bf16 v[48:63], v[152:155], v[136:139], v[48:63]
    ds_read_b128 v[152:155], v6 offset:9472
    v_add_u32 v4, 9472, v4
    v_add_u32 v5, 9472, v5
    v_add_u32 v7, 9472, v7
    v_add_u32 v6, 9472, v6
    s_waitcnt vmcnt(0)
    v_cmp_eq_u32 vcc, s28, v252
    s_nop 3
    s_cmp_eq_u32 vcc_lo, -1
    s_cbranch_scc1 P2_flaok
    v_and_b32 v8, 63, v0
    v_lshlrev_b32 v8, 2, v8
    s_mov_b32 s51, s47
    s_mov_b32 s50, 300000
    s_mov_b32 s52, 0xffffffff
    s_mov_b32 s53, 0x0
poll_17:
    buffer_load_dword v9, v8, s[8:11], s51 offen sc1
    s_waitcnt vmcnt(0)
    v_cmp_eq_u32 vcc, s28, v9
    s_nop 3
    s_andn2_b64 vcc, s[52:53], vcc
    s_cbranch_scc0 poll_17_done
    s_sleep 2
    s_sub_u32 s50, s50, 1
    s_cmp_lg_u32 s50, 0
    s_cbranch_scc1 poll_17
poll_17_done:
P2_flaok:
    s_mul_i32 s43, s33, 14336
    s_mul_i32 s47, s34, 56320
    s_add_u32 s39, s43, s47
    s_add_u32 s39, s39, s46
    s_mul_i32 s47, s34, 75776
    s_add_u32 s40, s43, s47
    s_mov_b64 vcc, s[92:93]
    s_cbranch_vccz cy_23
    s_setprio 1
cy_23:
    v_exp_f32 v64, v64
    v_cvt_pk_bf16_f32 v140, v120, v121
    v_cvt_pk_bf16_f32 v141, v122, v123
    v_exp_f32 v65, v65
    v_cvt_pk_bf16_f32 v142, v124, v125
    v_cvt_pk_bf16_f32 v143, v126, v127
    v_mfma_f32_32x32x4bf16_1k v[96:127], v[148:149], v[24:25], 0
    ds_read_b64_tr_b16 v[148:149], v5 offset:4736
    v_exp_f32 v66, v66
    v_exp_f32 v67, v67
    v_exp_f32 v68, v68
    v_exp_f32 v69, v69
    v_exp_f32 v70, v70
    v_exp_f32 v71, v71
    v_exp_f32 v72, v72
    v_mfma_f32_32x32x16_bf16 v[48:63], v[156:159], v[140:143], v[48:63]
    ds_read_b128 v[156:159], v6 offset:608
    v_cvt_pk_bf16_f32 v128, v64, v65
    v_cvt_pk_bf16_f32 v129, v66, v67
    v_exp_f32 v73, v73
    v_cvt_pk_bf16_f32 v130, v68, v69
    v_cvt_pk_bf16_f32 v131, v70, v71
    v_exp_f32 v74, v74
    v_exp_f32 v75, v75
    s_waitcnt lgkmcnt(2)
    v_mfma_f32_32x32x16_bf16 v[32:47], v[152:155], v[128:131], v[32:47]
    v_exp_f32 v76, v76
    v_exp_f32 v77, v77
    v_exp_f32 v78, v78
    v_exp_f32 v79, v79
    v_mfma_f32_32x32x16_bf16 v[96:111], v[144:147], v[16:19], v[96:111]
    v_exp_f32 v80, v80
    v_cvt_pk_bf16_f32 v132, v72, v73
    v_cvt_pk_bf16_f32 v133, v74, v75
    v_exp_f32 v81, v81
    v_cvt_pk_bf16_f32 v134, v76, v77
    v_cvt_pk_bf16_f32 v135, v78, v79
    v_exp_f32 v82, v82
    ds_read_b128 v[12:15], v151
    v_exp_f32 v83, v83
    s_waitcnt lgkmcnt(0)
    v_mfma_f32_32x32x16_bf16 v[32:47], v[156:159], v[132:135], v[32:47]
    v_exp_f32 v84, v84
    v_min3_u32 v12, v12, v13, v14
    v_min_u32 v12, v12, v15
    s_nop 0
    v_readfirstlane_b32 s50, v12
    s_cmp_ge_u32 s50, 3
    s_cbranch_scc0 chk_18_spin
chk_18_back:
    v_exp_f32 v85, v85
    v_exp_f32 v86, v86
    v_exp_f32 v87, v87
    v_mfma_f32_32x32x16_bf16 v[112:127], v[144:147], v[20:23], v[112:127]
    ds_read_b64_tr_b16 v[144:145], v4 offset:4736
    ds_read_b64_tr_b16 v[146:147], v4 offset:4768
    v_exp_f32 v88, v88
    v_cvt_pk_bf16_f32 v136, v80, v81
    v_cvt_pk_bf16_f32 v137, v82, v83
    v_exp_f32 v89, v89
    v_cvt_pk_bf16_f32 v138, v84, v85
    v_cvt_pk_bf16_f32 v139, v86, v87
    v_exp_f32 v90, v90
    v_exp_f32 v91, v91
    v_exp_f32 v92, v92
    s_cbranch_vccz cs_19_o
    s_mov_b32 s50, 11534336
    buffer_load_dwordx4 v[208:211], v246, s[8:11], s50 offen sc1
    s_mov_b32 s50, 11665408
    buffer_load_dwordx4 v[212:215], v246, s[8:11], s50 offen sc1
    s_mov_b32 s50, 11796480
    buffer_load_dwordx4 v[216:219], v246, s[8:11], s50 offen sc1
    s_mov_b32 s50, 11927552
    buffer_load_dwordx4 v[220:223], v246, s[8:11], s50 offen sc1
    s_branch cs_19_e
cs_19_o:
    s_mov_b32 s50, 10354688
    buffer_load_dwordx4 v[208:211], v246, s[8:11], s50 offen sc1
    s_mov_b32 s50, 10485760
    buffer_load_dwordx4 v[212:215], v246, s[8:11], s50 offen sc1
    s_mov_b32 s50, 10616832
    buffer_load_dwordx4 v[216:219], v246, s[8:11], s50 offen sc1
cs_19_e:
    v_exp_f32 v93, v93
    v_exp_f32 v94, v94
    v_exp_f32 v95, v95
    v_mfma_f32_32x32x16_bf16 v[48:63], v[152:155], v[136:139], v[48:63]
    ds_read_b128 v[152:155], v6 offset:1216
    v_exp_f32 v96, v96
    v_cvt_pk_bf16_f32 v140, v88, v89
    v_cvt_pk_bf16_f32 v141, v90, v91
    v_exp_f32 v97, v97
    v_cvt_pk_bf16_f32 v142, v92, v93
    v_cvt_pk_bf16_f32 v143, v94, v95
    v_mfma_f32_32x32x4bf16_1k v[64:95], v[148:149], v[24:25], 0
    ds_read_b64_tr_b16 v[148:149], v7 offset:4736
    v_exp_f32 v98, v98
    s_mov_b32 m0, s40
    s_nop 0
    buffer_load_dwordx4 v2, s[8:11], s39 offen offset:0 sc1 lds
    v_exp_f32 v99, v99
    v_exp_f32 v100, v100
    v_exp_f32 v101, v101
    v_exp_f32 v102, v102
    v_exp_f32 v103, v103
    v_exp_f32 v104, v104
    v_mfma_f32_32x32x16_bf16 v[48:63], v[156:159], v[140:143], v[48:63]
    ds_read_b128 v[156:159], v6 offset:1824
    v_cvt_pk_bf16_f32 v128, v96, v97
    v_cvt_pk_bf16_f32 v129, v98, v99
    v_exp_f32 v105, v105
    v_cvt_pk_bf16_f32 v130, v100, v101
    buffer_load_dwordx4 v2, s[8:11], s39 offen offset:1024 sc1 lds
    v_cvt_pk_bf16_f32 v131, v102, v103
    v_exp_f32 v106, v106
    v_exp_f32 v107, v107
    s_waitcnt lgkmcnt(2)
    v_mfma_f32_32x32x16_bf16 v[32:47], v[152:155], v[128:131], v[32:47]
    v_exp_f32 v108, v108
    v_exp_f32 v109, v109
    v_exp_f32 v110, v110
    v_exp_f32 v111, v111
    v_mfma_f32_32x32x16_bf16 v[64:79], v[144:147], v[16:19], v[64:79]
    v_exp_f32 v112, v112
    v_cvt_pk_bf16_f32 v132, v104, v105
    v_cvt_pk_bf16_f32 v133, v106, v107
    buffer_load_dwordx4 v2, s[8:11], s39 offen offset:2048 sc1 lds
    v_exp_f32 v113, v113
    v_cvt_pk_bf16_f32 v134, v108, v109
    v_cvt_pk_bf16_f32 v135, v110, v111
    v_exp_f32 v114, v114
    v_exp_f32 v115, v115
    s_waitcnt lgkmcnt(0)
    v_mfma_f32_32x32x16_bf16 v[32:47], v[156:159], v[132:135], v[32:47]
    v_exp_f32 v116, v116
    v_exp_f32 v117, v117
    v_exp_f32 v118, v118
    v_exp_f32 v119, v119
    v_mfma_f32_32x32x16_bf16 v[80:95], v[144:147], v[20:23], v[80:95]
    ds_read_b64_tr_b16 v[144:145], v4 offset:5888
    ds_read_b64_tr_b16 v[146:147], v4 offset:5920
    v_exp_f32 v120, v120
    v_cvt_pk_bf16_f32 v136, v112, v113
    v_cvt_pk_bf16_f32 v137, v114, v115
    v_exp_f32 v121, v121
    v_cvt_pk_bf16_f32 v138, v116, v117
    buffer_load_dwordx4 v2, s[8:11], s39 offen offset:3072 sc1 lds
    s_add_u32 s40, s40, 4096
    s_add_u32 s39, s39, 4096
    v_cvt_pk_bf16_f32 v139, v118, v119
    v_exp_f32 v122, v122
    v_exp_f32 v123, v123
    v_exp_f32 v124, v124
    s_cbranch_vccz cs_20_o
    s_mov_b32 s50, 12058624
    buffer_load_dwordx4 v[224:227], v246, s[8:11], s50 offen sc1
    s_mov_b32 s50, 12189696
    buffer_load_dwordx4 v[228:231], v246, s[8:11], s50 offen sc1
    s_mov_b32 s50, 12320768
    buffer_load_dwordx4 v[232:235], v246, s[8:11], s50 offen sc1
    s_mov_b32 s50, 14548992
    buffer_load_dword v236, v247, s[8:11], s50 offen sc1
    s_branch cs_20_e
cs_20_o:
    s_mov_b32 s50, 10747904
    buffer_load_dwordx4 v[220:223], v246, s[8:11], s50 offen sc1
    s_mov_b32 s50, 10878976
    buffer_load_dwordx4 v[224:227], v246, s[8:11], s50 offen sc1
    s_mov_b32 s50, 11010048
    buffer_load_dwordx4 v[228:231], v246, s[8:11], s50 offen sc1
cs_20_e:
    v_exp_f32 v125, v125
    v_exp_f32 v126, v126
    v_exp_f32 v127, v127
    v_mfma_f32_32x32x16_bf16 v[48:63], v[152:155], v[136:139], v[48:63]
    ds_read_b128 v[152:155], v6 offset:4736
    v_exp_f32 v64, v64
    v_cvt_pk_bf16_f32 v140, v120, v121
    v_cvt_pk_bf16_f32 v141, v122, v123
    v_exp_f32 v65, v65
    v_cvt_pk_bf16_f32 v142, v124, v125
    v_cvt_pk_bf16_f32 v143, v126, v127
    v_mfma_f32_32x32x4bf16_1k v[96:127], v[148:149], v[24:25], 0
    ds_read_b64_tr_b16 v[148:149], v5 offset:9472
    v_exp_f32 v66, v66
    s_mov_b32 m0, s40
    s_nop 0
    buffer_load_dwordx4 v2, s[8:11], s39 offen offset:0 sc1 lds
    v_exp_f32 v67, v67
    v_exp_f32 v68, v68
    v_exp_f32 v69, v69
    v_exp_f32 v70, v70
    v_exp_f32 v71, v71
    v_exp_f32 v72, v72
    v_mfma_f32_32x32x16_bf16 v[48:63], v[156:159], v[140:143], v[48:63]
    ds_read_b128 v[156:159], v6 offset:5344
    v_cvt_pk_bf16_f32 v128, v64, v65
    v_cvt_pk_bf16_f32 v129, v66, v67
    v_exp_f32 v73, v73
    v_cvt_pk_bf16_f32 v130, v68, v69
    buffer_load_dwordx4 v2, s[8:11], s39 offen offset:1024 sc1 lds
    v_cvt_pk_bf16_f32 v131, v70, v71
    v_exp_f32 v74, v74
    v_exp_f32 v75, v75
    s_waitcnt lgkmcnt(2)
    v_mfma_f32_32x32x16_bf16 v[32:47], v[152:155], v[128:131], v[32:47]
    v_exp_f32 v76, v76
    v_exp_f32 v77, v77
    v_exp_f32 v78, v78
    v_exp_f32 v79, v79
    v_mfma_f32_32x32x16_bf16 v[96:111], v[144:147], v[16:19], v[96:111]
    v_exp_f32 v80, v80
    v_cvt_pk_bf16_f32 v132, v72, v73
    v_cvt_pk_bf16_f32 v133, v74, v75
    buffer_load_dwordx4 v2, s[8:11], s39 offen offset:2048 sc1 lds
    v_exp_f32 v81, v81
    v_cvt_pk_bf16_f32 v134, v76, v77
    v_cvt_pk_bf16_f32 v135, v78, v79
    v_exp_f32 v82, v82
    v_exp_f32 v83, v83
    s_waitcnt lgkmcnt(0)
    v_mfma_f32_32x32x16_bf16 v[32:47], v[156:159], v[132:135], v[32:47]
    v_exp_f32 v84, v84
    v_exp_f32 v85, v85
    v_exp_f32 v86, v86
    v_exp_f32 v87, v87
    v_mfma_f32_32x32x16_bf16 v[112:127], v[144:147], v[20:23], v[112:127]
    ds_read_b64_tr_b16 v[144:145], v4 offset:9472
    ds_read_b64_tr_b16 v[146:147], v4 offset:9504
    v_exp_f32 v88, v88
    v_cvt_pk_bf16_f32 v136, v80, v81
    v_cvt_pk_bf16_f32 v137, v82, v83
    v_exp_f32 v89, v89
    v_cvt_pk_bf16_f32 v138, v84, v85
    buffer_load_dwordx4 v2, s[8:11], s39 offen offset:3072 sc1 lds
    s_add_u32 s40, s40, 4096
    s_add_u32 s39, s39, 4096
    v_cvt_pk_bf16_f32 v139, v86, v87
    v_exp_f32 v90, v90
    v_exp_f32 v91, v91
    v_exp_f32 v92, v92
    s_cbranch_vccz cs_21_o
    s_mov_b32 s50, 14557184
    buffer_load_dword v237, v247, s[8:11], s50 offen sc1
    s_mov_b32 s50, 14565376
    buffer_load_dword v238, v247, s[8:11], s50 offen sc1
    s_mov_b32 s50, 14573568
    buffer_load_dword v239, v247, s[8:11], s50 offen sc1
    s_mov_b32 s50, 14680064
    buffer_load_dword v240, v247, s[8:11], s50 offen sc1
    s_branch cs_21_e
cs_21_o:
    s_mov_b32 s50, 11141120
    buffer_load_dwordx4 v[232:235], v246, s[8:11], s50 offen sc1
    s_mov_b32 s50, 11272192
    buffer_load_dwordx4 v[236:239], v246, s[8:11], s50 offen sc1
    s_mov_b32 s50, 11403264
    buffer_load_dwordx4 v[240:243], v246, s[8:11], s50 offen sc1
cs_21_e:
    v_exp_f32 v93, v93
    v_exp_f32 v94, v94
    v_exp_f32 v95, v95
    v_mfma_f32_32x32x16_bf16 v[48:63], v[152:155], v[136:139], v[48:63]
    ds_read_b128 v[152:155], v6 offset:5952
    s_cbranch_vccz cy_24
    s_setprio 0
cy_24:
    v_exp_f32 v96, v96
    v_cvt_pk_bf16_f32 v140, v88, v89
    v_cvt_pk_bf16_f32 v141, v90, v91
    v_exp_f32 v97, v97
    v_cvt_pk_bf16_f32 v142, v92, v93
    v_cvt_pk_bf16_f32 v143, v94, v95
    v_mfma_f32_32x32x4bf16_1k v[64:95], v[148:149], v[24:25], 0
    ds_read_b64_tr_b16 v[148:149], v7 offset:9472
    v_exp_f32 v98, v98
    s_mov_b32 m0, s40
    s_nop 0
    buffer_load_dwordx4 v2, s[8:11], s39 offen offset:0 sc1 lds
    v_exp_f32 v99, v99
    v_exp_f32 v100, v100
    v_exp_f32 v101, v101
    v_exp_f32 v102, v102
    v_exp_f32 v103, v103
    v_exp_f32 v104, v104
    v_mfma_f32_32x32x16_bf16 v[48:63], v[156:159], v[140:143], v[48:63]
    ds_read_b128 v[156:159], v6 offset:6560
    v_cvt_pk_bf16_f32 v128, v96, v97
    v_cvt_pk_bf16_f32 v129, v98, v99
    v_exp_f32 v105, v105
    v_cvt_pk_bf16_f32 v130, v100, v101
    buffer_load_dwordx4 v2, s[8:11], s39 offen offset:1024 sc1 lds
    v_cvt_pk_bf16_f32 v131, v102, v103
    v_exp_f32 v106, v106
    v_exp_f32 v107, v107
    s_waitcnt lgkmcnt(2)
    v_mfma_f32_32x32x16_bf16 v[32:47], v[152:155], v[128:131], v[32:47]
    v_exp_f32 v108, v108
    v_exp_f32 v109, v109
    v_exp_f32 v110, v110
    v_exp_f32 v111, v111
    v_mfma_f32_32x32x16_bf16 v[64:79], v[144:147], v[16:19], v[64:79]
    v_exp_f32 v112, v112
    v_cvt_pk_bf16_f32 v132, v104, v105
    v_cvt_pk_bf16_f32 v133, v106, v107
    buffer_load_dwordx4 v2, s[8:11], s39 offen offset:2048 sc1 lds
    v_exp_f32 v113, v113
    v_cvt_pk_bf16_f32 v134, v108, v109
    v_cvt_pk_bf16_f32 v135, v110, v111
    v_exp_f32 v114, v114
    v_exp_f32 v115, v115
    s_waitcnt lgkmcnt(0)
    v_mfma_f32_32x32x16_bf16 v[32:47], v[156:159], v[132:135], v[32:47]
    v_exp_f32 v116, v116
    v_exp_f32 v117, v117
    v_exp_f32 v118, v118
    v_exp_f32 v119, v119
    v_mfma_f32_32x32x16_bf16 v[80:95], v[144:147], v[20:23], v[80:95]
    ds_read_b64_tr_b16 v[144:145], v4 offset:10624
    ds_read_b64_tr_b16 v[146:147], v4 offset:10656
    v_exp_f32 v120, v120
    v_cvt_pk_bf16_f32 v136, v112, v113
    v_cvt_pk_bf16_f32 v137, v114, v115
    v_exp_f32 v121, v121
    v_cvt_pk_bf16_f32 v138, v116, v117
    buffer_load_dwordx4 v2, s[8:11], s39 offen offset:3072 sc1 lds
    s_add_u32 s40, s40, 4096
    s_add_u32 s39, s39, 4096
    v_cvt_pk_bf16_f32 v139, v118, v119
    v_exp_f32 v122, v122
    v_exp_f32 v123, v123
    v_exp_f32 v124, v124
    s_cbranch_vccz cs_22_o
    s_mov_b32 s50, 14688256
    buffer_load_dword v241, v247, s[8:11], s50 offen sc1
    s_mov_b32 s50, 14696448
    buffer_load_dword v242, v247, s[8:11], s50 offen sc1
    s_mov_b32 s50, 14704640
    buffer_load_dword v243, v247, s[8:11], s50 offen sc1
    s_branch cs_22_e
cs_22_o:
cs_22_e:
    v_exp_f32 v125, v125
    v_exp_f32 v126, v126
    v_exp_f32 v127, v127
    v_mfma_f32_32x32x16_bf16 v[48:63], v[152:155], v[136:139], v[48:63]
    ds_read_b128 v[152:155], v6 offset:9472
    v_add_u32 v4, 9472, v4
    v_add_u32 v5, 9472, v5
    v_add_u32 v7, 9472, v7
    v_add_u32 v6, 9472, v6
    s_mov_b64 vcc, s[92:93]
    s_cbranch_vccz cy_25
    s_setprio 1
cy_25:
    v_exp_f32 v64, v64
    v_cvt_pk_bf16_f32 v140, v120, v121
    v_cvt_pk_bf16_f32 v141, v122, v123
    v_exp_f32 v65, v65
    v_cvt_pk_bf16_f32 v142, v124, v125
    v_cvt_pk_bf16_f32 v143, v126, v127
    v_mfma_f32_32x32x4bf16_1k v[96:127], v[148:149], v[24:25], 0
    ds_read_b64_tr_b16 v[148:149], v5 offset:4736
    v_exp_f32 v66, v66
    v_exp_f32 v67, v67
    v_exp_f32 v68, v68
    v_exp_f32 v69, v69
    v_exp_f32 v70, v70
    s_mov_b32 m0, s40
    s_nop 0
    buffer_load_dwordx4 v2, s[8:11], s39 offen offset:0 sc1 lds
    v_exp_f32 v71, v71
    v_exp_f32 v72, v72
    v_mfma_f32_32x32x16_bf16 v[48:63], v[156:159], v[140:143], v[48:63]
    ds_read_b128 v[156:159], v6 offset:608
    v_cvt_pk_bf16_f32 v128, v64, v65
    v_cvt_pk_bf16_f32 v129, v66, v67
    v_exp_f32 v73, v73
    v_cvt_pk_bf16_f32 v130, v68, v69
    v_cvt_pk_bf16_f32 v131, v70, v71
    v_exp_f32 v74, v74
    v_exp_f32 v75, v75
    s_waitcnt lgkmcnt(2)
    v_mfma_f32_32x32x16_bf16 v[32:47], v[152:155], v[128:131], v[32:47]
    v_exp_f32 v76, v76
    v_exp_f32 v77, v77
    v_exp_f32 v78, v78
    v_exp_f32 v79, v79
    v_mfma_f32_32x32x16_bf16 v[96:111], v[144:147], v[16:19], v[96:111]
    v_exp_f32 v80, v80
    v_cvt_pk_bf16_f32 v132, v72, v73
    v_cvt_pk_bf16_f32 v133, v74, v75
    v_exp_f32 v81, v81
    v_cvt_pk_bf16_f32 v134, v76, v77
    v_cvt_pk_bf16_f32 v135, v78, v79
    v_exp_f32 v82, v82
    v_exp_f32 v83, v83
    s_waitcnt lgkmcnt(0)
    v_mfma_f32_32x32x16_bf16 v[32:47], v[156:159], v[132:135], v[32:47]
    v_exp_f32 v84, v84
    v_exp_f32 v85, v85
    v_exp_f32 v86, v86
    s_cmp_lt_u32 s33, 3
    s_cselect_b32 s50, s39, 1073741824
    s_cselect_b32 s51, s40, 161792
    s_mov_b32 m0, s51
    s_nop 0
    buffer_load_dwordx4 v2, s[8:11], s50 offen offset:1024 sc1 lds
    v_exp_f32 v87, v87
    v_mfma_f32_32x32x16_bf16 v[112:127], v[144:147], v[20:23], v[112:127]
    ds_read_b64_tr_b16 v[144:145], v4 offset:4736
    ds_read_b64_tr_b16 v[146:147], v4 offset:4768
    v_exp_f32 v88, v88
    v_cvt_pk_bf16_f32 v136, v80, v81
    v_cvt_pk_bf16_f32 v137, v82, v83
    v_exp_f32 v89, v89
    v_cvt_pk_bf16_f32 v138, v84, v85
    v_cvt_pk_bf16_f32 v139, v86, v87
    v_exp_f32 v90, v90
    v_exp_f32 v91, v91
    v_exp_f32 v92, v92
    v_exp_f32 v93, v93
    v_exp_f32 v94, v94
    v_exp_f32 v95, v95
    v_mfma_f32_32x32x16_bf16 v[48:63], v[152:155], v[136:139], v[48:63]
    ds_read_b128 v[152:155], v6 offset:1216
    v_exp_f32 v96, v96
    v_cvt_pk_bf16_f32 v140, v88, v89
    v_cvt_pk_bf16_f32 v141, v90, v91
    v_exp_f32 v97, v97
    v_cvt_pk_bf16_f32 v142, v92, v93
    v_cvt_pk_bf16_f32 v143, v94, v95
    v_mfma_f32_32x32x4bf16_1k v[64:95], v[148:149], v[24:25], 0
    ds_read_b64_tr_b16 v[148:149], v7 offset:4736
    v_exp_f32 v98, v98
    v_exp_f32 v99, v99
    v_exp_f32 v100, v100
    v_exp_f32 v101, v101
    v_exp_f32 v102, v102
    v_exp_f32 v103, v103
    v_exp_f32 v104, v104
    v_mfma_f32_32x32x16_bf16 v[48:63], v[156:159], v[140:143], v[48:63]
    ds_read_b128 v[156:159], v6 offset:1824
    v_cvt_pk_bf16_f32 v128, v96, v97
    v_cvt_pk_bf16_f32 v129, v98, v99
    v_exp_f32 v105, v105
    v_cvt_pk_bf16_f32 v130, v100, v101
    v_cvt_pk_bf16_f32 v131, v102, v103
    v_exp_f32 v106, v106
    v_exp_f32 v107, v107
    s_waitcnt lgkmcnt(2)
    v_mfma_f32_32x32x16_bf16 v[32:47], v[152:155], v[128:131], v[32:47]
    v_exp_f32 v108, v108
    v_lshlrev_b32 v8, 2, v244
    s_mov_b32 s50, 10346496
    buffer_load_dword v245, v8, s[8:11], s50 offen sc1
    v_exp_f32 v109, v109
    v_exp_f32 v110, v110
    v_exp_f32 v111, v111
    v_mfma_f32_32x32x16_bf16 v[64:79], v[144:147], v[16:19], v[64:79]
    v_exp_f32 v112, v112
    v_cvt_pk_bf16_f32 v132, v104, v105
    v_cvt_pk_bf16_f32 v133, v106, v107
    v_exp_f32 v113, v113
    v_cvt_pk_bf16_f32 v134, v108, v109
    v_cvt_pk_bf16_f32 v135, v110, v111
    v_exp_f32 v114, v114
    v_exp_f32 v115, v115
    s_waitcnt lgkmcnt(0)
    v_mfma_f32_32x32x16_bf16 v[32:47], v[156:159], v[132:135], v[32:47]
    v_exp_f32 v116, v116
    v_exp_f32 v117, v117
    v_exp_f32 v118, v118
    v_exp_f32 v119, v119
    v_mfma_f32_32x32x16_bf16 v[80:95], v[144:147], v[20:23], v[80:95]
    ds_read_b64_tr_b16 v[144:145], v4 offset:5888
    ds_read_b64_tr_b16 v[146:147], v4 offset:5920
    v_exp_f32 v120, v120
    v_cvt_pk_bf16_f32 v136, v112, v113
    v_cvt_pk_bf16_f32 v137, v114, v115
    v_exp_f32 v121, v121
    v_cvt_pk_bf16_f32 v138, v116, v117
    v_cvt_pk_bf16_f32 v139, v118, v119
    v_exp_f32 v122, v122
    v_exp_f32 v123, v123
    v_exp_f32 v124, v124
    v_exp_f32 v125, v125
    v_exp_f32 v126, v126
    v_exp_f32 v127, v127
    v_mfma_f32_32x32x16_bf16 v[48:63], v[152:155], v[136:139], v[48:63]
    ds_read_b128 v[152:155], v6 offset:4736
    v_exp_f32 v64, v64
    v_cvt_pk_bf16_f32 v140, v120, v121
    v_cvt_pk_bf16_f32 v141, v122, v123
    v_exp_f32 v65, v65
    v_cvt_pk_bf16_f32 v142, v124, v125
    v_cvt_pk_bf16_f32 v143, v126, v127
    v_mfma_f32_32x32x4bf16_1k v[96:127], v[148:149], v[24:25], 0
    ds_read_b64_tr_b16 v[148:149], v5 offset:9472
    v_exp_f32 v66, v66
    v_exp_f32 v67, v67
    v_exp_f32 v68, v68
    v_exp_f32 v69, v69
    v_exp_f32 v70, v70
    v_exp_f32 v71, v71
    v_exp_f32 v72, v72
    v_mfma_f32_32x32x16_bf16 v[48:63], v[156:159], v[140:143], v[48:63]
    ds_read_b128 v[156:159], v6 offset:5344
    v_cvt_pk_bf16_f32 v128, v64, v65
    v_cvt_pk_bf16_f32 v129, v66, v67
    v_exp_f32 v73, v73
    v_cvt_pk_bf16_f32 v130, v68, v69
    v_cvt_pk_bf16_f32 v131, v70, v71
    v_exp_f32 v74, v74
    v_exp_f32 v75, v75
    s_waitcnt lgkmcnt(2)
    v_mfma_f32_32x32x16_bf16 v[32:47], v[152:155], v[128:131], v[32:47]
    v_exp_f32 v76, v76
    v_exp_f32 v77, v77
    v_exp_f32 v78, v78
    v_exp_f32 v79, v79
    v_mfma_f32_32x32x16_bf16 v[96:111], v[144:147], v[16:19], v[96:111]
    v_exp_f32 v80, v80
    v_cvt_pk_bf16_f32 v132, v72, v73
    v_cvt_pk_bf16_f32 v133, v74, v75
    v_exp_f32 v81, v81
    v_cvt_pk_bf16_f32 v134, v76, v77
    v_cvt_pk_bf16_f32 v135, v78, v79
    v_exp_f32 v82, v82
    v_exp_f32 v83, v83
    s_waitcnt lgkmcnt(0)
    v_mfma_f32_32x32x16_bf16 v[32:47], v[156:159], v[132:135], v[32:47]
    v_exp_f32 v84, v84
    v_exp_f32 v85, v85
    v_exp_f32 v86, v86
    v_exp_f32 v87, v87
    v_mfma_f32_32x32x16_bf16 v[112:127], v[144:147], v[20:23], v[112:127]
    ds_read_b64_tr_b16 v[144:145], v4 offset:9472
    ds_read_b64_tr_b16 v[146:147], v4 offset:9504
    v_exp_f32 v88, v88
    v_cvt_pk_bf16_f32 v136, v80, v81
    v_cvt_pk_bf16_f32 v137, v82, v83
    v_exp_f32 v89, v89
    v_cvt_pk_bf16_f32 v138, v84, v85
    v_cvt_pk_bf16_f32 v139, v86, v87
    v_exp_f32 v90, v90
    v_exp_f32 v91, v91
    v_exp_f32 v92, v92
    v_exp_f32 v93, v93
    v_exp_f32 v94, v94
    v_exp_f32 v95, v95
    v_mfma_f32_32x32x16_bf16 v[48:63], v[152:155], v[136:139], v[48:63]
    ds_read_b128 v[152:155], v6 offset:5952
    s_cbranch_vccz cy_26
    s_setprio 0
cy_26:
    v_exp_f32 v96, v96
    v_cvt_pk_bf16_f32 v140, v88, v89
    v_cvt_pk_bf16_f32 v141, v90, v91
    v_exp_f32 v97, v97
    v_cvt_pk_bf16_f32 v142, v92, v93
    v_cvt_pk_bf16_f32 v143, v94, v95
    v_mfma_f32_32x32x4bf16_1k v[64:95], v[148:149], v[24:25], 0
    ds_read_b64_tr_b16 v[148:149], v7 offset:9472
    v_exp_f32 v98, v98
    v_exp_f32 v99, v99
    v_exp_f32 v100, v100
    v_exp_f32 v101, v101
    v_exp_f32 v102, v102
    v_exp_f32 v103, v103
    v_exp_f32 v104, v104
    v_mfma_f32_32x32x16_bf16 v[48:63], v[156:159], v[140:143], v[48:63]
    ds_read_b128 v[156:159], v6 offset:6560
    v_cvt_pk_bf16_f32 v128, v96, v97
    v_cvt_pk_bf16_f32 v129, v98, v99
    v_exp_f32 v105, v105
    v_cvt_pk_bf16_f32 v130, v100, v101
    v_cvt_pk_bf16_f32 v131, v102, v103
    v_exp_f32 v106, v106
    v_exp_f32 v107, v107
    s_waitcnt lgkmcnt(2)
    v_mfma_f32_32x32x16_bf16 v[32:47], v[152:155], v[128:131], v[32:47]
    v_exp_f32 v108, v108
    v_exp_f32 v109, v109
    v_exp_f32 v110, v110
    v_exp_f32 v111, v111
    v_mfma_f32_32x32x16_bf16 v[64:79], v[144:147], v[16:19], v[64:79]
    v_exp_f32 v112, v112
    v_cvt_pk_bf16_f32 v132, v104, v105
    v_cvt_pk_bf16_f32 v133, v106, v107
    v_exp_f32 v113, v113
    v_cvt_pk_bf16_f32 v134, v108, v109
    v_cvt_pk_bf16_f32 v135, v110, v111
    v_exp_f32 v114, v114
    v_exp_f32 v115, v115
    s_waitcnt lgkmcnt(0)
    v_mfma_f32_32x32x16_bf16 v[32:47], v[156:159], v[132:135], v[32:47]
    v_exp_f32 v116, v116
    v_exp_f32 v117, v117
    v_exp_f32 v118, v118
    v_exp_f32 v119, v119
    v_mfma_f32_32x32x16_bf16 v[80:95], v[144:147], v[20:23], v[80:95]
    ds_read_b64_tr_b16 v[144:145], v4 offset:10624
    ds_read_b64_tr_b16 v[146:147], v4 offset:10656
    v_exp_f32 v120, v120
    v_cvt_pk_bf16_f32 v136, v112, v113
    v_cvt_pk_bf16_f32 v137, v114, v115
    v_exp_f32 v121, v121
    v_cvt_pk_bf16_f32 v138, v116, v117
    v_cvt_pk_bf16_f32 v139, v118, v119
    v_exp_f32 v122, v122
    v_exp_f32 v123, v123
    v_exp_f32 v124, v124
    v_exp_f32 v125, v125
    v_exp_f32 v126, v126
    v_exp_f32 v127, v127
    v_mfma_f32_32x32x16_bf16 v[48:63], v[152:155], v[136:139], v[48:63]
    ds_read_b128 v[152:155], v6 offset:9472
    v_add_u32 v4, 9472, v4
    v_add_u32 v5, 9472, v5
    v_add_u32 v7, 9472, v7
    v_add_u32 v6, 9472, v6
    s_setprio 0
    v_cvt_pk_bf16_f32 v140, v120, v121
    v_cvt_pk_bf16_f32 v141, v122, v123
    v_cvt_pk_bf16_f32 v142, v124, v125
    v_cvt_pk_bf16_f32 v143, v126, v127
    s_nop 1
    v_mfma_f32_32x32x16_bf16 v[48:63], v[156:159], v[140:143], v[48:63]
    s_waitcnt lgkmcnt(0)
    s_nop 15
    v_mov_b32 v12, 0x6c800000
    v_mov_b32 v13, 0x12800000
    v_cmp_gt_u32 vcc, 32, v1
    v_max3_f32 v9, |v32|, |v33|, |v34|
    v_max3_f32 v9, v9, |v35|, |v36|
    v_cndmask_b32 v43, v44, v42, vcc
    v_max3_f32 v9, v9, |v37|, |v38|
    v_max3_f32 v10, |v40|, |v41|, 0
    v_max3_f32 v9, v9, |v39|, |v43|
    v_cndmask_b32 v10, 0, v10, vcc
    v_max_f32 v9, v9, v10
    v_cmp_lt_f32 vcc, v9, v12
    v_cmp_lt_f32 s[48:49], v13, v43
    s_nop 1
    s_and_b64 s[48:49], s[48:49], vcc
    v_cmp_gt_u32 vcc, 32, v1
    v_max3_f32 v9, |v48|, |v49|, |v50|
    v_max3_f32 v9, v9, |v51|, |v52|
    v_cndmask_b32 v59, v60, v58, vcc
    v_max3_f32 v9, v9, |v53|, |v54|
    v_max3_f32 v10, |v56|, |v57|, 0
    v_max3_f32 v9, v9, |v55|, |v59|
    v_cndmask_b32 v10, 0, v10, vcc
    v_max_f32 v9, v9, v10
    v_cmp_lt_f32 vcc, v9, v12
    v_cmp_lt_f32 s[52:53], v13, v59
    s_nop 1
    s_and_b64 s[52:53], s[52:53], vcc
    s_and_b64 s[48:49], s[48:49], s[52:53]
    s_cmp_eq_u64 s[48:49], -1
    s_cselect_b32 s50, 0, 1
    v_mov_b32 v9, s50
    s_lshl_b32 s51, s3, 2
    s_add_u32 s51, s51, 152704
    v_mov_b32 v10, s51
    s_mul_i32 s50, s34, 75776
    s_mul_i32 s51, s33, 3072
    s_add_u32 s50, s50, s51
    s_add_u32 s50, s50, 56832
    v_add_u32 v11, s50, v2
    s_barrier
    ds_write_b32 v10, v9
    v_mov_b32 v12, 73216
    v_mov_b32 v13, 0
    ds_write_b32 v12, v13
    s_cmp_eq_u32 s34, 0
    s_cbranch_scc0 P2_x1
    ds_write_b128 v11, v[48:51] offset:0
    ds_write_b128 v11, v[52:55] offset:1024
    ds_write_b128 v11, v[56:59] offset:2048
    s_branch P2_x2
P2_x1:
    ds_write_b128 v11, v[32:35] offset:0
    ds_write_b128 v11, v[36:39] offset:1024
    ds_write_b128 v11, v[40:43] offset:2048
    s_waitcnt lgkmcnt(0)
    v_mov_b32 v32, v48
    v_mov_b32 v33, v49
    v_mov_b32 v34, v50
    v_mov_b32 v35, v51
    v_mov_b32 v36, v52
    v_mov_b32 v37, v53
    v_mov_b32 v38, v54
    v_mov_b32 v39, v55
    v_mov_b32 v40, v56
    v_mov_b32 v41, v57
    v_mov_b32 v42, v58
    v_mov_b32 v43, v59
P2_x2:
    s_waitcnt lgkmcnt(0)
    s_barrier
    s_xor_b32 s50, s34, 1
    s_mul_i32 s50, s50, 75776
    s_add_u32 s50, s50, s51
    s_add_u32 s50, s50, 56832
    v_add_u32 v10, s50, v2
    v_mov_b32 v11, 152704
    ds_read_b128 v[64:67], v10
    ds_read_b128 v[68:71], v10 offset:1024
    ds_read_b128 v[72:75], v10 offset:2048
    ds_read_b128 v[80:83], v11
    ds_read_b128 v[84:87], v11 offset:16
    s_lshl_b32 s50, s32, 8
    s_lshl_b32 s51, s33, 6
    s_add_u32 s50, s50, s51
    s_lshl_b32 s51, s34, 5
    s_add_u32 s47, s50, s51
    v_and_b32 v12, 31, v1
    v_add_u32 v12, s47, v12
    v_lshrrev_b32 v13, 5, v1
    v_lshlrev_b32 v13, 4, v13
    v_lshl_add_u32 v10, v12, 5, v13
    v_lshlrev_b32 v12, 2, v12
    v_mov_b32 v13, 1073741824
    v_cmp_gt_u32 vcc, 32, v1
    s_nop 1
    v_cndmask_b32 v11, v13, v12, vcc
    s_waitcnt lgkmcnt(0)
    v_or3_b32 v80, v80, v81, v82
    v_or3_b32 v80, v80, v83, v84
    v_or3_b32 v80, v80, v85, v86
    v_or_b32 v80, v80, v87
    s_nop 0
    v_readfirstlane_b32 s50, v80
    s_cmp_lg_u32 s50, 0
    s_cbranch_scc1 P2_fallback
    v_add_f32 v32, v32, v64
    v_add_f32 v33, v33, v65
    v_add_f32 v34, v34, v66
    v_add_f32 v35, v35, v67
    v_add_f32 v36, v36, v68
    v_add_f32 v37, v37, v69
    v_add_f32 v38, v38, v70
    v_add_f32 v39, v39, v71
    v_add_f32 v40, v40, v72
    v_add_f32 v41, v41, v73
    v_add_f32 v42, v42, v74
    v_add_f32 v43, v43, v75
    v_mov_b32 v8, v43
P2_fin:
    v_rcp_f32 v8, v8
    s_nop 0
    v_mul_f32 v32, v32, v8
    v_mul_f32 v33, v33, v8
    v_mul_f32 v34, v34, v8
    v_mul_f32 v35, v35, v8
    v_mul_f32 v36, v36, v8
    v_mul_f32 v37, v37, v8
    v_mul_f32 v38, v38, v8
    v_mul_f32 v39, v39, v8
    v_mul_f32 v40, v40, v8
    v_mul_f32 v41, v41, v8
    v_cvt_pk_bf16_f32 v12, v32, v33
    v_cvt_pk_bf16_f32 v13, v34, v35
    v_cvt_pk_bf16_f32 v14, v36, v37
    v_cvt_pk_bf16_f32 v15, v38, v39
    v_cvt_pk_bf16_f32 v9, v40, v41
    s_mul_i32 s51, s31, 65536
    s_add_u32 s51, s51, 12451840
    buffer_store_dwordx4 v[12:15], v10, s[8:11], s51 offen sc1
    s_mul_i32 s51, s31, 8192
    s_add_u32 s51, s51, 14811136
    buffer_store_dword v9, v11, s[8:11], s51 offen sc1
    s_branch P2_end
P2_fallback:
    s_waitcnt vmcnt(0)
    s_barrier
    s_add_u32 s50, s35, s38
    s_mov_b32 s51, s38
    s_mov_b32 s52, 19
P2_fbdma:
    s_cmp_ge_u32 s51, 151552
    s_cselect_b32 s53, 1073741824, s50
    s_cselect_b32 s54, 162816, s51
    s_mov_b32 m0, s54
    s_nop 0
    buffer_load_dwordx4 v2, s[8:11], s53 offen sc1 lds
    s_add_u32 s50, s50, 8192
    s_add_u32 s51, s51, 8192
    s_sub_u32 s52, s52, 1
    s_cmp_lg_u32 s52, 0
    s_cbranch_scc1 P2_fbdma
    s_cmp_eq_u32 s34, 0
    s_cbranch_scc1 P2_fb0
    v_mov_b32 v16, v20
    v_mov_b32 v17, v21
    v_mov_b32 v18, v22
    v_mov_b32 v19, v23
P2_fb0:
    v_mov_b32 v9, 0
    s_nop 1
    v_permlane32_swap_b32 v24, v9
    s_cmp_eq_u32 s34, 0
    s_cbranch_scc1 P2_fb1
    v_mov_b32 v24, v9
P2_fb1:
    v_mov_b32 v25, 0
    s_mul_i32 s50, s34, 75776
    s_add_u32 s50, s50, 75776
    v_subrev_u32 v4, s50, v4
    v_subrev_u32 v5, s50, v5
    v_subrev_u32 v7, s50, v7
    v_subrev_u32 v6, s50, v6
    s_waitcnt vmcnt(0)
    s_barrier
    s_mov_b32 s48, 0
    v_mov_b32 v14, 0xff7fffff
P2_fbpass:
    v_mov_b32 v32, 0
    v_mov_b32 v33, 0
    v_mov_b32 v34, 0
    v_mov_b32 v35, 0
    v_mov_b32 v36, 0
    v_mov_b32 v37, 0
    v_mov_b32 v38, 0
    v_mov_b32 v39, 0
    v_mov_b32 v40, 0
    v_mov_b32 v41, 0
    v_mov_b32 v42, 0
    v_mov_b32 v43, 0
    v_mov_b32 v44, 0
    v_mov_b32 v45, 0
    v_mov_b32 v46, 0
    v_mov_b32 v47, 0
    s_mov_b32 s43, 0
P2_fbloop:
    ds_read_b64_tr_b16 v[144:145], v4 offset:0
    ds_read_b64_tr_b16 v[146:147], v4 offset:32
    ds_read_b64_tr_b16 v[148:149], v5 offset:0
    ds_read_b128 v[152:155], v6 offset:0
    ds_read_b128 v[156:159], v6 offset:608
    s_waitcnt lgkmcnt(0)
    v_mfma_f32_32x32x8bf16_1k v[64:79], v[148:149], v[24:25], 0
    v_mfma_f32_32x32x16_bf16 v[64:79], v[144:147], v[16:19], v[64:79]
    s_nop 15
    s_cmp_eq_u32 s48, 0
    s_cbranch_scc0 P2_fbm0
    v_max3_f32 v14, v14, v64, v65
    v_max3_f32 v14, v14, v66, v67
    v_max3_f32 v14, v14, v68, v69
    v_max3_f32 v14, v14, v70, v71
    v_max3_f32 v14, v14, v72, v73
    v_max3_f32 v14, v14, v74, v75
    v_max3_f32 v14, v14, v76, v77
    v_max3_f32 v14, v14, v78, v79
    s_branch P2_fbn0
P2_fbm0:
    v_exp_f32 v64, v64
    v_exp_f32 v65, v65
    v_exp_f32 v66, v66
    v_exp_f32 v67, v67
    v_exp_f32 v68, v68
    v_exp_f32 v69, v69
    v_exp_f32 v70, v70
    v_exp_f32 v71, v71
    v_exp_f32 v72, v72
    v_exp_f32 v73, v73
    v_exp_f32 v74, v74
    v_exp_f32 v75, v75
    v_exp_f32 v76, v76
    v_exp_f32 v77, v77
    v_exp_f32 v78, v78
    v_exp_f32 v79, v79
    s_nop 0
    v_cvt_pk_bf16_f32 v128, v64, v65
    v_cvt_pk_bf16_f32 v129, v66, v67
    v_cvt_pk_bf16_f32 v130, v68, v69
    v_cvt_pk_bf16_f32 v131, v70, v71
    v_cvt_pk_bf16_f32 v132, v72, v73
    v_cvt_pk_bf16_f32 v133, v74, v75
    v_cvt_pk_bf16_f32 v134, v76, v77
    v_cvt_pk_bf16_f32 v135, v78, v79
    s_nop 1
    v_mfma_f32_32x32x16_bf16 v[32:47], v[152:155], v[128:131], v[32:47]
    v_mfma_f32_32x32x16_bf16 v[32:47], v[156:159], v[132:135], v[32:47]
    s_nop 15
P2_fbn0:
    ds_read_b64_tr_b16 v[144:145], v4 offset:1152
    ds_read_b64_tr_b16 v[146:147], v4 offset:1184
    ds_read_b64_tr_b16 v[148:149], v7 offset:0
    ds_read_b128 v[152:155], v6 offset:1216
    ds_read_b128 v[156:159], v6 offset:1824
    s_waitcnt lgkmcnt(0)
    v_mfma_f32_32x32x8bf16_1k v[64:79], v[148:149], v[24:25], 0
    v_mfma_f32_32x32x16_bf16 v[64:79], v[144:147], v[16:19], v[64:79]
    s_nop 15
    s_cmp_eq_u32 s48, 0
    s_cbranch_scc0 P2_fbm1
    v_max3_f32 v14, v14, v64, v65
    v_max3_f32 v14, v14, v66, v67
    v_max3_f32 v14, v14, v68, v69
    v_max3_f32 v14, v14, v70, v71
    v_max3_f32 v14, v14, v72, v73
    v_max3_f32 v14, v14, v74, v75
    v_max3_f32 v14, v14, v76, v77
    v_max3_f32 v14, v14, v78, v79
    s_branch P2_fbn1
P2_fbm1:
    v_exp_f32 v64, v64
    v_exp_f32 v65, v65
    v_exp_f32 v66, v66
    v_exp_f32 v67, v67
    v_exp_f32 v68, v68
    v_exp_f32 v69, v69
    v_exp_f32 v70, v70
    v_exp_f32 v71, v71
    v_exp_f32 v72, v72
    v_exp_f32 v73, v73
    v_exp_f32 v74, v74
    v_exp_f32 v75, v75
    v_exp_f32 v76, v76
    v_exp_f32 v77, v77
    v_exp_f32 v78, v78
    v_exp_f32 v79, v79
    s_nop 0
    v_cvt_pk_bf16_f32 v128, v64, v65
    v_cvt_pk_bf16_f32 v129, v66, v67
    v_cvt_pk_bf16_f32 v130, v68, v69
    v_cvt_pk_bf16_f32 v131, v70, v71
    v_cvt_pk_bf16_f32 v132, v72, v73
    v_cvt_pk_bf16_f32 v133, v74, v75
    v_cvt_pk_bf16_f32 v134, v76, v77
    v_cvt_pk_bf16_f32 v135, v78, v79
    s_nop 1
    v_mfma_f32_32x32x16_bf16 v[32:47], v[152:155], v[128:131], v[32:47]
    v_mfma_f32_32x32x16_bf16 v[32:47], v[156:159], v[132:135], v[32:47]
    s_nop 15
P2_fbn1:
    v_add_u32 v4, 4736, v4
    v_add_u32 v5, 4736, v5
    v_add_u32 v7, 4736, v7
    v_add_u32 v6, 4736, v6
    s_add_u32 s43, s43, 1
    s_cmp_lt_u32 s43, 32
    s_cbranch_scc1 P2_fbloop
    v_subrev_u32 v4, 151552, v4
    v_subrev_u32 v5, 151552, v5
    v_subrev_u32 v7, 151552, v7
    v_subrev_u32 v6, 151552, v6
    s_cmp_lg_u32 s48, 0
    s_cbranch_scc1 P2_fbdone
    s_mov_b32 s48, 1
    v_mov_b32 v15, v14
    s_nop 1
    v_permlane32_swap_b32 v14, v15
    s_nop 1
    v_max_f32 v14, v14, v15
    v_sub_f32 v14, 0, v14
    v_cvt_pk_bf16_f32 v15, v14, v14
    v_and_b32 v15, 0xffff0000, v15
    v_sub_f32 v13, v14, v15
    v_cvt_pk_bf16_f32 v15, v15, v13
    v_cmp_gt_u32 vcc, 32, v1
    s_nop 1
    v_cndmask_b32 v25, 0, v15, vcc
    s_branch P2_fbpass
P2_fbdone:
    s_barrier
    v_mov_b32 v12, 73216
    v_mov_b32 v13, 0
    ds_write_b32 v12, v13
    s_waitcnt lgkmcnt(0)
    s_mul_i32 s43, s33, 14336
    s_mul_i32 s52, s34, 56320
    s_add_u32 s39, s43, s52
    s_add_u32 s39, s39, s46
    s_mul_i32 s52, s34, 75776
    s_add_u32 s40, s43, s52
    s_mov_b32 m0, s40
    s_nop 0
    buffer_load_dwordx4 v2, s[8:11], s39 offen offset:0 sc1 lds
    buffer_load_dwordx4 v2, s[8:11], s39 offen offset:1024 sc1 lds
    buffer_load_dwordx4 v2, s[8:11], s39 offen offset:2048 sc1 lds
    buffer_load_dwordx4 v2, s[8:11], s39 offen offset:3072 sc1 lds
    s_add_u32 s40, s40, 4096
    s_add_u32 s39, s39, 4096
    s_mov_b32 m0, s40
    s_nop 0
    buffer_load_dwordx4 v2, s[8:11], s39 offen offset:0 sc1 lds
    buffer_load_dwordx4 v2, s[8:11], s39 offen offset:1024 sc1 lds
    buffer_load_dwordx4 v2, s[8:11], s39 offen offset:2048 sc1 lds
    buffer_load_dwordx4 v2, s[8:11], s39 offen offset:3072 sc1 lds
    s_add_u32 s40, s40, 4096
    s_add_u32 s39, s39, 4096
    s_mov_b32 m0, s40
    s_nop 0
    buffer_load_dwordx4 v2, s[8:11], s39 offen offset:0 sc1 lds
    buffer_load_dwordx4 v2, s[8:11], s39 offen offset:1024 sc1 lds
    buffer_load_dwordx4 v2, s[8:11], s39 offen offset:2048 sc1 lds
    buffer_load_dwordx4 v2, s[8:11], s39 offen offset:3072 sc1 lds
    s_add_u32 s40, s40, 4096
    s_add_u32 s39, s39, 4096
    s_mov_b32 m0, s40
    s_nop 0
    buffer_load_dwordx4 v2, s[8:11], s39 offen offset:0 sc1 lds
    s_cmp_lt_u32 s33, 3
    s_cselect_b32 s50, s39, 1073741824
    s_cselect_b32 s51, s40, 161792
    s_mov_b32 m0, s51
    s_nop 0
    buffer_load_dwordx4 v2, s[8:11], s50 offen offset:1024 sc1 lds
    v_cmp_gt_u32 vcc, 32, v1
    s_nop 1
    v_cndmask_b32 v8, v44, v42, vcc
    v_and_b32 v12, 31, v1
    v_add_u32 v12, s47, v12
    v_lshrrev_b32 v13, 5, v1
    v_lshlrev_b32 v13, 4, v13
    v_lshl_add_u32 v10, v12, 5, v13
    v_lshlrev_b32 v12, 2, v12
    v_mov_b32 v13, 1073741824
    v_cmp_gt_u32 vcc, 32, v1
    s_nop 1
    v_cndmask_b32 v11, v13, v12, vcc
    s_branch P2_fin
chk_5_spin:
    s_mov_b32 s51, 300000
chk_5_loop:
    ds_read_b128 v[12:15], v151
    s_waitcnt lgkmcnt(0)
    v_min3_u32 v12, v12, v13, v14
    v_min_u32 v12, v12, v15
    s_nop 0
    v_readfirstlane_b32 s50, v12
    s_cmp_ge_u32 s50, 1
    s_cbranch_scc1 chk_5_back
    s_sub_u32 s51, s51, 1
    s_cmp_lg_u32 s51, 0
    s_cbranch_scc1 chk_5_loop
    s_branch chk_5_back
chk_7_spin:
    s_mov_b32 s51, 300000
chk_7_loop:
    v_mov_b32 v9, 152736
    ds_read_b128 v[12:15], v9
    ds_read_b128 v[8:11], v9 offset:16
    s_waitcnt lgkmcnt(0)
    v_min3_u32 v12, v12, v13, v14
    v_min_u32 v12, v12, v15
    v_min3_u32 v8, v8, v9, v10
    v_min3_u32 v12, v12, v8, v11
    s_nop 0
    v_readfirstlane_b32 s50, v12
    s_cmp_ge_u32 s50, 2
    s_cbranch_scc1 chk_7_back
    s_sub_u32 s51, s51, 1
    s_cmp_lg_u32 s51, 0
    s_cbranch_scc1 chk_7_loop
    s_branch chk_7_back
sga_9_do:
    s_lshl_b32 s50, s32, 5
    s_add_u32 s50, s50, s31
    s_lshl_b32 s50, s50, 2
    s_add_u32 s50, s50, 16548864
    v_mov_b32 v250, 0
    v_mov_b32 v251, s28
    s_mov_b64 exec, 1
    buffer_store_dword v251, v250, s[8:11], s50 offen sc1
    s_mov_b64 exec, -1
    s_branch sga_9_back
chk_18_spin:
    s_mov_b32 s51, 300000
chk_18_loop:
    ds_read_b128 v[12:15], v151
    s_waitcnt lgkmcnt(0)
    v_min3_u32 v12, v12, v13, v14
    v_min_u32 v12, v12, v15
    s_nop 0
    v_readfirstlane_b32 s50, v12
    s_cmp_ge_u32 s50, 3
    s_cbranch_scc1 chk_18_back
    s_sub_u32 s51, s51, 1
    s_cmp_lg_u32 s51, 0
    s_cbranch_scc1 chk_18_loop
    s_branch chk_18_back
P2_end:
    v_add_u32 v3, 65536, v2
    v_add_u32 v4, 131072, v2
    v_add_u32 v5, 32768, v2
    v_add_u32 v6, 98304, v2
    s_waitcnt vmcnt(2)
    s_barrier
    s_cmp_eq_u32 s34, 0
    s_cbranch_scc0 P3_a1
    ds_read_b128 v[140:143], v2 offset:0
    ds_read_b128 v[144:147], v2 offset:1024
    ds_read_b128 v[148:151], v2 offset:2048
    ds_read_b128 v[152:155], v2 offset:3072
    ds_read_b128 v[156:159], v2 offset:4096
    s_add_u32 s50, s38, 112640
    s_sub_u32 s51, s50, 55808
    s_sub_u32 s52, s50, -4608
    s_cmp_ge_u32 s50, 128000
    s_cselect_b32 s51, s52, s51
    s_add_u32 s52, s50, s46
    s_cmp_ge_u32 s50, 158720
    s_cselect_b32 s52, 1073741824, s52
    s_cselect_b32 s51, 72192, s51
    s_mov_b32 m0, s51
    s_nop 0
    buffer_load_dwordx4 v2, s[8:11], s52 offen sc1 lds
    s_add_u32 s50, s38, 120832
    s_sub_u32 s51, s50, 55808
    s_sub_u32 s52, s50, -4608
    s_cmp_ge_u32 s50, 128000
    s_cselect_b32 s51, s52, s51
    s_add_u32 s52, s50, s46
    s_cmp_ge_u32 s50, 158720
    s_cselect_b32 s52, 1073741824, s52
    s_cselect_b32 s51, 72192, s51
    s_mov_b32 m0, s51
    s_nop 0
    buffer_load_dwordx4 v2, s[8:11], s52 offen sc1 lds
    s_add_u32 s50, s38, 129024
    s_sub_u32 s51, s50, 55808
    s_sub_u32 s52, s50, -4608
    s_cmp_ge_u32 s50, 128000
    s_cselect_b32 s51, s52, s51
    s_add_u32 s52, s50, s46
    s_cmp_ge_u32 s50, 158720
    s_cselect_b32 s52, 1073741824, s52
    s_cselect_b32 s51, 72192, s51
    s_mov_b32 m0, s51
    s_nop 0
    buffer_load_dwordx4 v2, s[8:11], s52 offen sc1 lds
    s_add_u32 s50, s38, 137216
    s_sub_u32 s51, s50, 55808
    s_sub_u32 s52, s50, -4608
    s_cmp_ge_u32 s50, 128000
    s_cselect_b32 s51, s52, s51
    s_add_u32 s52, s50, s46
    s_cmp_ge_u32 s50, 158720
    s_cselect_b32 s52, 1073741824, s52
    s_cselect_b32 s51, 72192, s51
    s_mov_b32 m0, s51
    s_nop 0
    buffer_load_dwordx4 v2, s[8:11], s52 offen sc1 lds
    s_add_u32 s50, s38, 145408
    s_sub_u32 s51, s50, 55808
    s_sub_u32 s52, s50, -4608
    s_cmp_ge_u32 s50, 128000
    s_cselect_b32 s51, s52, s51
    s_add_u32 s52, s50, s46
    s_cmp_ge_u32 s50, 158720
    s_cselect_b32 s52, 1073741824, s52
    s_cselect_b32 s51, 72192, s51
    s_mov_b32 m0, s51
    s_nop 0
    buffer_load_dwordx4 v2, s[8:11], s52 offen sc1 lds
    s_add_u32 s50, s38, 153600
    s_sub_u32 s51, s50, 55808
    s_sub_u32 s52, s50, -4608
    s_cmp_ge_u32 s50, 128000
    s_cselect_b32 s51, s52, s51
    s_add_u32 s52, s50, s46
    s_cmp_ge_u32 s50, 158720
    s_cselect_b32 s52, 1073741824, s52
    s_cselect_b32 s51, 72192, s51
    s_mov_b32 m0, s51
    s_nop 0
    buffer_load_dwordx4 v2, s[8:11], s52 offen sc1 lds
    s_waitcnt vmcnt(6)
    v_mov_b32 v8, 1
    v_mov_b32 v9, 73216
    s_mov_b64 exec, 1
    ds_add_rtn_u32 v10, v9, v8
    s_mov_b64 exec, -1
    s_waitcnt lgkmcnt(0)
    v_readfirstlane_b32 s50, v10
    s_cmp_eq_u32 s50, 7
    s_cbranch_scc0 P3_nosigB0
    s_lshl_b32 s47, s32, 5
    s_add_u32 s47, s47, s31
    s_lshl_b32 s50, s47, 2
    s_add_u32 s50, s50, 16549888
    v_mov_b32 v250, 0
    v_mov_b32 v251, s28
    s_mov_b64 exec, 1
    buffer_store_dword v251, v250, s[8:11], s50 offen sc1
    s_mov_b64 exec, -1
P3_nosigB0:
    ds_read_b128 v[160:163], v2 offset:5120
    ds_read_b128 v[164:167], v2 offset:6144
    ds_read_b128 v[168:171], v2 offset:7168
    ds_read_b128 v[172:175], v2 offset:8192
    ds_read_b128 v[176:179], v2 offset:9216
    s_waitcnt lgkmcnt(5)
    v_mfma_f32_16x16x32_bf16 v[24:27], v[140:143], v[208:211], 0
    v_mfma_f32_16x16x32_bf16 v[28:31], v[144:147], v[208:211], 0
    v_mfma_f32_16x16x32_bf16 v[32:35], v[148:151], v[208:211], 0
    v_mfma_f32_16x16x32_bf16 v[36:39], v[152:155], v[208:211], 0
    v_mfma_f32_16x16x32_bf16 v[40:43], v[156:159], v[208:211], 0
    ds_read_b128 v[140:143], v2 offset:10240
    ds_read_b128 v[144:147], v2 offset:11264
    ds_read_b128 v[148:151], v2 offset:12288
    ds_read_b128 v[152:155], v2 offset:13312
    ds_read_b128 v[156:159], v2 offset:14336
    s_waitcnt lgkmcnt(5)
    v_mfma_f32_16x16x32_bf16 v[24:27], v[160:163], v[212:215], v[24:27]
    v_mfma_f32_16x16x32_bf16 v[28:31], v[164:167], v[212:215], v[28:31]
    v_mfma_f32_16x16x32_bf16 v[32:35], v[168:171], v[212:215], v[32:35]
    v_mfma_f32_16x16x32_bf16 v[36:39], v[172:175], v[212:215], v[36:39]
    v_mfma_f32_16x16x32_bf16 v[40:43], v[176:179], v[212:215], v[40:43]
    ds_read_b128 v[160:163], v2 offset:15360
    ds_read_b128 v[164:167], v2 offset:16384
    ds_read_b128 v[168:171], v2 offset:17408
    ds_read_b128 v[172:175], v2 offset:18432
    ds_read_b128 v[176:179], v2 offset:19456
    s_waitcnt lgkmcnt(5)
    v_mfma_f32_16x16x32_bf16 v[24:27], v[140:143], v[216:219], v[24:27]
    v_mfma_f32_16x16x32_bf16 v[28:31], v[144:147], v[216:219], v[28:31]
    v_mfma_f32_16x16x32_bf16 v[32:35], v[148:151], v[216:219], v[32:35]
    v_mfma_f32_16x16x32_bf16 v[36:39], v[152:155], v[216:219], v[36:39]
    v_mfma_f32_16x16x32_bf16 v[40:43], v[156:159], v[216:219], v[40:43]
    ds_read_b128 v[140:143], v2 offset:20480
    ds_read_b128 v[144:147], v2 offset:21504
    ds_read_b128 v[148:151], v2 offset:22528
    ds_read_b128 v[152:155], v2 offset:23552
    ds_read_b128 v[156:159], v2 offset:24576
    s_waitcnt lgkmcnt(5)
    v_mfma_f32_16x16x32_bf16 v[24:27], v[160:163], v[220:223], v[24:27]
    v_mfma_f32_16x16x32_bf16 v[28:31], v[164:167], v[220:223], v[28:31]
    v_mfma_f32_16x16x32_bf16 v[32:35], v[168:171], v[220:223], v[32:35]
    v_mfma_f32_16x16x32_bf16 v[36:39], v[172:175], v[220:223], v[36:39]
    v_mfma_f32_16x16x32_bf16 v[40:43], v[176:179], v[220:223], v[40:43]
    ds_read_b128 v[160:163], v2 offset:25600
    ds_read_b128 v[164:167], v2 offset:26624
    ds_read_b128 v[168:171], v2 offset:27648
    ds_read_b128 v[172:175], v2 offset:28672
    ds_read_b128 v[176:179], v2 offset:29696
    s_waitcnt lgkmcnt(5)
    v_mfma_f32_16x16x32_bf16 v[24:27], v[140:143], v[224:227], v[24:27]
    v_mfma_f32_16x16x32_bf16 v[28:31], v[144:147], v[224:227], v[28:31]
    v_mfma_f32_16x16x32_bf16 v[32:35], v[148:151], v[224:227], v[32:35]
    v_mfma_f32_16x16x32_bf16 v[36:39], v[152:155], v[224:227], v[36:39]
    v_mfma_f32_16x16x32_bf16 v[40:43], v[156:159], v[224:227], v[40:43]
    ds_read_b128 v[140:143], v2 offset:30720
    ds_read_b128 v[144:147], v2 offset:31744
    ds_read_b128 v[148:151], v2 offset:32768
    ds_read_b128 v[152:155], v2 offset:33792
    ds_read_b128 v[156:159], v2 offset:34816
    s_waitcnt lgkmcnt(5)
    v_mfma_f32_16x16x32_bf16 v[24:27], v[160:163], v[228:231], v[24:27]
    v_mfma_f32_16x16x32_bf16 v[28:31], v[164:167], v[228:231], v[28:31]
    v_mfma_f32_16x16x32_bf16 v[32:35], v[168:171], v[228:231], v[32:35]
    v_mfma_f32_16x16x32_bf16 v[36:39], v[172:175], v[228:231], v[36:39]
    v_mfma_f32_16x16x32_bf16 v[40:43], v[176:179], v[228:231], v[40:43]
    ds_read_b128 v[160:163], v5 offset:3072
    ds_read_b128 v[164:167], v5 offset:4096
    ds_read_b128 v[168:171], v5 offset:5120
    ds_read_b128 v[172:175], v5 offset:6144
    ds_read_b128 v[176:179], v5 offset:7168
    s_waitcnt lgkmcnt(5)
    v_mfma_f32_16x16x32_bf16 v[24:27], v[140:143], v[232:235], v[24:27]
    v_mfma_f32_16x16x32_bf16 v[28:31], v[144:147], v[232:235], v[28:31]
    v_mfma_f32_16x16x32_bf16 v[32:35], v[148:151], v[232:235], v[32:35]
    v_mfma_f32_16x16x32_bf16 v[36:39], v[152:155], v[232:235], v[36:39]
    v_mfma_f32_16x16x32_bf16 v[40:43], v[156:159], v[232:235], v[40:43]
    ds_read_b128 v[140:143], v5 offset:8192
    ds_read_b128 v[144:147], v5 offset:9216
    ds_read_b128 v[148:151], v5 offset:10240
    ds_read_b128 v[152:155], v5 offset:11264
    ds_read_b128 v[156:159], v5 offset:12288
    s_waitcnt lgkmcnt(5)
    v_mfma_f32_16x16x32_bf16 v[24:27], v[160:163], v[236:239], v[24:27]
    v_mfma_f32_16x16x32_bf16 v[28:31], v[164:167], v[236:239], v[28:31]
    v_mfma_f32_16x16x32_bf16 v[32:35], v[168:171], v[236:239], v[32:35]
    v_mfma_f32_16x16x32_bf16 v[36:39], v[172:175], v[236:239], v[36:39]
    v_mfma_f32_16x16x32_bf16 v[40:43], v[176:179], v[236:239], v[40:43]
    s_waitcnt lgkmcnt(0)
    v_mfma_f32_16x16x32_bf16 v[24:27], v[140:143], v[240:243], v[24:27]
    v_mfma_f32_16x16x32_bf16 v[28:31], v[144:147], v[240:243], v[28:31]
    v_mfma_f32_16x16x32_bf16 v[32:35], v[148:151], v[240:243], v[32:35]
    v_mfma_f32_16x16x32_bf16 v[36:39], v[152:155], v[240:243], v[36:39]
    v_mfma_f32_16x16x32_bf16 v[40:43], v[156:159], v[240:243], v[40:43]
    s_branch P3_a2
P3_a1:
    ds_read_b128 v[140:143], v5 offset:13312
    ds_read_b128 v[144:147], v5 offset:14336
    ds_read_b128 v[148:151], v5 offset:15360
    ds_read_b128 v[152:155], v5 offset:16384
    ds_read_b128 v[156:159], v5 offset:17408
    s_add_u32 s50, s38, 112640
    s_sub_u32 s51, s50, 55808
    s_sub_u32 s52, s50, -4608
    s_cmp_ge_u32 s50, 128000
    s_cselect_b32 s51, s52, s51
    s_add_u32 s52, s50, s46
    s_cmp_ge_u32 s50, 158720
    s_cselect_b32 s52, 1073741824, s52
    s_cselect_b32 s51, 72192, s51
    s_mov_b32 m0, s51
    s_nop 0
    buffer_load_dwordx4 v2, s[8:11], s52 offen sc1 lds
    s_add_u32 s50, s38, 120832
    s_sub_u32 s51, s50, 55808
    s_sub_u32 s52, s50, -4608
    s_cmp_ge_u32 s50, 128000
    s_cselect_b32 s51, s52, s51
    s_add_u32 s52, s50, s46
    s_cmp_ge_u32 s50, 158720
    s_cselect_b32 s52, 1073741824, s52
    s_cselect_b32 s51, 72192, s51
    s_mov_b32 m0, s51
    s_nop 0
    buffer_load_dwordx4 v2, s[8:11], s52 offen sc1 lds
    s_add_u32 s50, s38, 129024
    s_sub_u32 s51, s50, 55808
    s_sub_u32 s52, s50, -4608
    s_cmp_ge_u32 s50, 128000
    s_cselect_b32 s51, s52, s51
    s_add_u32 s52, s50, s46
    s_cmp_ge_u32 s50, 158720
    s_cselect_b32 s52, 1073741824, s52
    s_cselect_b32 s51, 72192, s51
    s_mov_b32 m0, s51
    s_nop 0
    buffer_load_dwordx4 v2, s[8:11], s52 offen sc1 lds
    s_add_u32 s50, s38, 137216
    s_sub_u32 s51, s50, 55808
    s_sub_u32 s52, s50, -4608
    s_cmp_ge_u32 s50, 128000
    s_cselect_b32 s51, s52, s51
    s_add_u32 s52, s50, s46
    s_cmp_ge_u32 s50, 158720
    s_cselect_b32 s52, 1073741824, s52
    s_cselect_b32 s51, 72192, s51
    s_mov_b32 m0, s51
    s_nop 0
    buffer_load_dwordx4 v2, s[8:11], s52 offen sc1 lds
    s_add_u32 s50, s38, 145408
    s_sub_u32 s51, s50, 55808
    s_sub_u32 s52, s50, -4608
    s_cmp_ge_u32 s50, 128000
    s_cselect_b32 s51, s52, s51
    s_add_u32 s52, s50, s46
    s_cmp_ge_u32 s50, 158720
    s_cselect_b32 s52, 1073741824, s52
    s_cselect_b32 s51, 72192, s51
    s_mov_b32 m0, s51
    s_nop 0
    buffer_load_dwordx4 v2, s[8:11], s52 offen sc1 lds
    s_add_u32 s50, s38, 153600
    s_sub_u32 s51, s50, 55808
    s_sub_u32 s52, s50, -4608
    s_cmp_ge_u32 s50, 128000
    s_cselect_b32 s51, s52, s51
    s_add_u32 s52, s50, s46
    s_cmp_ge_u32 s50, 158720
    s_cselect_b32 s52, 1073741824, s52
    s_cselect_b32 s51, 72192, s51
    s_mov_b32 m0, s51
    s_nop 0
    buffer_load_dwordx4 v2, s[8:11], s52 offen sc1 lds
    s_waitcnt vmcnt(6)
    v_mov_b32 v8, 1
    v_mov_b32 v9, 73216
    s_mov_b64 exec, 1
    ds_add_rtn_u32 v10, v9, v8
    s_mov_b64 exec, -1
    s_waitcnt lgkmcnt(0)
    v_readfirstlane_b32 s50, v10
    s_cmp_eq_u32 s50, 7
    s_cbranch_scc0 P3_nosigB1
    s_lshl_b32 s47, s32, 5
    s_add_u32 s47, s47, s31
    s_lshl_b32 s50, s47, 2
    s_add_u32 s50, s50, 16549888
    v_mov_b32 v250, 0
    v_mov_b32 v251, s28
    s_mov_b64 exec, 1
    buffer_store_dword v251, v250, s[8:11], s50 offen sc1
    s_mov_b64 exec, -1
P3_nosigB1:
    ds_read_b128 v[160:163], v5 offset:18432
    ds_read_b128 v[164:167], v5 offset:19456
    ds_read_b128 v[168:171], v5 offset:20480
    ds_read_b128 v[172:175], v5 offset:21504
    ds_read_b128 v[176:179], v5 offset:22528
    s_waitcnt lgkmcnt(5)
    v_mfma_f32_16x16x32_bf16 v[24:27], v[140:143], v[208:211], 0
    v_mfma_f32_16x16x32_bf16 v[28:31], v[144:147], v[208:211], 0
    v_mfma_f32_16x16x32_bf16 v[32:35], v[148:151], v[208:211], 0
    v_mfma_f32_16x16x32_bf16 v[36:39], v[152:155], v[208:211], 0
    v_mfma_f32_16x16x32_bf16 v[40:43], v[156:159], v[208:211], 0
    ds_read_b128 v[140:143], v3 offset:10240
    ds_read_b128 v[144:147], v3 offset:11264
    ds_read_b128 v[148:151], v3 offset:12288
    ds_read_b128 v[152:155], v3 offset:13312
    ds_read_b128 v[156:159], v3 offset:14336
    s_waitcnt lgkmcnt(5)
    v_mfma_f32_16x16x32_bf16 v[24:27], v[160:163], v[212:215], v[24:27]
    v_mfma_f32_16x16x32_bf16 v[28:31], v[164:167], v[212:215], v[28:31]
    v_mfma_f32_16x16x32_bf16 v[32:35], v[168:171], v[212:215], v[32:35]
    v_mfma_f32_16x16x32_bf16 v[36:39], v[172:175], v[212:215], v[36:39]
    v_mfma_f32_16x16x32_bf16 v[40:43], v[176:179], v[212:215], v[40:43]
    ds_read_b128 v[160:163], v3 offset:15360
    ds_read_b128 v[164:167], v3 offset:16384
    ds_read_b128 v[168:171], v3 offset:17408
    ds_read_b128 v[172:175], v3 offset:18432
    ds_read_b128 v[176:179], v3 offset:19456
    s_waitcnt lgkmcnt(5)
    v_mfma_f32_16x16x32_bf16 v[24:27], v[140:143], v[216:219], v[24:27]
    v_mfma_f32_16x16x32_bf16 v[28:31], v[144:147], v[216:219], v[28:31]
    v_mfma_f32_16x16x32_bf16 v[32:35], v[148:151], v[216:219], v[32:35]
    v_mfma_f32_16x16x32_bf16 v[36:39], v[152:155], v[216:219], v[36:39]
    v_mfma_f32_16x16x32_bf16 v[40:43], v[156:159], v[216:219], v[40:43]
    ds_read_b128 v[140:143], v3 offset:20480
    ds_read_b128 v[144:147], v3 offset:21504
    ds_read_b128 v[148:151], v3 offset:22528
    ds_read_b128 v[152:155], v3 offset:23552
    ds_read_b128 v[156:159], v3 offset:24576
    s_waitcnt lgkmcnt(5)
    v_mfma_f32_16x16x32_bf16 v[24:27], v[160:163], v[220:223], v[24:27]
    v_mfma_f32_16x16x32_bf16 v[28:31], v[164:167], v[220:223], v[28:31]
    v_mfma_f32_16x16x32_bf16 v[32:35], v[168:171], v[220:223], v[32:35]
    v_mfma_f32_16x16x32_bf16 v[36:39], v[172:175], v[220:223], v[36:39]
    v_mfma_f32_16x16x32_bf16 v[40:43], v[176:179], v[220:223], v[40:43]
    ds_read_b128 v[160:163], v3 offset:25600
    ds_read_b128 v[164:167], v3 offset:26624
    ds_read_b128 v[168:171], v3 offset:27648
    ds_read_b128 v[172:175], v3 offset:28672
    ds_read_b128 v[176:179], v3 offset:29696
    s_waitcnt lgkmcnt(5)
    v_mfma_f32_16x16x32_bf16 v[24:27], v[140:143], v[224:227], v[24:27]
    v_mfma_f32_16x16x32_bf16 v[28:31], v[144:147], v[224:227], v[28:31]
    v_mfma_f32_16x16x32_bf16 v[32:35], v[148:151], v[224:227], v[32:35]
    v_mfma_f32_16x16x32_bf16 v[36:39], v[152:155], v[224:227], v[36:39]
    v_mfma_f32_16x16x32_bf16 v[40:43], v[156:159], v[224:227], v[40:43]
    ds_read_b128 v[140:143], v3 offset:30720
    ds_read_b128 v[144:147], v3 offset:31744
    ds_read_b128 v[148:151], v3 offset:32768
    ds_read_b128 v[152:155], v3 offset:33792
    ds_read_b128 v[156:159], v3 offset:34816
    s_waitcnt lgkmcnt(5)
    v_mfma_f32_16x16x32_bf16 v[24:27], v[160:163], v[228:231], v[24:27]
    v_mfma_f32_16x16x32_bf16 v[28:31], v[164:167], v[228:231], v[28:31]
    v_mfma_f32_16x16x32_bf16 v[32:35], v[168:171], v[228:231], v[32:35]
    v_mfma_f32_16x16x32_bf16 v[36:39], v[172:175], v[228:231], v[36:39]
    v_mfma_f32_16x16x32_bf16 v[40:43], v[176:179], v[228:231], v[40:43]
    ds_read_b128 v[160:163], v6 offset:3072
    ds_read_b128 v[164:167], v6 offset:4096
    ds_read_b128 v[168:171], v6 offset:5120
    ds_read_b128 v[172:175], v6 offset:6144
    ds_read_b128 v[176:179], v6 offset:7168
    s_waitcnt lgkmcnt(5)
    v_mfma_f32_16x16x32_bf16 v[24:27], v[140:143], v[232:235], v[24:27]
    v_mfma_f32_16x16x32_bf16 v[28:31], v[144:147], v[232:235], v[28:31]
    v_mfma_f32_16x16x32_bf16 v[32:35], v[148:151], v[232:235], v[32:35]
    v_mfma_f32_16x16x32_bf16 v[36:39], v[152:155], v[232:235], v[36:39]
    v_mfma_f32_16x16x32_bf16 v[40:43], v[156:159], v[232:235], v[40:43]
    s_lshl_b32 s47, s29, 7
    s_add_u32 s47, s47, 16549888
    v_lshlrev_b32 v8, 2, v1
    buffer_load_dword v16, v8, s[8:11], s47 offen sc1
    ds_read_b128 v[140:143], v6 offset:8192
    ds_read_b128 v[144:147], v6 offset:9216
    ds_read_b128 v[148:151], v6 offset:10240
    ds_read_b128 v[152:155], v6 offset:11264
    ds_read_b128 v[156:159], v6 offset:12288
    s_waitcnt lgkmcnt(5)
    v_mfma_f32_16x16x32_bf16 v[24:27], v[160:163], v[236:239], v[24:27]
    v_mfma_f32_16x16x32_bf16 v[28:31], v[164:167], v[236:239], v[28:31]
    v_mfma_f32_16x16x32_bf16 v[32:35], v[168:171], v[236:239], v[32:35]
    v_mfma_f32_16x16x32_bf16 v[36:39], v[172:175], v[236:239], v[36:39]
    v_mfma_f32_16x16x32_bf16 v[40:43], v[176:179], v[236:239], v[40:43]
    s_waitcnt lgkmcnt(0)
    v_mfma_f32_16x16x32_bf16 v[24:27], v[140:143], v[240:243], v[24:27]
    v_mfma_f32_16x16x32_bf16 v[28:31], v[144:147], v[240:243], v[28:31]
    v_mfma_f32_16x16x32_bf16 v[32:35], v[148:151], v[240:243], v[32:35]
    v_mfma_f32_16x16x32_bf16 v[36:39], v[152:155], v[240:243], v[36:39]
    v_mfma_f32_16x16x32_bf16 v[40:43], v[156:159], v[240:243], v[40:43]
P3_a2:
    s_waitcnt vmcnt(0)
    s_barrier
    s_add_u32 s50, s38, 0
    s_add_u32 s52, s50, s46
    s_add_u32 s52, s52, 158720
    s_cmp_ge_u32 s50, 25600
    s_cselect_b32 s52, 1073741824, s52
    s_cselect_b32 s51, 72192, s50
    s_mov_b32 m0, s51
    s_nop 0
    buffer_load_dwordx4 v2, s[8:11], s52 offen sc1 lds
    s_add_u32 s50, s38, 8192
    s_add_u32 s52, s50, s46
    s_add_u32 s52, s52, 158720
    s_cmp_ge_u32 s50, 25600
    s_cselect_b32 s52, 1073741824, s52
    s_cselect_b32 s51, 72192, s50
    s_mov_b32 m0, s51
    s_nop 0
    buffer_load_dwordx4 v2, s[8:11], s52 offen sc1 lds
    s_add_u32 s50, s38, 16384
    s_add_u32 s52, s50, s46
    s_add_u32 s52, s52, 158720
    s_cmp_ge_u32 s50, 25600
    s_cselect_b32 s52, 1073741824, s52
    s_cselect_b32 s51, 72192, s50
    s_mov_b32 m0, s51
    s_nop 0
    buffer_load_dwordx4 v2, s[8:11], s52 offen sc1 lds
    s_add_u32 s50, s38, 24576
    s_add_u32 s52, s50, s46
    s_add_u32 s52, s52, 158720
    s_cmp_ge_u32 s50, 25600
    s_cselect_b32 s52, 1073741824, s52
    s_cselect_b32 s51, 72192, s50
    s_mov_b32 m0, s51
    s_nop 0
    buffer_load_dwordx4 v2, s[8:11], s52 offen sc1 lds
    s_mov_b32 s20, s70
    s_and_b32 s21, s71, 0xffff
    s_mov_b32 s22, 2359296
    s_mov_b32 s23, 0x00020000
    s_lshl_b32 s47, s29, 7
    s_add_u32 s47, s47, 16549888
    v_lshrrev_b32 v12, 4, v1
    s_movk_i32 s48, 1152
    v_mul_lo_u32 v13, s48, v244
    s_mul_i32 s48, s45, 144
    v_add_u32 v13, s48, v13
    v_lshl_add_u32 v18, v12, 4, v13
    v_lshl_add_u32 v19, v12, 3, v13
    v_mov_b32 v14, 1073741824
    v_cmp_gt_u32 vcc, 2, v12
    v_sub_f32 v21, 1.0, v245
    v_cvt_pk_bf16_f32 v21, v21, v21
    v_cndmask_b32 v19, v14, v19, vcc
    v_lshlrev_b32 v21, 16, v21
    v_mov_b32 v22, v245
    v_mov_b32 v23, v245
    v_mov_b32 v20, v21
    v_pk_mul_f32 v[24:25], v[24:25], v[22:23]
    v_pk_mul_f32 v[26:27], v[26:27], v[22:23]
    v_pk_mul_f32 v[28:29], v[28:29], v[22:23]
    v_pk_mul_f32 v[30:31], v[30:31], v[22:23]
    v_pk_mul_f32 v[32:33], v[32:33], v[22:23]
    v_pk_mul_f32 v[34:35], v[34:35], v[22:23]
    v_pk_mul_f32 v[36:37], v[36:37], v[22:23]
    v_pk_mul_f32 v[38:39], v[38:39], v[22:23]
    v_pk_mul_f32 v[40:41], v[40:41], v[22:23]
    v_pk_mul_f32 v[42:43], v[42:43], v[22:23]
    s_lshl_b32 s48, s45, 2
    s_add_u32 s48, s48, s33
    s_lshl_b32 s49, s29, 8
    s_lshl_b32 s50, s44, 6
    s_add_u32 s49, s49, s50
    s_lshl_b32 s50, s48, 16
    s_lshl_b32 s51, s49, 5
    s_add_u32 s50, s50, s51
    s_add_u32 s50, s50, 12451840
    s_lshl_b32 s51, s48, 13
    s_lshl_b32 s52, s49, 2
    s_add_u32 s51, s51, s52
    s_add_u32 s51, s51, 14811136
    s_cmp_eq_u32 s34, 0
    s_cselect_b32 s54, s50, s51
    s_cselect_b32 s55, 16, 2
    v_lshlrev_b32 v10, 7, v1
    v_mov_b32 v11, 1073741824
    v_cmp_gt_u32 vcc, s55, v1
    s_nop 1
    v_cndmask_b32 v10, v11, v10, vcc
    s_cmp_eq_u32 s3, 4
    s_cbranch_scc1 P3_pollB
    s_waitcnt vmcnt(0)
    s_branch P3_nopollB
P3_pollB:
    v_cmp_eq_u32 vcc, s28, v16
    s_nop 3
    s_cmp_eq_u32 vcc_lo, -1
    s_cbranch_scc0 pb_27_go
    s_waitcnt vmcnt(0)
    s_branch P3_nopollB
pb_27_go:
    v_lshlrev_b32 v8, 2, v1
    s_mov_b32 s50, 300000
    buffer_load_dword v12, v8, s[8:11], s47 offen sc1
    s_sleep 3
    buffer_load_dword v13, v8, s[8:11], s47 offen sc1
pb_27:
    s_sleep 3
    buffer_load_dword v14, v8, s[8:11], s47 offen sc1
    s_waitcnt vmcnt(2)
    v_cmp_eq_u32 vcc, s28, v12
    s_nop 3
    s_cmp_eq_u32 vcc_lo, -1
    s_cbranch_scc1 pb_27_done
    s_sleep 3
    buffer_load_dword v12, v8, s[8:11], s47 offen sc1
    s_waitcnt vmcnt(2)
    v_cmp_eq_u32 vcc, s28, v13
    s_nop 3
    s_cmp_eq_u32 vcc_lo, -1
    s_cbranch_scc1 pb_27_done
    s_sleep 3
    buffer_load_dword v13, v8, s[8:11], s47 offen sc1
    s_waitcnt vmcnt(2)
    v_cmp_eq_u32 vcc, s28, v14
    s_nop 3
    s_cmp_eq_u32 vcc_lo, -1
    s_cbranch_scc1 pb_27_done
    s_sub_u32 s50, s50, 1
    s_cmp_lg_u32 s50, 0
    s_cbranch_scc1 pb_27
pb_27_done:
P3_nopollB:
    s_barrier
    buffer_load_dword v248, v10, s[8:11], s54 offen
    s_cmp_eq_u32 s34, 0
    s_cbranch_scc0 P3_b1
    s_mov_b32 s50, 12451840
    buffer_load_dwordx4 v[64:67], v246, s[8:11], s50 offen sc1
    s_mov_b32 s50, 12582912
    buffer_load_dwordx4 v[68:71], v246, s[8:11], s50 offen sc1
    s_mov_b32 s50, 12713984
    buffer_load_dwordx4 v[72:75], v246, s[8:11], s50 offen sc1
    s_mov_b32 s50, 12845056
    buffer_load_dwordx4 v[76:79], v246, s[8:11], s50 offen sc1
    s_mov_b32 s50, 12976128
    buffer_load_dwordx4 v[80:83], v246, s[8:11], s50 offen sc1
    s_mov_b32 s50, 13107200
    buffer_load_dwordx4 v[84:87], v246, s[8:11], s50 offen sc1
    s_mov_b32 s50, 13238272
    buffer_load_dwordx4 v[88:91], v246, s[8:11], s50 offen sc1
    s_mov_b32 s50, 13369344
    buffer_load_dwordx4 v[92:95], v246, s[8:11], s50 offen sc1
    s_mov_b32 s50, 13500416
    buffer_load_dwordx4 v[96:99], v246, s[8:11], s50 offen sc1
    ds_read_b128 v[140:143], v6 offset:13312
    ds_read_b128 v[144:147], v6 offset:14336
    ds_read_b128 v[148:151], v6 offset:15360
    ds_read_b128 v[152:155], v6 offset:16384
    ds_read_b128 v[156:159], v6 offset:17408
    ds_read_b128 v[160:163], v6 offset:18432
    ds_read_b128 v[164:167], v6 offset:19456
    ds_read_b128 v[168:171], v6 offset:20480
    ds_read_b128 v[172:175], v6 offset:21504
    ds_read_b128 v[176:179], v6 offset:22528
    s_waitcnt vmcnt(8) lgkmcnt(5)
    v_mfma_f32_16x16x32_bf16 v[44:47], v[140:143], v[64:67], 0
    v_mfma_f32_16x16x32_bf16 v[48:51], v[144:147], v[64:67], 0
    v_mfma_f32_16x16x32_bf16 v[52:55], v[148:151], v[64:67], 0
    v_mfma_f32_16x16x32_bf16 v[56:59], v[152:155], v[64:67], 0
    v_mfma_f32_16x16x32_bf16 v[60:63], v[156:159], v[64:67], 0
    ds_read_b128 v[140:143], v6 offset:23552
    ds_read_b128 v[144:147], v6 offset:24576
    ds_read_b128 v[148:151], v6 offset:25600
    ds_read_b128 v[152:155], v6 offset:26624
    ds_read_b128 v[156:159], v6 offset:27648
    s_waitcnt vmcnt(7) lgkmcnt(5)
    v_mfma_f32_16x16x32_bf16 v[44:47], v[160:163], v[68:71], v[44:47]
    v_mfma_f32_16x16x32_bf16 v[48:51], v[164:167], v[68:71], v[48:51]
    v_mfma_f32_16x16x32_bf16 v[52:55], v[168:171], v[68:71], v[52:55]
    v_mfma_f32_16x16x32_bf16 v[56:59], v[172:175], v[68:71], v[56:59]
    v_mfma_f32_16x16x32_bf16 v[60:63], v[176:179], v[68:71], v[60:63]
    ds_read_b128 v[160:163], v6 offset:28672
    ds_read_b128 v[164:167], v6 offset:29696
    ds_read_b128 v[168:171], v6 offset:30720
    ds_read_b128 v[172:175], v6 offset:31744
    ds_read_b128 v[176:179], v6 offset:32768
    s_waitcnt vmcnt(6) lgkmcnt(5)
    v_mfma_f32_16x16x32_bf16 v[44:47], v[140:143], v[72:75], v[44:47]
    v_mfma_f32_16x16x32_bf16 v[48:51], v[144:147], v[72:75], v[48:51]
    v_mfma_f32_16x16x32_bf16 v[52:55], v[148:151], v[72:75], v[52:55]
    v_mfma_f32_16x16x32_bf16 v[56:59], v[152:155], v[72:75], v[56:59]
    v_mfma_f32_16x16x32_bf16 v[60:63], v[156:159], v[72:75], v[60:63]
    ds_read_b128 v[140:143], v5 offset:24064
    ds_read_b128 v[144:147], v5 offset:25088
    ds_read_b128 v[148:151], v5 offset:26112
    ds_read_b128 v[152:155], v5 offset:27136
    ds_read_b128 v[156:159], v5 offset:28160
    s_waitcnt vmcnt(5) lgkmcnt(5)
    v_mfma_f32_16x16x32_bf16 v[44:47], v[160:163], v[76:79], v[44:47]
    v_mfma_f32_16x16x32_bf16 v[48:51], v[164:167], v[76:79], v[48:51]
    v_mfma_f32_16x16x32_bf16 v[52:55], v[168:171], v[76:79], v[52:55]
    v_mfma_f32_16x16x32_bf16 v[56:59], v[172:175], v[76:79], v[56:59]
    v_mfma_f32_16x16x32_bf16 v[60:63], v[176:179], v[76:79], v[60:63]
    ds_read_b128 v[160:163], v5 offset:29184
    ds_read_b128 v[164:167], v5 offset:30208
    ds_read_b128 v[168:171], v5 offset:31232
    ds_read_b128 v[172:175], v5 offset:32256
    ds_read_b128 v[176:179], v5 offset:33280
    s_waitcnt vmcnt(4) lgkmcnt(5)
    v_mfma_f32_16x16x32_bf16 v[44:47], v[140:143], v[80:83], v[44:47]
    v_mfma_f32_16x16x32_bf16 v[48:51], v[144:147], v[80:83], v[48:51]
    v_mfma_f32_16x16x32_bf16 v[52:55], v[148:151], v[80:83], v[52:55]
    v_mfma_f32_16x16x32_bf16 v[56:59], v[152:155], v[80:83], v[56:59]
    v_mfma_f32_16x16x32_bf16 v[60:63], v[156:159], v[80:83], v[60:63]
    ds_read_b128 v[140:143], v3 offset:1536
    ds_read_b128 v[144:147], v3 offset:2560
    ds_read_b128 v[148:151], v3 offset:3584
    ds_read_b128 v[152:155], v3 offset:4608
    ds_read_b128 v[156:159], v3 offset:5632
    s_waitcnt vmcnt(3) lgkmcnt(5)
    v_mfma_f32_16x16x32_bf16 v[44:47], v[160:163], v[84:87], v[44:47]
    v_mfma_f32_16x16x32_bf16 v[48:51], v[164:167], v[84:87], v[48:51]
    v_mfma_f32_16x16x32_bf16 v[52:55], v[168:171], v[84:87], v[52:55]
    v_mfma_f32_16x16x32_bf16 v[56:59], v[172:175], v[84:87], v[56:59]
    v_mfma_f32_16x16x32_bf16 v[60:63], v[176:179], v[84:87], v[60:63]
    ds_read_b128 v[160:163], v4 offset:1536
    ds_read_b128 v[164:167], v4 offset:2560
    ds_read_b128 v[168:171], v4 offset:3584
    ds_read_b128 v[172:175], v4 offset:4608
    ds_read_b128 v[176:179], v4 offset:5632
    s_waitcnt vmcnt(2) lgkmcnt(5)
    v_mfma_f32_16x16x32_bf16 v[44:47], v[140:143], v[88:91], v[44:47]
    v_mfma_f32_16x16x32_bf16 v[48:51], v[144:147], v[88:91], v[48:51]
    v_mfma_f32_16x16x32_bf16 v[52:55], v[148:151], v[88:91], v[52:55]
    v_mfma_f32_16x16x32_bf16 v[56:59], v[152:155], v[88:91], v[56:59]
    v_mfma_f32_16x16x32_bf16 v[60:63], v[156:159], v[88:91], v[60:63]
    ds_read_b128 v[140:143], v4 offset:6656
    ds_read_b128 v[144:147], v4 offset:7680
    ds_read_b128 v[148:151], v4 offset:8704
    ds_read_b128 v[152:155], v4 offset:9728
    ds_read_b128 v[156:159], v4 offset:10752
    s_waitcnt vmcnt(1) lgkmcnt(5)
    v_mfma_f32_16x16x32_bf16 v[44:47], v[160:163], v[92:95], v[44:47]
    v_mfma_f32_16x16x32_bf16 v[48:51], v[164:167], v[92:95], v[48:51]
    v_mfma_f32_16x16x32_bf16 v[52:55], v[168:171], v[92:95], v[52:55]
    v_mfma_f32_16x16x32_bf16 v[56:59], v[172:175], v[92:95], v[56:59]
    v_mfma_f32_16x16x32_bf16 v[60:63], v[176:179], v[92:95], v[60:63]
    s_waitcnt vmcnt(0) lgkmcnt(0)
    v_mfma_f32_16x16x32_bf16 v[44:47], v[140:143], v[96:99], v[44:47]
    v_mfma_f32_16x16x32_bf16 v[48:51], v[144:147], v[96:99], v[48:51]
    v_mfma_f32_16x16x32_bf16 v[52:55], v[148:151], v[96:99], v[52:55]
    v_mfma_f32_16x16x32_bf16 v[56:59], v[152:155], v[96:99], v[56:59]
    v_mfma_f32_16x16x32_bf16 v[60:63], v[156:159], v[96:99], v[60:63]
    s_branch P3_b2
P3_b1:
    s_mov_b32 s50, 13631488
    buffer_load_dwordx4 v[64:67], v246, s[8:11], s50 offen sc1
    s_mov_b32 s50, 13762560
    buffer_load_dwordx4 v[68:71], v246, s[8:11], s50 offen sc1
    s_mov_b32 s50, 13893632
    buffer_load_dwordx4 v[72:75], v246, s[8:11], s50 offen sc1
    s_mov_b32 s50, 14024704
    buffer_load_dwordx4 v[76:79], v246, s[8:11], s50 offen sc1
    s_mov_b32 s50, 14155776
    buffer_load_dwordx4 v[80:83], v246, s[8:11], s50 offen sc1
    s_mov_b32 s50, 14286848
    buffer_load_dwordx4 v[84:87], v246, s[8:11], s50 offen sc1
    s_mov_b32 s50, 14417920
    buffer_load_dwordx4 v[88:91], v246, s[8:11], s50 offen sc1
    s_mov_b32 s50, 14811136
    buffer_load_dword v92, v247, s[8:11], s50 offen sc1
    s_mov_b32 s50, 14819328
    buffer_load_dword v93, v247, s[8:11], s50 offen sc1
    s_mov_b32 s50, 14827520
    buffer_load_dword v94, v247, s[8:11], s50 offen sc1
    s_mov_b32 s50, 14835712
    buffer_load_dword v95, v247, s[8:11], s50 offen sc1
    s_mov_b32 s50, 14942208
    buffer_load_dword v96, v247, s[8:11], s50 offen sc1
    s_mov_b32 s50, 14950400
    buffer_load_dword v97, v247, s[8:11], s50 offen sc1
    s_mov_b32 s50, 14958592
    buffer_load_dword v98, v247, s[8:11], s50 offen sc1
    s_mov_b32 s50, 14966784
    buffer_load_dword v99, v247, s[8:11], s50 offen sc1
    ds_read_b128 v[140:143], v4 offset:11776
    ds_read_b128 v[144:147], v4 offset:12800
    ds_read_b128 v[148:151], v4 offset:13824
    ds_read_b128 v[152:155], v4 offset:14848
    ds_read_b128 v[156:159], v4 offset:15872
    ds_read_b128 v[160:163], v4 offset:16896
    ds_read_b128 v[164:167], v4 offset:17920
    ds_read_b128 v[168:171], v4 offset:18944
    ds_read_b128 v[172:175], v4 offset:19968
    ds_read_b128 v[176:179], v4 offset:20992
    s_waitcnt vmcnt(14) lgkmcnt(5)
    v_mfma_f32_16x16x32_bf16 v[44:47], v[140:143], v[64:67], 0
    v_mfma_f32_16x16x32_bf16 v[48:51], v[144:147], v[64:67], 0
    v_mfma_f32_16x16x32_bf16 v[52:55], v[148:151], v[64:67], 0
    v_mfma_f32_16x16x32_bf16 v[56:59], v[152:155], v[64:67], 0
    v_mfma_f32_16x16x32_bf16 v[60:63], v[156:159], v[64:67], 0
    ds_read_b128 v[140:143], v4 offset:22016
    ds_read_b128 v[144:147], v4 offset:23040
    ds_read_b128 v[148:151], v4 offset:24064
    ds_read_b128 v[152:155], v4 offset:25088
    ds_read_b128 v[156:159], v4 offset:26112
    s_waitcnt vmcnt(13) lgkmcnt(5)
    v_mfma_f32_16x16x32_bf16 v[44:47], v[160:163], v[68:71], v[44:47]
    v_mfma_f32_16x16x32_bf16 v[48:51], v[164:167], v[68:71], v[48:51]
    v_mfma_f32_16x16x32_bf16 v[52:55], v[168:171], v[68:71], v[52:55]
    v_mfma_f32_16x16x32_bf16 v[56:59], v[172:175], v[68:71], v[56:59]
    v_mfma_f32_16x16x32_bf16 v[60:63], v[176:179], v[68:71], v[60:63]
    ds_read_b128 v[160:163], v4 offset:27136
    ds_read_b128 v[164:167], v4 offset:28160
    ds_read_b128 v[168:171], v4 offset:29184
    ds_read_b128 v[172:175], v4 offset:30208
    ds_read_b128 v[176:179], v4 offset:31232
    s_waitcnt vmcnt(12) lgkmcnt(5)
    v_mfma_f32_16x16x32_bf16 v[44:47], v[140:143], v[72:75], v[44:47]
    v_mfma_f32_16x16x32_bf16 v[48:51], v[144:147], v[72:75], v[48:51]
    v_mfma_f32_16x16x32_bf16 v[52:55], v[148:151], v[72:75], v[52:55]
    v_mfma_f32_16x16x32_bf16 v[56:59], v[152:155], v[72:75], v[56:59]
    v_mfma_f32_16x16x32_bf16 v[60:63], v[156:159], v[72:75], v[60:63]
    ds_read_b128 v[140:143], v2 offset:0
    ds_read_b128 v[144:147], v2 offset:1024
    ds_read_b128 v[148:151], v2 offset:2048
    ds_read_b128 v[152:155], v2 offset:3072
    ds_read_b128 v[156:159], v2 offset:4096
    s_waitcnt vmcnt(11) lgkmcnt(5)
    v_mfma_f32_16x16x32_bf16 v[44:47], v[160:163], v[76:79], v[44:47]
    v_mfma_f32_16x16x32_bf16 v[48:51], v[164:167], v[76:79], v[48:51]
    v_mfma_f32_16x16x32_bf16 v[52:55], v[168:171], v[76:79], v[52:55]
    v_mfma_f32_16x16x32_bf16 v[56:59], v[172:175], v[76:79], v[56:59]
    v_mfma_f32_16x16x32_bf16 v[60:63], v[176:179], v[76:79], v[60:63]
    ds_read_b128 v[160:163], v2 offset:5120
    ds_read_b128 v[164:167], v2 offset:6144
    ds_read_b128 v[168:171], v2 offset:7168
    ds_read_b128 v[172:175], v2 offset:8192
    ds_read_b128 v[176:179], v2 offset:9216
    s_waitcnt vmcnt(10) lgkmcnt(5)
    v_mfma_f32_16x16x32_bf16 v[44:47], v[140:143], v[80:83], v[44:47]
    v_mfma_f32_16x16x32_bf16 v[48:51], v[144:147], v[80:83], v[48:51]
    v_mfma_f32_16x16x32_bf16 v[52:55], v[148:151], v[80:83], v[52:55]
    v_mfma_f32_16x16x32_bf16 v[56:59], v[152:155], v[80:83], v[56:59]
    v_mfma_f32_16x16x32_bf16 v[60:63], v[156:159], v[80:83], v[60:63]
    ds_read_b128 v[140:143], v2 offset:10240
    ds_read_b128 v[144:147], v2 offset:11264
    ds_read_b128 v[148:151], v2 offset:12288
    ds_read_b128 v[152:155], v2 offset:13312
    ds_read_b128 v[156:159], v2 offset:14336
    s_waitcnt vmcnt(9) lgkmcnt(5)
    v_mfma_f32_16x16x32_bf16 v[44:47], v[160:163], v[84:87], v[44:47]
    v_mfma_f32_16x16x32_bf16 v[48:51], v[164:167], v[84:87], v[48:51]
    v_mfma_f32_16x16x32_bf16 v[52:55], v[168:171], v[84:87], v[52:55]
    v_mfma_f32_16x16x32_bf16 v[56:59], v[172:175], v[84:87], v[56:59]
    v_mfma_f32_16x16x32_bf16 v[60:63], v[176:179], v[84:87], v[60:63]
    ds_read_b128 v[160:163], v2 offset:15360
    ds_read_b128 v[164:167], v2 offset:16384
    ds_read_b128 v[168:171], v2 offset:17408
    ds_read_b128 v[172:175], v2 offset:18432
    ds_read_b128 v[176:179], v2 offset:19456
    s_waitcnt vmcnt(8) lgkmcnt(5)
    v_mfma_f32_16x16x32_bf16 v[44:47], v[140:143], v[88:91], v[44:47]
    v_mfma_f32_16x16x32_bf16 v[48:51], v[144:147], v[88:91], v[48:51]
    v_mfma_f32_16x16x32_bf16 v[52:55], v[148:151], v[88:91], v[52:55]
    v_mfma_f32_16x16x32_bf16 v[56:59], v[152:155], v[88:91], v[56:59]
    v_mfma_f32_16x16x32_bf16 v[60:63], v[156:159], v[88:91], v[60:63]
    ds_read_b128 v[140:143], v2 offset:20480
    ds_read_b128 v[144:147], v2 offset:21504
    ds_read_b128 v[148:151], v2 offset:22528
    ds_read_b128 v[152:155], v2 offset:23552
    ds_read_b128 v[156:159], v2 offset:24576
    s_waitcnt vmcnt(4) lgkmcnt(5)
    v_mfma_f32_16x16x32_bf16 v[44:47], v[160:163], v[92:95], v[44:47]
    v_mfma_f32_16x16x32_bf16 v[48:51], v[164:167], v[92:95], v[48:51]
    v_mfma_f32_16x16x32_bf16 v[52:55], v[168:171], v[92:95], v[52:55]
    v_mfma_f32_16x16x32_bf16 v[56:59], v[172:175], v[92:95], v[56:59]
    v_mfma_f32_16x16x32_bf16 v[60:63], v[176:179], v[92:95], v[60:63]
    s_waitcnt vmcnt(0) lgkmcnt(0)
    v_mfma_f32_16x16x32_bf16 v[44:47], v[140:143], v[96:99], v[44:47]
    v_mfma_f32_16x16x32_bf16 v[48:51], v[144:147], v[96:99], v[48:51]
    v_mfma_f32_16x16x32_bf16 v[52:55], v[148:151], v[96:99], v[52:55]
    v_mfma_f32_16x16x32_bf16 v[56:59], v[152:155], v[96:99], v[56:59]
    v_mfma_f32_16x16x32_bf16 v[60:63], v[156:159], v[96:99], v[60:63]
P3_b2:
    s_nop 4
    v_pk_fma_f32 v[24:25], v[44:45], v[20:21], v[24:25]
    v_pk_fma_f32 v[26:27], v[46:47], v[20:21], v[26:27]
    v_pk_fma_f32 v[28:29], v[48:49], v[20:21], v[28:29]
    v_pk_fma_f32 v[30:31], v[50:51], v[20:21], v[30:31]
    v_pk_fma_f32 v[32:33], v[52:53], v[20:21], v[32:33]
    v_pk_fma_f32 v[34:35], v[54:55], v[20:21], v[34:35]
    v_pk_fma_f32 v[36:37], v[56:57], v[20:21], v[36:37]
    v_pk_fma_f32 v[38:39], v[58:59], v[20:21], v[38:39]
    v_pk_fma_f32 v[40:41], v[60:61], v[20:21], v[40:41]
    v_pk_fma_f32 v[42:43], v[62:63], v[20:21], v[42:43]
    s_mul_i32 s47, s33, 5120
    s_add_u32 s47, s47, 32768
    v_add_u32 v9, s47, v2
    s_cmp_eq_u32 s34, 0
    s_cbranch_scc0 P3_k1
    ds_write_b128 v9, v[32:35] offset:2048
    ds_write_b128 v9, v[36:39] offset:3072
    s_waitcnt lgkmcnt(0)
    s_barrier
    ds_read_b128 v[44:47], v9 offset:0
    ds_read_b128 v[48:51], v9 offset:1024
    ds_read_b128 v[60:63], v9 offset:4096
    s_waitcnt lgkmcnt(0)
    v_pk_add_f32 v[24:25], v[24:25], v[44:45]
    v_pk_add_f32 v[26:27], v[26:27], v[46:47]
    v_pk_add_f32 v[28:29], v[28:29], v[48:49]
    v_pk_add_f32 v[30:31], v[30:31], v[50:51]
    v_pk_add_f32 v[40:41], v[40:41], v[60:61]
    v_pk_add_f32 v[42:43], v[42:43], v[62:63]
    v_cvt_pk_bf16_f32 v12, v24, v25
    v_cvt_pk_bf16_f32 v13, v26, v27
    v_cvt_pk_bf16_f32 v14, v28, v29
    v_cvt_pk_bf16_f32 v15, v30, v31
    buffer_store_dwordx4 v[12:15], v18, s[20:23], 0 offen offset:0
    v_cvt_pk_bf16_f32 v20, v40, v41
    v_cvt_pk_bf16_f32 v21, v42, v43
    buffer_store_dwordx2 v[20:21], v19, s[20:23], 0 offen offset:128
    s_branch P3_end
P3_k1:
    ds_write_b128 v9, v[24:27] offset:0
    ds_write_b128 v9, v[28:31] offset:1024
    ds_write_b128 v9, v[40:43] offset:4096
    s_waitcnt lgkmcnt(0)
    s_barrier
    ds_read_b128 v[52:55], v9 offset:2048
    ds_read_b128 v[56:59], v9 offset:3072
    s_waitcnt lgkmcnt(0)
    v_pk_add_f32 v[32:33], v[32:33], v[52:53]
    v_pk_add_f32 v[34:35], v[34:35], v[54:55]
    v_pk_add_f32 v[36:37], v[36:37], v[56:57]
    v_pk_add_f32 v[38:39], v[38:39], v[58:59]
    v_cvt_pk_bf16_f32 v12, v32, v33
    v_cvt_pk_bf16_f32 v13, v34, v35
    v_cvt_pk_bf16_f32 v14, v36, v37
    v_cvt_pk_bf16_f32 v15, v38, v39
    buffer_store_dwordx4 v[12:15], v18, s[20:23], 0 offen offset:64
P3_end:
L_done:
    s_endpgm

.section .rodata,"a"
.p2align 6
.amdhsa_kernel gated_mix__linear_attn_block__mha_block__prompt_kernel
  .amdhsa_next_free_vgpr 256
  .amdhsa_next_free_sgpr 102
  .amdhsa_accum_offset 256
  .amdhsa_group_segment_fixed_size 0
  .amdhsa_kernarg_size 80
  .amdhsa_user_sgpr_count 2
  .amdhsa_user_sgpr_kernarg_segment_ptr 1
  .amdhsa_system_sgpr_workgroup_id_x 1
.end_amdhsa_kernel
```
